```python
import torch

def _softmax(x, axis=-1):
    return torch.softmax(x, dim=axis)
def _gelu(x):
    return torch.nn.functional.gelu(x, approximate="tanh")
def _silu(x):
    return torch.nn.functional.silu(x)
def _sigmoid(x):
    return torch.sigmoid(x)
def _layernorm(x, axis=-1, eps=1e-5):
    m = x.mean(dim=axis, keepdim=True)
    v = x.var(dim=axis, keepdim=True, unbiased=False)
    return (x - m) / torch.sqrt(v + eps)
def _scatter_add(tgt, idx, src, axis=0):
    return tgt.clone().index_add_(axis, idx, src)
def _segment_sum(src, seg, n):
    out = torch.zeros((n,) + src.shape[1:], dtype=src.dtype)
    return out.index_add_(0, seg, src)
def _pad(x, pw):
    flat = tuple(v for pair in reversed(pw) for v in pair)
    return torch.nn.functional.pad(x, flat)

kernel_name = 'recurrent_scan__spectral_gfnet__swiglu_ffn__prompt'

def setup_inputs():

    _w = (lambda a: (lambda t: t.to(torch.bfloat16) if t.is_floating_point() else t)(torch.as_tensor(a)))
    def _A_setup():
        B, S, D = 1, 2048, 640
        Df = D // 2 + 1
        return {
            "x": _w((lambda *s: torch.randn(*s, dtype=torch.bfloat16) * 0.05)(B, S, D)),
            "w_r": _w((lambda *s: torch.randn(*s, dtype=torch.bfloat16) * 0.1)(S, Df) * 0.02),
            "w_i": _w((lambda *s: torch.randn(*s, dtype=torch.bfloat16) * 0.1)(S, Df) * 0.02),
        }
    _A_in = _A_setup()

    def _B_setup():
        B, S, D, F = 1, 2048, 640, 1536
        return {
            "x": _w((lambda *s: torch.randn(*s, dtype=torch.bfloat16) * 0.05)(B, S, D)),
            "w_gate": _w((lambda *s: torch.randn(*s, dtype=torch.bfloat16) * 0.05)(D, F)),
            "w_up": _w((lambda *s: torch.randn(*s, dtype=torch.bfloat16) * 0.05)(D, F)),
            "w_down": _w((lambda *s: torch.randn(*s, dtype=torch.bfloat16) * 0.05)(F, D)),
        }
    _B_in = _B_setup()

    return {
        "A_x": _A_in["x"],
        "A_w_r": _A_in["w_r"],
        "A_w_i": _A_in["w_i"],
        "B_x": _B_in["x"],
        "B_w_gate": _B_in["w_gate"],
        "B_w_up": _B_in["w_up"],
        "B_w_down": _B_in["w_down"],
    }

def reference(A_x, A_w_r, A_w_i, B_x, B_w_gate, B_w_up, B_w_down):
    def _A_ref(x, w_r, w_i):
        B, S, D = x.shape
        X = (lambda x, axes=(-2,-1): torch.fft.rfft2(x.float(), dim=axes))(x, axes=(-2, -1))
        W = w_r + 1j * w_i
        X = X * W
        y = (lambda x, s, axes=(-2,-1): torch.fft.irfft2(x, s=s, dim=axes).to(torch.bfloat16))(X, (S, D), axes=(-2, -1))
        return y

    def _B_ref(x, w_gate, w_up, w_down):
        g = _silu(x @ w_gate)
        u = x @ w_up
        return (g * u) @ w_down

    x = A_x
    xn = _layernorm(x, axis=-1)
    s = _A_ref(xn, A_w_r, A_w_i)
    g = _silu(_B_ref(xn, B_w_gate, B_w_up, B_w_down))
    return x + s * g
```

```asm
; @launch grid=(256,1,1) block=(256,1,1) lds=163840
.amdgcn_target "amdgcn-amd-amdhsa--gfx950"
.text
.globl recurrent_scan__spectral_gfnet__swiglu_ffn__prompt_kernel
.p2align 8
.type recurrent_scan__spectral_gfnet__swiglu_ffn__prompt_kernel,@function
recurrent_scan__spectral_gfnet__swiglu_ffn__prompt_kernel:
    s_cmp_lt_u32 s2, 256
    s_cbranch_scc1 k_go
    s_endpgm
k_go:
    s_load_dwordx16 s[4:19], s[0:1], 0
    s_load_dwordx4 s[20:23], s[0:1], 64
    s_and_b32 s48, s2, 7
    s_lshr_b32 s49, s2, 3
    v_lshrrev_b32 v1, 6, v0
    s_nop 0
    v_readfirstlane_b32 s3, v1
    v_and_b32 v0, 63, v0
    s_getpc_b64 s[60:61]
k_pc:
    s_and_b32 s50, s49, 7
    s_lshl_b32 s50, s50, 2
    s_add_u32 s50, s50, s3
    s_lshl_b32 s50, s50, 11
    v_lshl_add_u32 v2, v0, 5, s50
    v_min_u32 v2, k_end-k_pc-4, v2
    v_mov_b32 v3, s61
    v_add_co_u32 v2, vcc, s60, v2
    s_nop 1
    v_addc_co_u32 v3, vcc, 0, v3, vcc
    global_load_dword v125, v[2:3], off
    s_cmp_lt_u32 s49, 24
    s_cbranch_scc1 k_ffn
    s_sub_u32 s50, s49, 24
    s_and_b32 s57, s50, 1
    s_lshr_b32 s50, s50, 1
    s_and_b32 s56, s48, 1
    s_lshl_b32 s56, s56, 2
    s_add_u32 s56, s56, s50
    s_lshl_b32 s56, s56, 2
    s_and_b32 s50, s48, 2
    s_add_u32 s56, s56, s50
    s_lshr_b32 s50, s48, 2
    s_add_u32 s56, s56, s50
    v_lshrrev_b32 v2, 3, v0
    v_and_b32 v3, 7, v0
    v_and_b32 v4, 6, v2
    v_xor_b32 v4, v4, v3
    v_mul_u32_u24 v10, 40960, v2
    v_lshl_add_u32 v10, v4, 4, v10
    s_lshl_b32 s50, s3, 1
    s_add_u32 s50, s50, s57
    s_xor_b32 s51, s50, 1
    s_mul_i32 s73, s50, 10240
    s_mul_i32 s72, s51, 10240
    s_lshl_b32 s50, s50, 8
    s_add_u32 s50, s50, s56
    s_mul_i32 s60, s50, 1280
    s_lshl_b32 s51, s51, 8
    s_add_u32 s51, s51, s56
    s_mul_i32 s61, s51, 1280
    s_waitcnt lgkmcnt(0)
    s_load_dword s54, s[22:23], 0
    s_mov_b32 s24, s4
    s_mov_b32 s25, s5
    s_mov_b32 s26, 2621440
    s_mov_b32 s27, 0x20000
    s_mov_b32 s28, s22
    s_mov_b32 s29, s23
    s_mov_b32 s30, 14680064
    s_mov_b32 s31, 0x20000
    s_add_u32 m0, s73, 0
    s_nop 0
    buffer_load_dwordx4 v10, s[24:27], s60 offen offset:0 lds
    s_add_u32 m0, s73, 896
    s_nop 0
    buffer_load_dwordx4 v10, s[24:27], s60 offen offset:128 lds
    s_add_u32 m0, s73, 1792
    s_nop 0
    buffer_load_dwordx4 v10, s[24:27], s60 offen offset:256 lds
    s_add_u32 m0, s73, 2688
    s_nop 0
    buffer_load_dwordx4 v10, s[24:27], s60 offen offset:384 lds
    s_add_u32 m0, s73, 3584
    s_nop 0
    buffer_load_dwordx4 v10, s[24:27], s60 offen offset:512 lds
    s_add_u32 m0, s73, 4480
    s_nop 0
    buffer_load_dwordx4 v10, s[24:27], s60 offen offset:640 lds
    s_add_u32 m0, s73, 5376
    s_nop 0
    buffer_load_dwordx4 v10, s[24:27], s60 offen offset:768 lds
    s_add_u32 m0, s73, 6272
    s_nop 0
    buffer_load_dwordx4 v10, s[24:27], s60 offen offset:896 lds
    s_branch k_spec
k_ffn:
    s_and_b32 s50, s48, 1
    s_and_b32 s51, s49, 3
    s_lshr_b32 s52, s49, 2
    s_lshr_b32 s58, s48, 2
    s_and_b32 s53, s48, 6
    s_lshl_b32 s53, s53, 1
    s_lshr_b32 s53, 0x2004, s53
    s_and_b32 s53, s53, 15
    s_add_u32 s52, s52, s53
    s_cmp_ge_u32 s52, 6
    s_cselect_b32 s53, -6, 0
    s_add_u32 s52, s52, s53
    s_lshl_b32 s57, s50, 2
    s_add_u32 s57, s57, s51
    s_lshl_b32 s57, s57, 2
    s_and_b32 s53, s48, 2
    s_add_u32 s57, s57, s53
    s_add_u32 s57, s57, s58
    s_lshr_b32 s56, s48, 1
    s_mul_i32 s56, s56, 6
    s_add_u32 s56, s56, s52
    s_mul_i32 s52, s52, 27
    s_lshr_b32 s52, s52, 4
    s_mul_i32 s51, s51, 5
    s_lshr_b32 s51, s51, 1
    s_lshr_b32 s74, s3, 1
    s_mul_i32 s74, s74, 5
    s_add_u32 s74, s74, s52
    s_add_u32 s74, s74, s58
    s_cmp_ge_u32 s74, 6
    s_cselect_b32 s53, -6, 4
    s_add_u32 s74, s74, s53
    s_lshl_b32 s74, s74, 3
    s_lshr_b32 s53, s57, 2
    s_add_u32 s74, s74, s53
    s_mul_i32 s74, s74, 192
    s_add_u32 s74, s74, s56
    s_lshl_b32 s74, s74, 7
    s_add_u32 s59, s51, s52
    s_add_u32 s59, s59, s50
    s_add_u32 s59, s59, s58
    s_sub_u32 s50, s59, 10
    s_cmp_ge_u32 s59, 10
    s_cselect_b32 s59, s50, s59
    s_lshr_b32 s50, s3, 1
    s_and_b32 s51, s3, 1
    s_lshl_b32 s51, s51, 10
    s_xor_b32 s60, s57, s50
    s_add_u32 s60, s60, s51
    s_mul_i32 s60, s60, 10
    s_add_u32 s60, s60, s59
    s_lshl_b32 s60, s60, 7
    s_lshl_b32 s62, s3, 12
    s_add_u32 s63, s62, 65536
    s_lshl_b32 s61, s59, 2
    s_add_u32 s61, s61, s3
    s_mul_i32 s61, s61, 49152
    s_lshl_b32 s52, s56, 7
    s_add_u32 s61, s61, s52
    v_lshrrev_b32 v8, 3, v0
    v_and_b32 v9, 7, v0
    v_lshrrev_b32 v10, 4, v0
    v_xor_b32 v10, v10, v9
    v_lshlrev_b32 v10, 4, v10
    v_mul_u32_u24 v2, 40960, v8
    v_add_u32 v2, v2, v10
    v_xor_b32 v3, 64, v2
    v_add_u32 v3, 326656, v3
    v_add_u32 v4, 653312, v2
    v_add_u32 v5, 653312, v3
    v_and_b32 v10, 2, v8
    v_xor_b32 v10, v10, v9
    v_lshlrev_b32 v10, 4, v10
    v_mul_u32_u24 v6, 3072, v8
    v_add_u32 v6, v6, v10
    v_xor_b32 v7, 64, v6
    v_add_u32 v7, 23552, v7
    s_mov_b32 s26, 2621440
    s_mov_b32 s27, 0x20000
    s_mov_b32 s34, 1966080
    s_mov_b32 s35, 0x20000
    s_mov_b32 s38, 1968128
    s_mov_b32 s39, 0x20000
    s_mov_b32 s42, 1966080
    s_mov_b32 s43, 0x20000
    s_mov_b32 s30, 14680064
    s_mov_b32 s31, 0x20000
    s_mov_b32 s46, 2621440
    s_mov_b32 s47, 0x20000
    s_add_u32 m0, s62, 0
    s_waitcnt lgkmcnt(0)
    s_mov_b64 s[24:25], s[4:5]
    buffer_load_dwordx4 v2, s[24:27], s60 offen offset:0 lds
    buffer_load_dwordx4 v3, s[24:27], s60 offen offset:1024 lds
    s_mov_b64 s[32:33], s[12:13]
    s_sub_u32 s36, s14, 2048
    s_subb_u32 s37, s15, 0
    s_load_dword s54, s[22:23], 0
    buffer_load_dwordx4 v4, s[24:27], s60 offen offset:2048 lds
    buffer_load_dwordx4 v5, s[24:27], s60 offen offset:3072 lds
    s_movk_i32 s6, 128
    s_mov_b32 s7, 196608
    s_add_u32 m0, s63, 0
    s_nop 0
    buffer_load_dwordx4 v6, s[32:35], s61 offen offset:0 lds
    s_cmp_eq_u32 s59, 9
    s_cselect_b32 s75, -1152, s6
    s_add_u32 s60, s60, s75
    buffer_load_dwordx4 v7, s[32:35], s61 offen offset:1024 lds
    buffer_load_dwordx4 v6, s[36:39], s61 offen offset:2048 lds
    buffer_load_dwordx4 v7, s[36:39], s61 offen offset:3072 lds
    s_bitcmp1_b32 s3, 0
    s_cselect_b64 s[40:41], s[14:15], s[12:13]
    buffer_load_dword v126, v6, s[40:43], s74 offen
    s_mov_b64 s[40:41], s[16:17]
    s_mov_b64 s[44:45], s[18:19]
    s_mov_b64 s[28:29], s[22:23]
    s_xor_b32 s76, s57, 2
    s_add_u32 s76, s76, s51
    s_mul_i32 s76, s76, 1280
    s_xor_b32 s77, s57, 3
    s_add_u32 s77, s77, s51
    s_mul_i32 s77, s77, 1280
    s_add_u32 s52, s50, s59
    s_cmp_ge_u32 s52, 10
    s_cselect_b32 s53, -10, 0
    s_add_u32 s53, s53, s52
    s_lshl_b32 s84, s53, 7
    s_cmp_ge_u32 s52, 8
    s_cselect_b32 s53, -8, 2
    s_add_u32 s53, s53, s52
    s_lshl_b32 s85, s53, 7
    s_cmp_ge_u32 s52, 6
    s_cselect_b32 s53, -6, 4
    s_add_u32 s53, s53, s52
    s_lshl_b32 s86, s53, 7
    s_cmp_ge_u32 s52, 4
    s_cselect_b32 s53, -4, 6
    s_add_u32 s53, s53, s52
    s_lshl_b32 s87, s53, 7
    s_cmp_ge_u32 s52, 2
    s_cselect_b32 s53, -2, 8
    s_add_u32 s53, s53, s52
    s_lshl_b32 s88, s53, 7
    s_lshl_b32 s56, s56, 2
    s_add_u32 s56, s56, s3
    s_xor_b32 s52, s57, 0
    s_mul_i32 s52, s52, 192
    s_add_u32 s52, s52, s56
    s_lshl_b32 s52, s52, 10
    s_add_u32 s80, s52, 7340032
    s_xor_b32 s52, s57, 1
    s_mul_i32 s52, s52, 192
    s_add_u32 s52, s52, s56
    s_lshl_b32 s52, s52, 10
    s_add_u32 s81, s52, 7340032
    s_xor_b32 s52, s57, 2
    s_mul_i32 s52, s52, 192
    s_add_u32 s52, s52, s56
    s_lshl_b32 s52, s52, 10
    s_add_u32 s82, s52, 7340032
    s_xor_b32 s52, s57, 3
    s_mul_i32 s52, s52, 192
    s_add_u32 s52, s52, s56
    s_lshl_b32 s52, s52, 10
    s_add_u32 s83, s52, 7340032
    s_lshr_b32 s52, s48, 1
    s_lshl_b32 s52, s52, 3
    s_add_u32 s52, s52, s56
    s_lshl_b32 s53, s57, 7
    s_add_u32 s52, s52, s53
    s_lshl_b32 s52, s52, 2
    s_add_u32 s65, s52, 262144
    s_lshl_b32 s52, s57, 10
    s_add_u32 s78, s52, 65536
    s_xor_b32 s79, s78, 1024
    s_and_b32 s52, s48, 1
    s_lshl_b32 s52, s52, 3
    s_and_b32 s53, s48, 4
    s_add_u32 s52, s52, s53
    s_and_b32 s53, s49, 1
    s_lshl_b32 s53, s53, 1
    s_add_u32 s52, s52, s53
    s_bfe_u32 s58, s48, 0x10001
    s_add_u32 s72, s52, s58
    s_lshr_b32 s73, s49, 1
    s_sub_u32 s52, s73, 10
    s_cmp_ge_u32 s73, 10
    s_cselect_b32 s73, s52, s73
    s_lshl_b32 s52, s72, 1
    s_add_u32 s57, s52, s50
    s_add_u32 s52, s57, s51
    s_mul_i32 s52, s52, 10
    s_add_u32 s52, s52, s73
    s_lshl_b32 s69, s52, 7
    s_and_b32 s51, s3, 2
    s_add_u32 s51, s51, s58
    s_lshl_b32 s52, s57, 2
    s_add_u32 s52, s52, s51
    s_lshl_b32 s52, s52, 7
    s_add_u32 s66, s52, 262144
    s_lshl_b32 s53, s72, 2
    s_add_u32 s53, s53, s3
    s_mul_i32 s50, s53, 98304
    s_add_u32 s50, s50, 7340032
    s_xor_b32 s52, s51, 0
    s_mul_i32 s52, s52, 24576
    s_add_u32 s8, s52, s50
    s_xor_b32 s52, s51, 2
    s_mul_i32 s52, s52, 24576
    s_add_u32 s9, s52, s50
    s_xor_b32 s52, s51, 1
    s_mul_i32 s52, s52, 24576
    s_add_u32 s10, s52, s50
    s_xor_b32 s52, s51, 3
    s_mul_i32 s52, s52, 24576
    s_add_u32 s11, s52, s50
    s_mul_i32 s50, s3, 20480
    s_lshl_b32 s52, s73, 7
    s_add_u32 s50, s50, s52
    s_xor_b32 s52, s58, 0
    s_mul_i32 s52, s52, 491520
    s_add_u32 s4, s52, s50
    s_xor_b32 s52, s58, 2
    s_mul_i32 s52, s52, 491520
    s_add_u32 s5, s52, s50
    s_xor_b32 s52, s58, 1
    s_mul_i32 s52, s52, 491520
    s_add_u32 s0, s52, s50
    s_xor_b32 s52, s58, 3
    s_mul_i32 s52, s52, 491520
    s_add_u32 s89, s52, s50
    s_lshl_b32 s64, s3, 11
    s_sub_u32 s50, s73, 5
    s_cmp_ge_u32 s73, 5
    s_cselect_b32 s51, s50, s73
    s_cselect_b32 s52, 0x80008000, 0
    s_cmp_ge_u32 s51, 3
    s_cselect_b32 s70, 0x80008000, 0
    s_xor_b32 s70, s70, s52
    s_cmp_ge_u32 s51, 2
    s_cselect_b32 s71, 0x80008000, 0
    s_xor_b32 s71, s71, s52
    s_mul_i32 s50, s53, 40960
    s_lshl_b32 s51, s51, 7
    s_add_u32 s50, s50, s51
    s_add_u32 s68, s50, 4194304
    s_and_b32 s51, s3, 1
    s_lshl_b32 s51, s51, 2
    s_lshr_b32 s50, s72, 2
    s_add_u32 s50, s50, s51
    s_lshl_b32 s50, s50, 12
    s_add_u32 s67, s50, 196608
    s_waitcnt lgkmcnt(0)
    s_mul_i32 s54, s54, 0x9E3779B1
    s_add_u32 s54, s54, 0x7F4A7C15
    s_mul_i32 s50, s73, 10
    s_lshr_b32 s50, s50, 4
    s_cmp_ge_u32 s50, 6
    s_cselect_b32 s51, -6, 0
    s_add_u32 s51, s51, s50
    s_lshl_b32 s12, s51, 12
    s_mul_i32 s18, s51, 81920
    s_cmp_ge_u32 s50, 5
    s_cselect_b32 s51, -5, 1
    s_add_u32 s51, s51, s50
    s_lshl_b32 s13, s51, 12
    s_mul_i32 s19, s51, 81920
    s_cmp_ge_u32 s50, 4
    s_cselect_b32 s51, -4, 2
    s_add_u32 s51, s51, s50
    s_lshl_b32 s14, s51, 12
    s_mul_i32 s20, s51, 81920
    s_cmp_ge_u32 s50, 3
    s_cselect_b32 s51, -3, 3
    s_add_u32 s51, s51, s50
    s_lshl_b32 s15, s51, 12
    s_mul_i32 s21, s51, 81920
    s_cmp_ge_u32 s50, 2
    s_cselect_b32 s51, -2, 4
    s_add_u32 s51, s51, s50
    s_lshl_b32 s16, s51, 12
    s_mul_i32 s22, s51, 81920
    s_cmp_ge_u32 s50, 1
    s_cselect_b32 s51, -1, 5
    s_add_u32 s51, s51, s50
    s_lshl_b32 s17, s51, 12
    s_mul_i32 s23, s51, 81920
    v_mul_u32_u24 v12, 1280, v8
    v_add_u32 v12, v12, v10
    v_xor_b32 v13, 64, v12
    v_add_u32 v13, 9216, v13
    v_mul_u32_u24 v14, 640, v8
    v_add_u32 v14, v14, v10
    v_xor_b32 v15, 64, v14
    v_add_u32 v15, 4096, v15
    v_add_u32 v16, 8192, v14
    v_add_u32 v17, 8192, v15
    v_min_u32 v18, 23, v0
    v_lshlrev_b32 v18, 2, v18
    v_lshrrev_b32 v19, 1, v0
    v_lshlrev_b32 v19, 7, v19
    v_and_b32 v8, 15, v0
    v_lshrrev_b32 v9, 4, v0
    v_bfe_u32 v10, v0, 1, 3
    v_lshlrev_b32 v21, 4, v8
    v_lshl_add_u32 v21, v9, 9, v21
    v_xor_b32 v22, v9, v10
    v_lshlrev_b32 v22, 4, v22
    v_lshl_add_u32 v22, v8, 7, v22
    v_xor_b32 v23, 64, v22
    v_lshrrev_b32 v33, 5, v0
    v_xor_b32 v33, v33, v10
    v_lshlrev_b32 v33, 4, v33
    v_lshl_add_u32 v33, v8, 7, v33
    v_and_b32 v10, 1, v9
    v_lshl_add_u32 v33, v10, 3, v33
    s_add_u32 s50, s62, 81920
    v_add_u32 v33, s50, v33
    v_lshlrev_b32 v24, 4, v0
    v_add_u32 v25, 98304, v24
    v_and_b32 v31, 0x1f0, v24
    v_and_b32 v10, 3, v0
    v_lshlrev_b32 v32, 3, v10
    v_bfe_u32 v10, v0, 3, 2
    v_lshl_add_u32 v32, v10, 5, v32
    v_bfe_u32 v10, v0, 2, 2
    v_lshl_add_u32 v32, v10, 7, v32
    v_lshl_add_u32 v32, v9, 10, v32
    s_lshl_b32 s50, s3, 5
    s_add_u32 s50, s50, 65536
    v_xor_b32 v30, s50, v32
    v_lshrrev_b32 v10, 5, v0
    v_lshl_add_u32 v30, v10, 11, v30
    s_lshr_b32 s50, s3, 1
    s_mul_i32 s50, s50, 49152
    s_add_u32 s50, s50, 65536
    v_add_u32 v26, s50, v32
    v_xor_b32 v27, 32, v26
    v_xor_b32 v28, 64, v26
    v_xor_b32 v29, 96, v26
    s_add_u32 m0, s62, 16384
    s_nop 0
    buffer_load_dwordx4 v2, s[24:27], s60 offen offset:0 lds
    s_cmp_eq_u32 s59, 9
    s_cselect_b32 s75, -1769472, s7
    s_add_u32 s61, s61, s75
    buffer_load_dwordx4 v3, s[24:27], s60 offen offset:1024 lds
    buffer_load_dwordx4 v4, s[24:27], s60 offen offset:2048 lds
    buffer_load_dwordx4 v5, s[24:27], s60 offen offset:3072 lds
    s_and_b32 s51, s3, 1
    s_lshl_b32 s51, s51, 5
    v_add_u32 v8, s51, v8
    v_cvt_f32_u32 v114, v8
    v_mul_f32 v114, 0x3c800000, v114
    v_add_f32 v115, 0x3e800000, v114
    v_cvt_f32_u32 v9, v9
    v_mul_f32 v9, 4.0, v9
    v_cmp_gt_u32 vcc, 16, v0
    v_mul_f32 v8, v114, v9
    v_mul_f32 v10, 0x42000000, v114
    v_add_f32 v10, 0x3e800000, v10
    v_fmamk_f32 v225, v114, 0x0, v8
    v_fmamk_f32 v227, v114, 0x3f800000, v8
    v_fmamk_f32 v229, v114, 0x40000000, v8
    v_fmamk_f32 v231, v114, 0x40400000, v8
    v_fmamk_f32 v233, v114, 0x41800000, v8
    v_fmamk_f32 v235, v114, 0x41880000, v8
    v_fmamk_f32 v237, v114, 0x41900000, v8
    v_fmamk_f32 v239, v114, 0x41980000, v8
    v_cos_f32 v224, v225
    v_cos_f32 v226, v227
    v_cos_f32 v228, v229
    v_cos_f32 v230, v231
    v_cos_f32 v232, v233
    v_cos_f32 v234, v235
    v_cos_f32 v236, v237
    v_cos_f32 v238, v239
    v_cndmask_b32 v225, v225, v10, vcc
    v_sin_f32 v225, v225
    v_sin_f32 v227, v227
    v_sin_f32 v229, v229
    v_sin_f32 v231, v231
    v_sin_f32 v233, v233
    v_sin_f32 v235, v235
    v_sin_f32 v237, v237
    v_sin_f32 v239, v239
    v_mul_f32 v8, v115, v9
    v_mul_f32 v10, 0x42000000, v115
    v_add_f32 v10, 0x3e800000, v10
    v_fmamk_f32 v241, v115, 0x0, v8
    v_fmamk_f32 v243, v115, 0x3f800000, v8
    v_fmamk_f32 v245, v115, 0x40000000, v8
    v_fmamk_f32 v247, v115, 0x40400000, v8
    v_fmamk_f32 v249, v115, 0x41800000, v8
    v_fmamk_f32 v251, v115, 0x41880000, v8
    v_fmamk_f32 v253, v115, 0x41900000, v8
    v_fmamk_f32 v255, v115, 0x41980000, v8
    v_cos_f32 v240, v241
    v_cos_f32 v242, v243
    v_cos_f32 v244, v245
    v_cos_f32 v246, v247
    v_cos_f32 v248, v249
    v_cos_f32 v250, v251
    v_cos_f32 v252, v253
    v_cos_f32 v254, v255
    v_cndmask_b32 v241, v241, v10, vcc
    v_sin_f32 v241, v241
    v_sin_f32 v243, v243
    v_sin_f32 v245, v245
    v_sin_f32 v247, v247
    v_sin_f32 v249, v249
    v_sin_f32 v251, v251
    v_sin_f32 v253, v253
    v_sin_f32 v255, v255
    v_mov_b32 v42, 0x3f803f80
    v_mov_b32 v43, 0x3f803f80
    v_mov_b32 v44, 0x3f803f80
    v_mov_b32 v45, 0x3f803f80
    s_lshl_b32 s50, s49, 2
    s_add_u32 s50, s50, s3
    s_mul_i32 s50, s50, 20480
    s_lshl_b32 s51, s48, 9
    s_add_u32 s50, s50, s51
    v_min_u32 v8, 19, v0
    v_lshrrev_b32 v9, 2, v8
    v_and_b32 v8, 3, v8
    v_lshl_add_u32 v8, v8, 7, s50
    v_lshl_add_u32 v54, v9, 12, v8
    s_mov_b64 s[50:51], 0xffff
    s_lshl_b64 s[52:53], s[50:51], 16
    s_mov_b64 exec, 0
    s_cmp_eq_u32 s3, 1
    s_cbranch_scc1 ffn_pg1
    s_cmp_eq_u32 s3, 2
    s_cbranch_scc1 ffn_pg2
    s_cmp_eq_u32 s3, 3
    s_cbranch_scc1 ffn_pg3
    s_branch ffn_pg0
ffn_ret:
    s_mov_b64 exec, -1
    s_add_u32 m0, s63, 16384
    s_nop 0
    buffer_load_dwordx4 v6, s[32:35], s61 offen offset:0 lds
    s_cmp_eq_u32 s59, 8
    s_cselect_b32 s75, -1152, s6
    s_add_u32 s60, s60, s75
    buffer_load_dwordx4 v7, s[32:35], s61 offen offset:1024 lds
    buffer_load_dwordx4 v6, s[36:39], s61 offen offset:2048 lds
    buffer_load_dwordx4 v7, s[36:39], s61 offen offset:3072 lds
    s_branch ffn_main
.p2align 12
ffn_main:
ffn_pg0:
    s_cbranch_execz ffn_pg4
    s_waitcnt vmcnt(9)
    s_barrier
    ds_read_b64_tr_b16 a[0:1], v30 offset:0
    ds_read_b64_tr_b16 a[2:3], v30 offset:512
    ds_read_b64_tr_b16 a[4:5], v30 offset:2048
    ds_read_b64_tr_b16 a[6:7], v30 offset:2560
    ds_read_b128 v[58:61], v22 offset:0
    ds_read_b128 v[62:65], v22 offset:2048
    ds_read_b128 v[66:69], v22 offset:4096
    ds_read_b128 v[70:73], v22 offset:6144
    ds_read_b128 v[74:77], v22 offset:8192
    ds_read_b64_tr_b16 a[8:9], v30 offset:8192
    s_waitcnt lgkmcnt(5)
    v_mfma_f32_16x16x32_bf16 v[128:131], a[0:3], v[58:61], 0
    ds_read_b128 v[78:81], v22 offset:10240
    v_mfma_f32_16x16x32_bf16 v[136:139], a[4:7], v[58:61], 0
    ds_read_b64_tr_b16 a[10:11], v30 offset:8704
    s_add_u32 m0, s62, 32768
    s_waitcnt lgkmcnt(6)
    v_mfma_f32_16x16x32_bf16 v[132:135], a[0:3], v[62:65], 0
    ds_read_b128 v[82:85], v22 offset:12288
    v_mfma_f32_16x16x32_bf16 v[140:143], a[4:7], v[62:65], 0
    s_waitcnt lgkmcnt(5)
    buffer_load_dwordx4 v2, s[24:27], s60 offen offset:0 lds
    v_mfma_f32_16x16x32_bf16 v[144:147], a[0:3], v[66:69], 0
    ds_read_b128 v[86:89], v22 offset:14336
    s_cmp_eq_u32 s59, 8
    v_mfma_f32_16x16x32_bf16 v[152:155], a[4:7], v[66:69], 0
    ds_read_b128 v[58:61], v23 offset:0
    s_cselect_b32 s75, -1769472, s7
    v_mfma_f32_16x16x32_bf16 v[34:37], v[42:45], a[0:3], 0
    s_add_u32 s61, s61, s75
    buffer_load_dwordx4 v3, s[24:27], s60 offen offset:1024 lds
    v_mfma_f32_16x16x32_bf16 v[148:151], a[0:3], v[70:73], 0
    ds_read_b128 v[62:65], v23 offset:2048
    v_mfma_f32_16x16x32_bf16 v[156:159], a[4:7], v[70:73], 0
    s_waitcnt lgkmcnt(2)
    ds_read_b64_tr_b16 a[12:13], v30 offset:10240
    v_mfma_f32_16x16x32_bf16 v[160:163], a[0:3], v[74:77], 0
    ds_read_b128 v[66:69], v23 offset:4096
    v_cvt_pk_bf16_f32 v192, v224, v225
    v_mfma_f32_16x16x32_bf16 v[168:171], a[4:7], v[74:77], 0
    ds_read_b64_tr_b16 a[14:15], v30 offset:10752
    v_cvt_pk_bf16_f32 v193, v226, v227
    v_mfma_f32_16x16x32_bf16 v[164:167], a[0:3], v[78:81], 0
    ds_read_b128 v[70:73], v23 offset:6144
    v_cvt_pk_bf16_f32 v194, v228, v229
    v_mfma_f32_16x16x32_bf16 v[172:175], a[4:7], v[78:81], 0
    ds_read_b128 v[74:77], v23 offset:8192
    v_cvt_pk_bf16_f32 v195, v230, v231
    v_mfma_f32_16x16x32_bf16 v[176:179], a[0:3], v[82:85], 0
    ds_read_b128 v[78:81], v23 offset:10240
    v_cvt_pk_bf16_f32 v196, v232, v233
    v_mfma_f32_16x16x32_bf16 v[184:187], a[4:7], v[82:85], 0
    buffer_load_dwordx4 v4, s[24:27], s60 offen offset:2048 lds
    v_mfma_f32_16x16x32_bf16 v[38:41], v[42:45], a[4:7], 0
    buffer_load_dwordx4 v5, s[24:27], s60 offen offset:3072 lds
    v_mfma_f32_16x16x32_bf16 v[180:183], a[0:3], v[86:89], 0
    ds_read_b128 v[82:85], v23 offset:12288
    s_add_u32 m0, s63, 32768
    v_mfma_f32_16x16x32_bf16 v[188:191], a[4:7], v[86:89], 0
    s_waitcnt lgkmcnt(4)
    buffer_load_dwordx4 v6, s[32:35], s61 offen offset:0 lds
    v_mfma_f32_16x16x32_bf16 v[128:131], a[8:11], v[58:61], v[128:131]
    ds_read_b128 v[86:89], v23 offset:14336
    s_cmp_eq_u32 s59, 7
    v_mfma_f32_16x16x32_bf16 v[136:139], a[12:15], v[58:61], v[136:139]
    s_cselect_b32 s75, -1152, s6
    s_add_u32 s60, s60, s75
    buffer_load_dwordx4 v7, s[32:35], s61 offen offset:1024 lds
    v_mfma_f32_16x16x32_bf16 v[132:135], a[8:11], v[62:65], v[132:135]
    buffer_load_dwordx4 v6, s[36:39], s61 offen offset:2048 lds
    v_mfma_f32_16x16x32_bf16 v[140:143], a[12:15], v[62:65], v[140:143]
    buffer_load_dwordx4 v7, s[36:39], s61 offen offset:3072 lds
    v_mfma_f32_16x16x32_bf16 v[144:147], a[8:11], v[66:69], v[144:147]
    s_add_u32 m0, s62, 49152
    s_nop 0
    buffer_load_dwordx4 v2, s[24:27], s60 offen offset:0 lds
    v_mfma_f32_16x16x32_bf16 v[152:155], a[12:15], v[66:69], v[152:155]
    s_waitcnt vmcnt(9) lgkmcnt(0)
    s_barrier
    v_mfma_f32_16x16x32_bf16 v[34:37], v[42:45], a[8:11], v[34:37]
    ds_read_b64_tr_b16 a[16:17], v30 offset:16384
    s_cmp_eq_u32 s59, 7
    v_mfma_f32_16x16x32_bf16 v[148:151], a[8:11], v[70:73], v[148:151]
    ds_read_b128 v[58:61], v22 offset:16384
    s_cselect_b32 s75, -1769472, s7
    v_mfma_f32_16x16x32_bf16 v[156:159], a[12:15], v[70:73], v[156:159]
    ds_read_b64_tr_b16 a[18:19], v30 offset:16896
    s_add_u32 s61, s61, s75
    v_mfma_f32_16x16x32_bf16 v[160:163], a[8:11], v[74:77], v[160:163]
    ds_read_b128 v[62:65], v22 offset:18432
    v_cvt_pk_bf16_f32 v197, v234, v235
    v_mfma_f32_16x16x32_bf16 v[168:171], a[12:15], v[74:77], v[168:171]
    ds_read_b64_tr_b16 a[20:21], v30 offset:18432
    v_cvt_pk_bf16_f32 v198, v236, v237
    v_mfma_f32_16x16x32_bf16 v[164:167], a[8:11], v[78:81], v[164:167]
    ds_read_b128 v[66:69], v22 offset:20480
    v_cvt_pk_bf16_f32 v199, v238, v239
    v_mfma_f32_16x16x32_bf16 v[172:175], a[12:15], v[78:81], v[172:175]
    ds_read_b64_tr_b16 a[22:23], v30 offset:18944
    v_cvt_pk_bf16_f32 v200, v240, v241
    v_mfma_f32_16x16x32_bf16 v[176:179], a[8:11], v[82:85], v[176:179]
    ds_read_b128 v[70:73], v22 offset:22528
    v_cvt_pk_bf16_f32 v201, v242, v243
    v_mfma_f32_16x16x32_bf16 v[184:187], a[12:15], v[82:85], v[184:187]
    buffer_load_dwordx4 v3, s[24:27], s60 offen offset:1024 lds
    v_mfma_f32_16x16x32_bf16 v[38:41], v[42:45], a[12:15], v[38:41]
    ds_read_b64_tr_b16 a[24:25], v30 offset:24576
    v_cvt_pk_bf16_f32 v202, v244, v245
    v_mfma_f32_16x16x32_bf16 v[180:183], a[8:11], v[86:89], v[180:183]
    ds_read_b128 v[74:77], v22 offset:24576
    v_cvt_pk_bf16_f32 v203, v246, v247
    v_mfma_f32_16x16x32_bf16 v[188:191], a[12:15], v[86:89], v[188:191]
    s_waitcnt lgkmcnt(3)
    buffer_load_dwordx4 v4, s[24:27], s60 offen offset:2048 lds
    v_mfma_f32_16x16x32_bf16 v[128:131], a[16:19], v[58:61], v[128:131]
    ds_read_b128 v[78:81], v22 offset:26624
    v_cvt_pk_bf16_f32 v204, v248, v249
    v_mfma_f32_16x16x32_bf16 v[136:139], a[20:23], v[58:61], v[136:139]
    ds_read_b64_tr_b16 a[26:27], v30 offset:25088
    v_cvt_pk_bf16_f32 v205, v250, v251
    v_mfma_f32_16x16x32_bf16 v[132:135], a[16:19], v[62:65], v[132:135]
    ds_read_b128 v[82:85], v22 offset:28672
    v_cvt_pk_bf16_f32 v206, v252, v253
    v_mfma_f32_16x16x32_bf16 v[140:143], a[20:23], v[62:65], v[140:143]
    s_waitcnt lgkmcnt(5)
    buffer_load_dwordx4 v5, s[24:27], s60 offen offset:3072 lds
    v_mfma_f32_16x16x32_bf16 v[144:147], a[16:19], v[66:69], v[144:147]
    ds_read_b128 v[86:89], v22 offset:30720
    s_add_u32 m0, s63, 49152
    v_mfma_f32_16x16x32_bf16 v[152:155], a[20:23], v[66:69], v[152:155]
    ds_read_b128 v[58:61], v23 offset:16384
    v_cvt_pk_bf16_f32 v207, v254, v255
    v_mfma_f32_16x16x32_bf16 v[34:37], v[42:45], a[16:19], v[34:37]
    buffer_load_dwordx4 v6, s[32:35], s61 offen offset:0 lds
    v_mfma_f32_16x16x32_bf16 v[148:151], a[16:19], v[70:73], v[148:151]
    ds_read_b128 v[62:65], v23 offset:18432
    s_cmp_eq_u32 s59, 6
    v_mfma_f32_16x16x32_bf16 v[156:159], a[20:23], v[70:73], v[156:159]
    s_waitcnt lgkmcnt(2)
    ds_read_b64_tr_b16 a[28:29], v30 offset:26624
    v_mfma_f32_16x16x32_bf16 v[160:163], a[16:19], v[74:77], v[160:163]
    ds_read_b128 v[66:69], v23 offset:20480
    s_cselect_b32 s75, -1152, s6
    v_mfma_f32_16x16x32_bf16 v[168:171], a[20:23], v[74:77], v[168:171]
    ds_read_b64_tr_b16 a[30:31], v30 offset:27136
    s_add_u32 s60, s60, s75
    v_mfma_f32_16x16x32_bf16 v[164:167], a[16:19], v[78:81], v[164:167]
    ds_read_b128 v[70:73], v23 offset:22528
    v_accvgpr_write_b32 a208, v192
    v_mfma_f32_16x16x32_bf16 v[172:175], a[20:23], v[78:81], v[172:175]
    ds_read_b128 v[74:77], v23 offset:24576
    v_xor_b32 v208, s70, v192
    v_mfma_f32_16x16x32_bf16 v[176:179], a[16:19], v[82:85], v[176:179]
    ds_read_b128 v[78:81], v23 offset:26624
    v_xor_b32 v192, s71, v192
    v_mfma_f32_16x16x32_bf16 v[184:187], a[20:23], v[82:85], v[184:187]
    buffer_load_dwordx4 v7, s[32:35], s61 offen offset:1024 lds
    v_mfma_f32_16x16x32_bf16 v[38:41], v[42:45], a[20:23], v[38:41]
    buffer_load_dwordx4 v6, s[36:39], s61 offen offset:2048 lds
    v_mfma_f32_16x16x32_bf16 v[180:183], a[16:19], v[86:89], v[180:183]
    ds_read_b128 v[82:85], v23 offset:28672
    v_accvgpr_write_b32 a209, v193
    v_mfma_f32_16x16x32_bf16 v[188:191], a[20:23], v[86:89], v[188:191]
    s_waitcnt lgkmcnt(4)
    buffer_load_dwordx4 v7, s[36:39], s61 offen offset:3072 lds
    v_mfma_f32_16x16x32_bf16 v[128:131], a[24:27], v[58:61], v[128:131]
    ds_read_b128 v[86:89], v23 offset:30720
    s_add_u32 m0, s62, 0
    v_mfma_f32_16x16x32_bf16 v[136:139], a[28:31], v[58:61], v[136:139]
    buffer_load_dwordx4 v2, s[24:27], s60 offen offset:0 lds
    v_mfma_f32_16x16x32_bf16 v[132:135], a[24:27], v[62:65], v[132:135]
    s_cmp_eq_u32 s59, 6
    s_cselect_b32 s75, -1769472, s7
    s_add_u32 s61, s61, s75
    buffer_load_dwordx4 v3, s[24:27], s60 offen offset:1024 lds
    v_mfma_f32_16x16x32_bf16 v[140:143], a[28:31], v[62:65], v[140:143]
    buffer_load_dwordx4 v4, s[24:27], s60 offen offset:2048 lds
    v_mfma_f32_16x16x32_bf16 v[144:147], a[24:27], v[66:69], v[144:147]
    buffer_load_dwordx4 v5, s[24:27], s60 offen offset:3072 lds
    v_mfma_f32_16x16x32_bf16 v[152:155], a[28:31], v[66:69], v[152:155]
    s_waitcnt vmcnt(12) lgkmcnt(0)
    s_barrier
    v_mfma_f32_16x16x32_bf16 v[34:37], v[42:45], a[24:27], v[34:37]
    ds_read_b64_tr_b16 a[32:33], v30 offset:32768
    s_add_u32 m0, s63, 0
    v_mfma_f32_16x16x32_bf16 v[148:151], a[24:27], v[70:73], v[148:151]
    ds_read_b128 v[58:61], v22 offset:32768
    v_xor_b32 v209, s70, v193
    v_mfma_f32_16x16x32_bf16 v[156:159], a[28:31], v[70:73], v[156:159]
    ds_read_b64_tr_b16 a[34:35], v30 offset:33280
    v_xor_b32 v193, s71, v193
    v_mfma_f32_16x16x32_bf16 v[160:163], a[24:27], v[74:77], v[160:163]
    ds_read_b128 v[62:65], v22 offset:34816
    v_accvgpr_write_b32 a210, v194
    v_mfma_f32_16x16x32_bf16 v[168:171], a[28:31], v[74:77], v[168:171]
    ds_read_b64_tr_b16 a[36:37], v30 offset:34816
    v_xor_b32 v210, s70, v194
    v_mfma_f32_16x16x32_bf16 v[164:167], a[24:27], v[78:81], v[164:167]
    ds_read_b128 v[66:69], v22 offset:36864
    v_xor_b32 v194, s71, v194
    v_mfma_f32_16x16x32_bf16 v[172:175], a[28:31], v[78:81], v[172:175]
    ds_read_b64_tr_b16 a[38:39], v30 offset:35328
    v_accvgpr_write_b32 a211, v195
    v_mfma_f32_16x16x32_bf16 v[176:179], a[24:27], v[82:85], v[176:179]
    ds_read_b128 v[70:73], v22 offset:38912
    v_xor_b32 v211, s70, v195
    v_mfma_f32_16x16x32_bf16 v[184:187], a[28:31], v[82:85], v[184:187]
    buffer_load_dwordx4 v6, s[32:35], s61 offen offset:0 lds
    v_mfma_f32_16x16x32_bf16 v[38:41], v[42:45], a[28:31], v[38:41]
    ds_read_b64_tr_b16 a[40:41], v30 offset:40960
    s_cmp_eq_u32 s59, 5
    v_mfma_f32_16x16x32_bf16 v[180:183], a[24:27], v[86:89], v[180:183]
    ds_read_b128 v[74:77], v22 offset:40960
    s_cselect_b32 s75, -1152, s6
    v_mfma_f32_16x16x32_bf16 v[188:191], a[28:31], v[86:89], v[188:191]
    s_waitcnt lgkmcnt(3)
    s_add_u32 s60, s60, s75
    buffer_load_dwordx4 v7, s[32:35], s61 offen offset:1024 lds
    v_mfma_f32_16x16x32_bf16 v[128:131], a[32:35], v[58:61], v[128:131]
    ds_read_b128 v[78:81], v22 offset:43008
    v_xor_b32 v195, s71, v195
    v_mfma_f32_16x16x32_bf16 v[136:139], a[36:39], v[58:61], v[136:139]
    ds_read_b64_tr_b16 a[42:43], v30 offset:41472
    v_accvgpr_write_b32 a212, v196
    v_mfma_f32_16x16x32_bf16 v[132:135], a[32:35], v[62:65], v[132:135]
    ds_read_b128 v[82:85], v22 offset:45056
    v_xor_b32 v212, s70, v196
    v_mfma_f32_16x16x32_bf16 v[140:143], a[36:39], v[62:65], v[140:143]
    s_waitcnt lgkmcnt(5)
    buffer_load_dwordx4 v6, s[36:39], s61 offen offset:2048 lds
    v_mfma_f32_16x16x32_bf16 v[144:147], a[32:35], v[66:69], v[144:147]
    ds_read_b128 v[86:89], v22 offset:47104
    v_xor_b32 v196, s71, v196
    v_mfma_f32_16x16x32_bf16 v[152:155], a[36:39], v[66:69], v[152:155]
    ds_read_b128 v[58:61], v23 offset:32768
    v_accvgpr_write_b32 a213, v197
    v_mfma_f32_16x16x32_bf16 v[34:37], v[42:45], a[32:35], v[34:37]
    buffer_load_dwordx4 v7, s[36:39], s61 offen offset:3072 lds
    v_mfma_f32_16x16x32_bf16 v[148:151], a[32:35], v[70:73], v[148:151]
    ds_read_b128 v[62:65], v23 offset:34816
    s_add_u32 m0, s62, 16384
    v_mfma_f32_16x16x32_bf16 v[156:159], a[36:39], v[70:73], v[156:159]
    s_waitcnt lgkmcnt(2)
    ds_read_b64_tr_b16 a[44:45], v30 offset:43008
    v_mfma_f32_16x16x32_bf16 v[160:163], a[32:35], v[74:77], v[160:163]
    ds_read_b128 v[66:69], v23 offset:36864
    v_xor_b32 v213, s70, v197
    v_mfma_f32_16x16x32_bf16 v[168:171], a[36:39], v[74:77], v[168:171]
    ds_read_b64_tr_b16 a[46:47], v30 offset:43520
    v_xor_b32 v197, s71, v197
    v_mfma_f32_16x16x32_bf16 v[164:167], a[32:35], v[78:81], v[164:167]
    ds_read_b128 v[70:73], v23 offset:38912
    v_accvgpr_write_b32 a214, v198
    v_mfma_f32_16x16x32_bf16 v[172:175], a[36:39], v[78:81], v[172:175]
    ds_read_b128 v[74:77], v23 offset:40960
    v_xor_b32 v214, s70, v198
    v_mfma_f32_16x16x32_bf16 v[176:179], a[32:35], v[82:85], v[176:179]
    ds_read_b128 v[78:81], v23 offset:43008
    v_xor_b32 v198, s71, v198
    v_mfma_f32_16x16x32_bf16 v[184:187], a[36:39], v[82:85], v[184:187]
    buffer_load_dwordx4 v2, s[24:27], s60 offen offset:0 lds
    v_mfma_f32_16x16x32_bf16 v[38:41], v[42:45], a[36:39], v[38:41]
    s_cmp_eq_u32 s59, 5
    s_cselect_b32 s75, -1769472, s7
    s_add_u32 s61, s61, s75
    buffer_load_dwordx4 v3, s[24:27], s60 offen offset:1024 lds
    v_mfma_f32_16x16x32_bf16 v[180:183], a[32:35], v[86:89], v[180:183]
    ds_read_b128 v[82:85], v23 offset:45056
    v_accvgpr_write_b32 a215, v199
    v_mfma_f32_16x16x32_bf16 v[188:191], a[36:39], v[86:89], v[188:191]
    s_waitcnt lgkmcnt(4)
    buffer_load_dwordx4 v4, s[24:27], s60 offen offset:2048 lds
    v_mfma_f32_16x16x32_bf16 v[128:131], a[40:43], v[58:61], v[128:131]
    ds_read_b128 v[86:89], v23 offset:47104
    v_xor_b32 v215, s70, v199
    v_mfma_f32_16x16x32_bf16 v[136:139], a[44:47], v[58:61], v[136:139]
    buffer_load_dwordx4 v5, s[24:27], s60 offen offset:3072 lds
    v_mfma_f32_16x16x32_bf16 v[132:135], a[40:43], v[62:65], v[132:135]
    s_add_u32 m0, s63, 16384
    s_nop 0
    buffer_load_dwordx4 v6, s[32:35], s61 offen offset:0 lds
    v_mfma_f32_16x16x32_bf16 v[140:143], a[44:47], v[62:65], v[140:143]
    s_cmp_eq_u32 s59, 4
    s_cselect_b32 s75, -1152, s6
    s_add_u32 s60, s60, s75
    v_mfma_f32_16x16x32_bf16 v[144:147], a[40:43], v[66:69], v[144:147]
    buffer_load_dwordx4 v7, s[32:35], s61 offen offset:1024 lds
    v_mfma_f32_16x16x32_bf16 v[152:155], a[44:47], v[66:69], v[152:155]
    s_waitcnt vmcnt(14) lgkmcnt(0)
    s_barrier
    v_mfma_f32_16x16x32_bf16 v[34:37], v[42:45], a[40:43], v[34:37]
    ds_read_b64_tr_b16 a[48:49], v30 offset:49152
    v_xor_b32 v199, s71, v199
    v_mfma_f32_16x16x32_bf16 v[148:151], a[40:43], v[70:73], v[148:151]
    ds_read_b128 v[58:61], v22 offset:49152
    v_accvgpr_write_b32 a216, v200
    v_mfma_f32_16x16x32_bf16 v[156:159], a[44:47], v[70:73], v[156:159]
    ds_read_b64_tr_b16 a[50:51], v30 offset:49664
    v_xor_b32 v216, s70, v200
    v_mfma_f32_16x16x32_bf16 v[160:163], a[40:43], v[74:77], v[160:163]
    ds_read_b128 v[62:65], v22 offset:51200
    v_xor_b32 v200, s71, v200
    v_mfma_f32_16x16x32_bf16 v[168:171], a[44:47], v[74:77], v[168:171]
    ds_read_b64_tr_b16 a[52:53], v30 offset:51200
    v_accvgpr_write_b32 a217, v201
    v_mfma_f32_16x16x32_bf16 v[164:167], a[40:43], v[78:81], v[164:167]
    ds_read_b128 v[66:69], v22 offset:53248
    v_xor_b32 v217, s70, v201
    v_mfma_f32_16x16x32_bf16 v[172:175], a[44:47], v[78:81], v[172:175]
    ds_read_b64_tr_b16 a[54:55], v30 offset:51712
    v_xor_b32 v201, s71, v201
    v_mfma_f32_16x16x32_bf16 v[176:179], a[40:43], v[82:85], v[176:179]
    ds_read_b128 v[70:73], v22 offset:55296
    v_accvgpr_write_b32 a218, v202
    v_mfma_f32_16x16x32_bf16 v[184:187], a[44:47], v[82:85], v[184:187]
    buffer_load_dwordx4 v6, s[36:39], s61 offen offset:2048 lds
    v_mfma_f32_16x16x32_bf16 v[38:41], v[42:45], a[44:47], v[38:41]
    ds_read_b64_tr_b16 a[56:57], v30 offset:57344
    v_xor_b32 v218, s70, v202
    v_mfma_f32_16x16x32_bf16 v[180:183], a[40:43], v[86:89], v[180:183]
    ds_read_b128 v[74:77], v22 offset:57344
    v_xor_b32 v202, s71, v202
    v_mfma_f32_16x16x32_bf16 v[188:191], a[44:47], v[86:89], v[188:191]
    s_waitcnt lgkmcnt(3)
    buffer_load_dwordx4 v7, s[36:39], s61 offen offset:3072 lds
    v_mfma_f32_16x16x32_bf16 v[128:131], a[48:51], v[58:61], v[128:131]
    ds_read_b128 v[78:81], v22 offset:59392
    v_accvgpr_write_b32 a219, v203
    v_mfma_f32_16x16x32_bf16 v[136:139], a[52:55], v[58:61], v[136:139]
    ds_read_b64_tr_b16 a[58:59], v30 offset:57856
    v_xor_b32 v219, s70, v203
    v_mfma_f32_16x16x32_bf16 v[132:135], a[48:51], v[62:65], v[132:135]
    ds_read_b128 v[82:85], v22 offset:61440
    v_xor_b32 v203, s71, v203
    v_mfma_f32_16x16x32_bf16 v[140:143], a[52:55], v[62:65], v[140:143]
    s_waitcnt lgkmcnt(5)
    buffer_load_dword v126, v54, s[40:43], 0 offen
    v_mfma_f32_16x16x32_bf16 v[144:147], a[48:51], v[66:69], v[144:147]
    ds_read_b128 v[86:89], v22 offset:63488
    s_and_b32 s1, s66, 4294966911
    v_mfma_f32_16x16x32_bf16 v[152:155], a[52:55], v[66:69], v[152:155]
    ds_read_b128 v[58:61], v23 offset:49152
    v_accvgpr_write_b32 a220, v204
    v_mfma_f32_16x16x32_bf16 v[34:37], v[42:45], a[48:51], v[34:37]
    buffer_load_dword v126, v31, s[28:31], s1 offen
    v_mfma_f32_16x16x32_bf16 v[148:151], a[48:51], v[70:73], v[148:151]
    ds_read_b128 v[62:65], v23 offset:51200
    s_add_u32 m0, s62, 32768
    v_mfma_f32_16x16x32_bf16 v[156:159], a[52:55], v[70:73], v[156:159]
    s_waitcnt lgkmcnt(2)
    ds_read_b64_tr_b16 a[60:61], v30 offset:59392
    v_mfma_f32_16x16x32_bf16 v[160:163], a[48:51], v[74:77], v[160:163]
    ds_read_b128 v[66:69], v23 offset:53248
    v_xor_b32 v220, s70, v204
    v_mfma_f32_16x16x32_bf16 v[168:171], a[52:55], v[74:77], v[168:171]
    ds_read_b64_tr_b16 a[62:63], v30 offset:59904
    v_xor_b32 v204, s71, v204
    v_mfma_f32_16x16x32_bf16 v[164:167], a[48:51], v[78:81], v[164:167]
    ds_read_b128 v[70:73], v23 offset:55296
    v_accvgpr_write_b32 a221, v205
    v_mfma_f32_16x16x32_bf16 v[172:175], a[52:55], v[78:81], v[172:175]
    ds_read_b128 v[74:77], v23 offset:57344
    v_xor_b32 v221, s70, v205
    v_mfma_f32_16x16x32_bf16 v[176:179], a[48:51], v[82:85], v[176:179]
    ds_read_b128 v[78:81], v23 offset:59392
    v_xor_b32 v205, s71, v205
    v_mfma_f32_16x16x32_bf16 v[184:187], a[52:55], v[82:85], v[184:187]
    buffer_load_dwordx4 v2, s[24:27], s60 offen offset:0 lds
    v_mfma_f32_16x16x32_bf16 v[38:41], v[42:45], a[52:55], v[38:41]
    s_cmp_eq_u32 s59, 4
    s_cselect_b32 s75, -1769472, s7
    s_add_u32 s61, s61, s75
    buffer_load_dwordx4 v3, s[24:27], s60 offen offset:1024 lds
    v_mfma_f32_16x16x32_bf16 v[180:183], a[48:51], v[86:89], v[180:183]
    ds_read_b128 v[82:85], v23 offset:61440
    v_accvgpr_write_b32 a222, v206
    v_mfma_f32_16x16x32_bf16 v[188:191], a[52:55], v[86:89], v[188:191]
    s_waitcnt lgkmcnt(4)
    buffer_load_dwordx4 v4, s[24:27], s60 offen offset:2048 lds
    v_mfma_f32_16x16x32_bf16 v[128:131], a[56:59], v[58:61], v[128:131]
    ds_read_b128 v[86:89], v23 offset:63488
    v_xor_b32 v222, s70, v206
    v_mfma_f32_16x16x32_bf16 v[136:139], a[60:63], v[58:61], v[136:139]
    v_xor_b32 v206, s71, v206
    v_accvgpr_write_b32 a223, v207
    v_mfma_f32_16x16x32_bf16 v[132:135], a[56:59], v[62:65], v[132:135]
    buffer_load_dwordx4 v5, s[24:27], s60 offen offset:3072 lds
    v_mfma_f32_16x16x32_bf16 v[140:143], a[60:63], v[62:65], v[140:143]
    s_add_u32 m0, s63, 32768
    v_xor_b32 v223, s70, v207
    v_xor_b32 v207, s71, v207
    v_mfma_f32_16x16x32_bf16 v[144:147], a[56:59], v[66:69], v[144:147]
    buffer_load_dwordx4 v6, s[32:35], s61 offen offset:0 lds
    v_mfma_f32_16x16x32_bf16 v[152:155], a[60:63], v[66:69], v[152:155]
    s_waitcnt vmcnt(15) lgkmcnt(0)
    s_barrier
    v_mfma_f32_16x16x32_bf16 v[34:37], v[42:45], a[56:59], v[34:37]
    ds_read_b64_tr_b16 a[64:65], v30 offset:0
    s_cmp_eq_u32 s59, 3
    v_mfma_f32_16x16x32_bf16 v[148:151], a[56:59], v[70:73], v[148:151]
    ds_read_b128 v[58:61], v22 offset:0
    s_cselect_b32 s75, -1152, s6
    v_mfma_f32_16x16x32_bf16 v[156:159], a[60:63], v[70:73], v[156:159]
    ds_read_b64_tr_b16 a[66:67], v30 offset:512
    s_add_u32 s60, s60, s75
    v_mfma_f32_16x16x32_bf16 v[160:163], a[56:59], v[74:77], v[160:163]
    ds_read_b128 v[62:65], v22 offset:2048
    v_accvgpr_write_b32 a224, v208
    v_mfma_f32_16x16x32_bf16 v[168:171], a[60:63], v[74:77], v[168:171]
    ds_read_b64_tr_b16 a[68:69], v30 offset:2048
    v_accvgpr_write_b32 a240, v192
    v_mfma_f32_16x16x32_bf16 v[164:167], a[56:59], v[78:81], v[164:167]
    ds_read_b128 v[66:69], v22 offset:4096
    v_accvgpr_write_b32 a225, v209
    v_mfma_f32_16x16x32_bf16 v[172:175], a[60:63], v[78:81], v[172:175]
    ds_read_b64_tr_b16 a[70:71], v30 offset:2560
    v_accvgpr_write_b32 a241, v193
    v_mfma_f32_16x16x32_bf16 v[176:179], a[56:59], v[82:85], v[176:179]
    ds_read_b128 v[70:73], v22 offset:6144
    v_accvgpr_write_b32 a226, v210
    v_mfma_f32_16x16x32_bf16 v[184:187], a[60:63], v[82:85], v[184:187]
    buffer_load_dwordx4 v7, s[32:35], s61 offen offset:1024 lds
    v_mfma_f32_16x16x32_bf16 v[38:41], v[42:45], a[60:63], v[38:41]
    ds_read_b64_tr_b16 a[72:73], v30 offset:8192
    v_accvgpr_write_b32 a242, v194
    v_mfma_f32_16x16x32_bf16 v[180:183], a[56:59], v[86:89], v[180:183]
    ds_read_b128 v[74:77], v22 offset:8192
    v_accvgpr_write_b32 a227, v211
    v_mfma_f32_16x16x32_bf16 v[188:191], a[60:63], v[86:89], v[188:191]
    s_waitcnt lgkmcnt(3)
    buffer_load_dwordx4 v6, s[36:39], s61 offen offset:2048 lds
    v_mfma_f32_16x16x32_bf16 v[128:131], a[64:67], v[58:61], v[128:131]
    ds_read_b128 v[78:81], v22 offset:10240
    v_accvgpr_write_b32 a243, v195
    v_mfma_f32_16x16x32_bf16 v[136:139], a[68:71], v[58:61], v[136:139]
    ds_read_b64_tr_b16 a[74:75], v30 offset:8704
    v_accvgpr_write_b32 a228, v212
    v_mfma_f32_16x16x32_bf16 v[132:135], a[64:67], v[62:65], v[132:135]
    ds_read_b128 v[82:85], v22 offset:12288
    v_accvgpr_write_b32 a244, v196
    v_mfma_f32_16x16x32_bf16 v[140:143], a[68:71], v[62:65], v[140:143]
    s_waitcnt lgkmcnt(5)
    buffer_load_dwordx4 v7, s[36:39], s61 offen offset:3072 lds
    v_mfma_f32_16x16x32_bf16 v[144:147], a[64:67], v[66:69], v[144:147]
    ds_read_b128 v[86:89], v22 offset:14336
    s_add_u32 m0, s62, 49152
    v_mfma_f32_16x16x32_bf16 v[152:155], a[68:71], v[66:69], v[152:155]
    ds_read_b128 v[58:61], v23 offset:0
    v_accvgpr_write_b32 a229, v213
    v_mfma_f32_16x16x32_bf16 v[34:37], v[42:45], a[64:67], v[34:37]
    buffer_load_dwordx4 v2, s[24:27], s60 offen offset:0 lds
    v_mfma_f32_16x16x32_bf16 v[148:151], a[64:67], v[70:73], v[148:151]
    ds_read_b128 v[62:65], v23 offset:2048
    s_cmp_eq_u32 s59, 3
    v_mfma_f32_16x16x32_bf16 v[156:159], a[68:71], v[70:73], v[156:159]
    s_waitcnt lgkmcnt(2)
    ds_read_b64_tr_b16 a[76:77], v30 offset:10240
    v_mfma_f32_16x16x32_bf16 v[160:163], a[64:67], v[74:77], v[160:163]
    ds_read_b128 v[66:69], v23 offset:4096
    s_cselect_b32 s75, -1769472, s7
    v_mfma_f32_16x16x32_bf16 v[168:171], a[68:71], v[74:77], v[168:171]
    ds_read_b64_tr_b16 a[78:79], v30 offset:10752
    s_add_u32 s61, s61, s75
    v_mfma_f32_16x16x32_bf16 v[164:167], a[64:67], v[78:81], v[164:167]
    ds_read_b128 v[70:73], v23 offset:6144
    v_accvgpr_write_b32 a245, v197
    v_mfma_f32_16x16x32_bf16 v[172:175], a[68:71], v[78:81], v[172:175]
    ds_read_b128 v[74:77], v23 offset:8192
    v_accvgpr_write_b32 a230, v214
    v_mfma_f32_16x16x32_bf16 v[176:179], a[64:67], v[82:85], v[176:179]
    ds_read_b128 v[78:81], v23 offset:10240
    v_accvgpr_write_b32 a246, v198
    v_mfma_f32_16x16x32_bf16 v[184:187], a[68:71], v[82:85], v[184:187]
    buffer_load_dwordx4 v3, s[24:27], s60 offen offset:1024 lds
    v_mfma_f32_16x16x32_bf16 v[38:41], v[42:45], a[68:71], v[38:41]
    buffer_load_dwordx4 v4, s[24:27], s60 offen offset:2048 lds
    v_mfma_f32_16x16x32_bf16 v[180:183], a[64:67], v[86:89], v[180:183]
    ds_read_b128 v[82:85], v23 offset:12288
    v_accvgpr_write_b32 a231, v215
    v_mfma_f32_16x16x32_bf16 v[188:191], a[68:71], v[86:89], v[188:191]
    s_waitcnt lgkmcnt(4)
    buffer_load_dwordx4 v5, s[24:27], s60 offen offset:3072 lds
    v_mfma_f32_16x16x32_bf16 v[128:131], a[72:75], v[58:61], v[128:131]
    ds_read_b128 v[86:89], v23 offset:14336
    s_add_u32 m0, s63, 49152
    v_mfma_f32_16x16x32_bf16 v[136:139], a[76:79], v[58:61], v[136:139]
    v_accvgpr_write_b32 a247, v199
    v_accvgpr_write_b32 a232, v216
    v_mfma_f32_16x16x32_bf16 v[132:135], a[72:75], v[62:65], v[132:135]
    buffer_load_dwordx4 v6, s[32:35], s61 offen offset:0 lds
    v_mfma_f32_16x16x32_bf16 v[140:143], a[76:79], v[62:65], v[140:143]
    s_cmp_eq_u32 s59, 2
    s_cselect_b32 s75, -1152, s6
    s_add_u32 s60, s60, s75
    v_mfma_f32_16x16x32_bf16 v[144:147], a[72:75], v[66:69], v[144:147]
    buffer_load_dwordx4 v7, s[32:35], s61 offen offset:1024 lds
    v_mfma_f32_16x16x32_bf16 v[152:155], a[76:79], v[66:69], v[152:155]
    s_waitcnt vmcnt(16) lgkmcnt(0)
    s_barrier
    v_mfma_f32_16x16x32_bf16 v[34:37], v[42:45], a[72:75], v[34:37]
    ds_read_b64_tr_b16 a[80:81], v30 offset:16384
    v_accvgpr_write_b32 a248, v200
    v_mfma_f32_16x16x32_bf16 v[148:151], a[72:75], v[70:73], v[148:151]
    ds_read_b128 v[58:61], v22 offset:16384
    v_accvgpr_write_b32 a233, v217
    v_mfma_f32_16x16x32_bf16 v[156:159], a[76:79], v[70:73], v[156:159]
    ds_read_b64_tr_b16 a[82:83], v30 offset:16896
    v_accvgpr_write_b32 a249, v201
    v_mfma_f32_16x16x32_bf16 v[160:163], a[72:75], v[74:77], v[160:163]
    ds_read_b128 v[62:65], v22 offset:18432
    v_accvgpr_write_b32 a234, v218
    v_mfma_f32_16x16x32_bf16 v[168:171], a[76:79], v[74:77], v[168:171]
    ds_read_b64_tr_b16 a[84:85], v30 offset:18432
    v_accvgpr_write_b32 a250, v202
    v_mfma_f32_16x16x32_bf16 v[164:167], a[72:75], v[78:81], v[164:167]
    ds_read_b128 v[66:69], v22 offset:20480
    v_accvgpr_write_b32 a235, v219
    v_mfma_f32_16x16x32_bf16 v[172:175], a[76:79], v[78:81], v[172:175]
    ds_read_b64_tr_b16 a[86:87], v30 offset:18944
    v_accvgpr_write_b32 a251, v203
    v_mfma_f32_16x16x32_bf16 v[176:179], a[72:75], v[82:85], v[176:179]
    ds_read_b128 v[70:73], v22 offset:22528
    v_accvgpr_write_b32 a236, v220
    v_mfma_f32_16x16x32_bf16 v[184:187], a[76:79], v[82:85], v[184:187]
    buffer_load_dwordx4 v6, s[36:39], s61 offen offset:2048 lds
    v_mfma_f32_16x16x32_bf16 v[38:41], v[42:45], a[76:79], v[38:41]
    ds_read_b64_tr_b16 a[88:89], v30 offset:24576
    v_accvgpr_write_b32 a252, v204
    v_mfma_f32_16x16x32_bf16 v[180:183], a[72:75], v[86:89], v[180:183]
    ds_read_b128 v[74:77], v22 offset:24576
    v_accvgpr_write_b32 a237, v221
    v_mfma_f32_16x16x32_bf16 v[188:191], a[76:79], v[86:89], v[188:191]
    s_waitcnt lgkmcnt(3)
    buffer_load_dwordx4 v7, s[36:39], s61 offen offset:3072 lds
    v_mfma_f32_16x16x32_bf16 v[128:131], a[80:83], v[58:61], v[128:131]
    ds_read_b128 v[78:81], v22 offset:26624
    s_add_u32 m0, s62, 0
    v_mfma_f32_16x16x32_bf16 v[136:139], a[84:87], v[58:61], v[136:139]
    ds_read_b64_tr_b16 a[90:91], v30 offset:25088
    v_accvgpr_write_b32 a253, v205
    v_mfma_f32_16x16x32_bf16 v[132:135], a[80:83], v[62:65], v[132:135]
    ds_read_b128 v[82:85], v22 offset:28672
    v_accvgpr_write_b32 a238, v222
    v_mfma_f32_16x16x32_bf16 v[140:143], a[84:87], v[62:65], v[140:143]
    s_waitcnt lgkmcnt(5)
    buffer_load_dwordx4 v2, s[24:27], s60 offen offset:0 lds
    v_mfma_f32_16x16x32_bf16 v[144:147], a[80:83], v[66:69], v[144:147]
    ds_read_b128 v[86:89], v22 offset:30720
    s_cmp_eq_u32 s59, 2
    v_mfma_f32_16x16x32_bf16 v[152:155], a[84:87], v[66:69], v[152:155]
    ds_read_b128 v[58:61], v23 offset:16384
    s_cselect_b32 s75, -1769472, s7
    v_mfma_f32_16x16x32_bf16 v[34:37], v[42:45], a[80:83], v[34:37]
    s_add_u32 s61, s61, s75
    buffer_load_dwordx4 v3, s[24:27], s60 offen offset:1024 lds
    v_mfma_f32_16x16x32_bf16 v[148:151], a[80:83], v[70:73], v[148:151]
    ds_read_b128 v[62:65], v23 offset:18432
    v_accvgpr_write_b32 a254, v206
    v_mfma_f32_16x16x32_bf16 v[156:159], a[84:87], v[70:73], v[156:159]
ffn_pg1:
    s_cbranch_execz ffn_pg5
    s_waitcnt lgkmcnt(2)
    ds_read_b64_tr_b16 a[92:93], v30 offset:26624
    v_mfma_f32_16x16x32_bf16 v[160:163], a[80:83], v[74:77], v[160:163]
    ds_read_b128 v[66:69], v23 offset:20480
    v_accvgpr_write_b32 a239, v223
    v_mfma_f32_16x16x32_bf16 v[168:171], a[84:87], v[74:77], v[168:171]
    ds_read_b64_tr_b16 a[94:95], v30 offset:27136
    v_accvgpr_write_b32 a255, v207
    v_mfma_f32_16x16x32_bf16 v[164:167], a[80:83], v[78:81], v[164:167]
    ds_read_b128 v[70:73], v23 offset:22528
    v_mov_b32 v47, 0
    v_mfma_f32_16x16x32_bf16 v[172:175], a[84:87], v[78:81], v[172:175]
    ds_read_b128 v[74:77], v23 offset:24576
    v_mov_b32 v51, 0
    v_mfma_f32_16x16x32_bf16 v[176:179], a[80:83], v[82:85], v[176:179]
    ds_read_b128 v[78:81], v23 offset:26624
    v_mov_b32 v55, 0
    v_mfma_f32_16x16x32_bf16 v[184:187], a[84:87], v[82:85], v[184:187]
    buffer_load_dwordx4 v4, s[24:27], s60 offen offset:2048 lds
    v_mfma_f32_16x16x32_bf16 v[38:41], v[42:45], a[84:87], v[38:41]
    v_mov_b32 v48, 0
    v_mov_b32 v52, 0
    v_mfma_f32_16x16x32_bf16 v[180:183], a[80:83], v[86:89], v[180:183]
    ds_read_b128 v[82:85], v23 offset:28672
    v_mov_b32 v56, 0
    v_mfma_f32_16x16x32_bf16 v[188:191], a[84:87], v[86:89], v[188:191]
    s_waitcnt lgkmcnt(4)
    buffer_load_dwordx4 v5, s[24:27], s60 offen offset:3072 lds
    v_mfma_f32_16x16x32_bf16 v[128:131], a[88:91], v[58:61], v[128:131]
    ds_read_b128 v[86:89], v23 offset:30720
    s_add_u32 m0, s63, 0
    v_mfma_f32_16x16x32_bf16 v[136:139], a[92:95], v[58:61], v[136:139]
    v_mov_b32 v49, 0
    v_mov_b32 v53, 0
    v_mfma_f32_16x16x32_bf16 v[132:135], a[88:91], v[62:65], v[132:135]
    buffer_load_dwordx4 v6, s[32:35], s61 offen offset:0 lds
    v_mfma_f32_16x16x32_bf16 v[140:143], a[92:95], v[62:65], v[140:143]
    s_cmp_eq_u32 s59, 1
    s_cselect_b32 s75, -1152, s6
    s_add_u32 s60, s60, s75
    v_mfma_f32_16x16x32_bf16 v[144:147], a[88:91], v[66:69], v[144:147]
    buffer_load_dwordx4 v7, s[32:35], s61 offen offset:1024 lds
    v_mfma_f32_16x16x32_bf16 v[152:155], a[92:95], v[66:69], v[152:155]
    s_waitcnt vmcnt(14) lgkmcnt(0)
    s_barrier
    v_mfma_f32_16x16x32_bf16 v[34:37], v[42:45], a[88:91], v[34:37]
    ds_read_b64_tr_b16 a[96:97], v30 offset:32768
    v_mov_b32 v57, 0
    v_mfma_f32_16x16x32_bf16 v[148:151], a[88:91], v[70:73], v[148:151]
    ds_read_b128 v[58:61], v22 offset:32768
    v_mfma_f32_16x16x32_bf16 v[156:159], a[92:95], v[70:73], v[156:159]
    ds_read_b64_tr_b16 a[98:99], v30 offset:33280
    v_mfma_f32_16x16x32_bf16 v[160:163], a[88:91], v[74:77], v[160:163]
    ds_read_b128 v[62:65], v22 offset:34816
    v_mfma_f32_16x16x32_bf16 v[168:171], a[92:95], v[74:77], v[168:171]
    ds_read_b64_tr_b16 a[100:101], v30 offset:34816
    v_mfma_f32_16x16x32_bf16 v[164:167], a[88:91], v[78:81], v[164:167]
    ds_read_b128 v[66:69], v22 offset:36864
    v_mfma_f32_16x16x32_bf16 v[172:175], a[92:95], v[78:81], v[172:175]
    ds_read_b64_tr_b16 a[102:103], v30 offset:35328
    v_mfma_f32_16x16x32_bf16 v[176:179], a[88:91], v[82:85], v[176:179]
    ds_read_b128 v[70:73], v22 offset:38912
    v_mfma_f32_16x16x32_bf16 v[184:187], a[92:95], v[82:85], v[184:187]
    buffer_load_dwordx4 v6, s[36:39], s61 offen offset:2048 lds
    v_mfma_f32_16x16x32_bf16 v[38:41], v[42:45], a[92:95], v[38:41]
    ds_read_b64_tr_b16 a[104:105], v30 offset:40960
    v_mfma_f32_16x16x32_bf16 v[180:183], a[88:91], v[86:89], v[180:183]
    ds_read_b128 v[74:77], v22 offset:40960
    v_mfma_f32_16x16x32_bf16 v[188:191], a[92:95], v[86:89], v[188:191]
    s_waitcnt lgkmcnt(3)
    buffer_load_dwordx4 v7, s[36:39], s61 offen offset:3072 lds
    v_mfma_f32_16x16x32_bf16 v[128:131], a[96:99], v[58:61], v[128:131]
    ds_read_b128 v[78:81], v22 offset:43008
    s_add_u32 m0, s62, 16384
    v_mfma_f32_16x16x32_bf16 v[136:139], a[100:103], v[58:61], v[136:139]
    ds_read_b64_tr_b16 a[106:107], v30 offset:41472
    v_mfma_f32_16x16x32_bf16 v[132:135], a[96:99], v[62:65], v[132:135]
    ds_read_b128 v[82:85], v22 offset:45056
    v_mfma_f32_16x16x32_bf16 v[140:143], a[100:103], v[62:65], v[140:143]
    s_waitcnt lgkmcnt(5)
    buffer_load_dwordx4 v2, s[24:27], s60 offen offset:0 lds
    v_mfma_f32_16x16x32_bf16 v[144:147], a[96:99], v[66:69], v[144:147]
    ds_read_b128 v[86:89], v22 offset:47104
    s_cmp_eq_u32 s59, 1
    v_mfma_f32_16x16x32_bf16 v[152:155], a[100:103], v[66:69], v[152:155]
    ds_read_b128 v[58:61], v23 offset:32768
    s_cselect_b32 s75, -1769472, s7
    v_mfma_f32_16x16x32_bf16 v[34:37], v[42:45], a[96:99], v[34:37]
    s_add_u32 s61, s61, s75
    buffer_load_dwordx4 v3, s[24:27], s60 offen offset:1024 lds
    v_mfma_f32_16x16x32_bf16 v[148:151], a[96:99], v[70:73], v[148:151]
    ds_read_b128 v[62:65], v23 offset:34816
    v_mfma_f32_16x16x32_bf16 v[156:159], a[100:103], v[70:73], v[156:159]
    s_waitcnt lgkmcnt(2)
    ds_read_b64_tr_b16 a[108:109], v30 offset:43008
    v_mfma_f32_16x16x32_bf16 v[160:163], a[96:99], v[74:77], v[160:163]
    ds_read_b128 v[66:69], v23 offset:36864
    v_mfma_f32_16x16x32_bf16 v[168:171], a[100:103], v[74:77], v[168:171]
    ds_read_b64_tr_b16 a[110:111], v30 offset:43520
    v_mfma_f32_16x16x32_bf16 v[164:167], a[96:99], v[78:81], v[164:167]
    ds_read_b128 v[70:73], v23 offset:38912
    v_mfma_f32_16x16x32_bf16 v[172:175], a[100:103], v[78:81], v[172:175]
    ds_read_b128 v[74:77], v23 offset:40960
    v_mfma_f32_16x16x32_bf16 v[176:179], a[96:99], v[82:85], v[176:179]
    ds_read_b128 v[78:81], v23 offset:43008
    v_mfma_f32_16x16x32_bf16 v[184:187], a[100:103], v[82:85], v[184:187]
    buffer_load_dwordx4 v4, s[24:27], s60 offen offset:2048 lds
    v_mfma_f32_16x16x32_bf16 v[38:41], v[42:45], a[100:103], v[38:41]
    v_mfma_f32_16x16x32_bf16 v[180:183], a[96:99], v[86:89], v[180:183]
    ds_read_b128 v[82:85], v23 offset:45056
    v_mfma_f32_16x16x32_bf16 v[188:191], a[100:103], v[86:89], v[188:191]
    s_waitcnt lgkmcnt(4)
    buffer_load_dwordx4 v5, s[24:27], s60 offen offset:3072 lds
    v_mfma_f32_16x16x32_bf16 v[128:131], a[104:107], v[58:61], v[128:131]
    ds_read_b128 v[86:89], v23 offset:47104
    s_add_u32 m0, s63, 16384
    v_mfma_f32_16x16x32_bf16 v[136:139], a[108:111], v[58:61], v[136:139]
    v_mfma_f32_16x16x32_bf16 v[132:135], a[104:107], v[62:65], v[132:135]
    buffer_load_dwordx4 v6, s[32:35], s61 offen offset:0 lds
    v_mfma_f32_16x16x32_bf16 v[140:143], a[108:111], v[62:65], v[140:143]
    s_add_u32 s60, s76, s84
    v_mfma_f32_16x16x32_bf16 v[144:147], a[104:107], v[66:69], v[144:147]
    buffer_load_dwordx4 v7, s[32:35], s61 offen offset:1024 lds
    v_mfma_f32_16x16x32_bf16 v[152:155], a[108:111], v[66:69], v[152:155]
    s_waitcnt vmcnt(14) lgkmcnt(0)
    s_barrier
    v_mfma_f32_16x16x32_bf16 v[34:37], v[42:45], a[104:107], v[34:37]
    ds_read_b64_tr_b16 a[112:113], v30 offset:49152
    v_mfma_f32_16x16x32_bf16 v[148:151], a[104:107], v[70:73], v[148:151]
    ds_read_b128 v[58:61], v22 offset:49152
    v_mfma_f32_16x16x32_bf16 v[156:159], a[108:111], v[70:73], v[156:159]
    ds_read_b64_tr_b16 a[114:115], v30 offset:49664
    v_mfma_f32_16x16x32_bf16 v[160:163], a[104:107], v[74:77], v[160:163]
    ds_read_b128 v[62:65], v22 offset:51200
    v_mfma_f32_16x16x32_bf16 v[168:171], a[108:111], v[74:77], v[168:171]
    ds_read_b64_tr_b16 a[116:117], v30 offset:51200
    v_mfma_f32_16x16x32_bf16 v[164:167], a[104:107], v[78:81], v[164:167]
    ds_read_b128 v[66:69], v22 offset:53248
    v_mfma_f32_16x16x32_bf16 v[172:175], a[108:111], v[78:81], v[172:175]
    ds_read_b64_tr_b16 a[118:119], v30 offset:51712
    v_mfma_f32_16x16x32_bf16 v[176:179], a[104:107], v[82:85], v[176:179]
    ds_read_b128 v[70:73], v22 offset:55296
    v_mfma_f32_16x16x32_bf16 v[184:187], a[108:111], v[82:85], v[184:187]
    buffer_load_dwordx4 v6, s[36:39], s61 offen offset:2048 lds
    v_mfma_f32_16x16x32_bf16 v[38:41], v[42:45], a[108:111], v[38:41]
    ds_read_b64_tr_b16 a[120:121], v30 offset:57344
    v_mfma_f32_16x16x32_bf16 v[180:183], a[104:107], v[86:89], v[180:183]
    ds_read_b128 v[74:77], v22 offset:57344
    v_mfma_f32_16x16x32_bf16 v[188:191], a[108:111], v[86:89], v[188:191]
    s_waitcnt lgkmcnt(3)
    buffer_load_dwordx4 v7, s[36:39], s61 offen offset:3072 lds
    v_mfma_f32_16x16x32_bf16 v[128:131], a[112:115], v[58:61], v[128:131]
    ds_read_b128 v[78:81], v22 offset:59392
    s_add_u32 m0, s62, 32768
    v_mfma_f32_16x16x32_bf16 v[136:139], a[116:119], v[58:61], v[136:139]
    ds_read_b64_tr_b16 a[122:123], v30 offset:57856
    v_mfma_f32_16x16x32_bf16 v[132:135], a[112:115], v[62:65], v[132:135]
    ds_read_b128 v[82:85], v22 offset:61440
    v_mfma_f32_16x16x32_bf16 v[140:143], a[116:119], v[62:65], v[140:143]
    s_waitcnt lgkmcnt(5)
    buffer_load_dwordx4 v2, s[24:27], s60 offen offset:0 lds
    v_mfma_f32_16x16x32_bf16 v[144:147], a[112:115], v[66:69], v[144:147]
    ds_read_b128 v[86:89], v22 offset:63488
    v_mfma_f32_16x16x32_bf16 v[152:155], a[116:119], v[66:69], v[152:155]
    ds_read_b128 v[58:61], v23 offset:49152
    v_mfma_f32_16x16x32_bf16 v[34:37], v[42:45], a[112:115], v[34:37]
    buffer_load_dwordx4 v3, s[24:27], s60 offen offset:1024 lds
    v_mfma_f32_16x16x32_bf16 v[148:151], a[112:115], v[70:73], v[148:151]
    ds_read_b128 v[62:65], v23 offset:51200
    v_mfma_f32_16x16x32_bf16 v[156:159], a[116:119], v[70:73], v[156:159]
    s_waitcnt lgkmcnt(2)
    ds_read_b64_tr_b16 a[124:125], v30 offset:59392
    v_mfma_f32_16x16x32_bf16 v[160:163], a[112:115], v[74:77], v[160:163]
    ds_read_b128 v[66:69], v23 offset:53248
    v_mfma_f32_16x16x32_bf16 v[168:171], a[116:119], v[74:77], v[168:171]
    ds_read_b64_tr_b16 a[126:127], v30 offset:59904
    v_mfma_f32_16x16x32_bf16 v[164:167], a[112:115], v[78:81], v[164:167]
    ds_read_b128 v[70:73], v23 offset:55296
    v_mfma_f32_16x16x32_bf16 v[172:175], a[116:119], v[78:81], v[172:175]
    ds_read_b128 v[74:77], v23 offset:57344
    v_mfma_f32_16x16x32_bf16 v[176:179], a[112:115], v[82:85], v[176:179]
    ds_read_b128 v[78:81], v23 offset:59392
    v_mfma_f32_16x16x32_bf16 v[184:187], a[116:119], v[82:85], v[184:187]
    buffer_load_dwordx4 v4, s[24:27], s60 offen offset:2048 lds
    v_mfma_f32_16x16x32_bf16 v[38:41], v[42:45], a[116:119], v[38:41]
    v_mfma_f32_16x16x32_bf16 v[180:183], a[112:115], v[86:89], v[180:183]
    ds_read_b128 v[82:85], v23 offset:61440
    v_mfma_f32_16x16x32_bf16 v[188:191], a[116:119], v[86:89], v[188:191]
    s_waitcnt lgkmcnt(4)
    buffer_load_dwordx4 v5, s[24:27], s60 offen offset:3072 lds
    v_mfma_f32_16x16x32_bf16 v[128:131], a[120:123], v[58:61], v[128:131]
    ds_read_b128 v[86:89], v23 offset:63488
    s_add_u32 s60, s76, s85
    v_mfma_f32_16x16x32_bf16 v[136:139], a[124:127], v[58:61], v[136:139]
    v_mfma_f32_16x16x32_bf16 v[132:135], a[120:123], v[62:65], v[132:135]
    buffer_load_dwordx4 v[90:93], v31, s[28:31], s78 offen offset:0 sc1
    v_mfma_f32_16x16x32_bf16 v[140:143], a[124:127], v[62:65], v[140:143]
    v_mfma_f32_16x16x32_bf16 v[144:147], a[120:123], v[66:69], v[144:147]
    buffer_load_dwordx4 v[94:97], v31, s[28:31], s78 offen offset:512 sc1
    v_mfma_f32_16x16x32_bf16 v[152:155], a[124:127], v[66:69], v[152:155]
    s_waitcnt vmcnt(14) lgkmcnt(0)
    s_barrier
    v_mfma_f32_16x16x32_bf16 v[34:37], v[42:45], a[120:123], v[34:37]
    ds_read_b64_tr_b16 a[128:129], v30 offset:0
    v_mfma_f32_16x16x32_bf16 v[148:151], a[120:123], v[70:73], v[148:151]
    ds_read_b128 v[58:61], v22 offset:0
    v_mfma_f32_16x16x32_bf16 v[156:159], a[124:127], v[70:73], v[156:159]
    ds_read_b64_tr_b16 a[130:131], v30 offset:512
    v_mfma_f32_16x16x32_bf16 v[160:163], a[120:123], v[74:77], v[160:163]
    ds_read_b128 v[62:65], v22 offset:2048
    v_mfma_f32_16x16x32_bf16 v[168:171], a[124:127], v[74:77], v[168:171]
    ds_read_b64_tr_b16 a[132:133], v30 offset:2048
    v_mfma_f32_16x16x32_bf16 v[164:167], a[120:123], v[78:81], v[164:167]
    ds_read_b128 v[66:69], v22 offset:4096
    v_mfma_f32_16x16x32_bf16 v[172:175], a[124:127], v[78:81], v[172:175]
    ds_read_b64_tr_b16 a[134:135], v30 offset:2560
    v_mfma_f32_16x16x32_bf16 v[176:179], a[120:123], v[82:85], v[176:179]
    ds_read_b128 v[70:73], v22 offset:6144
    v_mfma_f32_16x16x32_bf16 v[184:187], a[124:127], v[82:85], v[184:187]
    buffer_load_dwordx4 v[98:101], v31, s[28:31], s79 offen offset:0 sc1
    v_mfma_f32_16x16x32_bf16 v[38:41], v[42:45], a[124:127], v[38:41]
    ds_read_b64_tr_b16 a[136:137], v30 offset:8192
    v_mfma_f32_16x16x32_bf16 v[180:183], a[120:123], v[86:89], v[180:183]
    ds_read_b128 v[74:77], v22 offset:8192
    v_mfma_f32_16x16x32_bf16 v[188:191], a[124:127], v[86:89], v[188:191]
    s_waitcnt lgkmcnt(3)
    buffer_load_dwordx4 v[102:105], v31, s[28:31], s79 offen offset:512 sc1
    v_mfma_f32_16x16x32_bf16 v[128:131], a[128:131], v[58:61], v[128:131]
    ds_read_b128 v[78:81], v22 offset:10240
    s_add_u32 m0, s62, 49152
    v_mfma_f32_16x16x32_bf16 v[136:139], a[132:135], v[58:61], v[136:139]
    ds_read_b64_tr_b16 a[138:139], v30 offset:8704
    v_mfma_f32_16x16x32_bf16 v[132:135], a[128:131], v[62:65], v[132:135]
    ds_read_b128 v[82:85], v22 offset:12288
    v_mfma_f32_16x16x32_bf16 v[140:143], a[132:135], v[62:65], v[140:143]
    s_waitcnt lgkmcnt(5)
    buffer_load_dwordx4 v2, s[24:27], s60 offen offset:0 lds
    v_mfma_f32_16x16x32_bf16 v[144:147], a[128:131], v[66:69], v[144:147]
    ds_read_b128 v[86:89], v22 offset:14336
    s_add_u32 s74, s20, s5
    v_mfma_f32_16x16x32_bf16 v[152:155], a[132:135], v[66:69], v[152:155]
    ds_read_b128 v[58:61], v23 offset:0
    v_mfma_f32_16x16x32_bf16 v[34:37], v[42:45], a[128:131], v[34:37]
    buffer_load_dwordx4 v3, s[24:27], s60 offen offset:1024 lds
    v_mfma_f32_16x16x32_bf16 v[148:151], a[128:131], v[70:73], v[148:151]
    ds_read_b128 v[62:65], v23 offset:2048
    v_mfma_f32_16x16x32_bf16 v[156:159], a[132:135], v[70:73], v[156:159]
    s_waitcnt lgkmcnt(2)
    ds_read_b64_tr_b16 a[140:141], v30 offset:10240
    v_mfma_f32_16x16x32_bf16 v[160:163], a[128:131], v[74:77], v[160:163]
    ds_read_b128 v[66:69], v23 offset:4096
    v_mfma_f32_16x16x32_bf16 v[168:171], a[132:135], v[74:77], v[168:171]
    ds_read_b64_tr_b16 a[142:143], v30 offset:10752
    v_mfma_f32_16x16x32_bf16 v[164:167], a[128:131], v[78:81], v[164:167]
    ds_read_b128 v[70:73], v23 offset:6144
    v_mfma_f32_16x16x32_bf16 v[172:175], a[132:135], v[78:81], v[172:175]
    ds_read_b128 v[74:77], v23 offset:8192
    v_mfma_f32_16x16x32_bf16 v[176:179], a[128:131], v[82:85], v[176:179]
    ds_read_b128 v[78:81], v23 offset:10240
    v_mfma_f32_16x16x32_bf16 v[184:187], a[132:135], v[82:85], v[184:187]
    buffer_load_dwordx4 v4, s[24:27], s60 offen offset:2048 lds
    v_mfma_f32_16x16x32_bf16 v[38:41], v[42:45], a[132:135], v[38:41]
    v_mfma_f32_16x16x32_bf16 v[180:183], a[128:131], v[86:89], v[180:183]
    ds_read_b128 v[82:85], v23 offset:12288
    v_mfma_f32_16x16x32_bf16 v[188:191], a[132:135], v[86:89], v[188:191]
    s_waitcnt lgkmcnt(4)
    buffer_load_dwordx4 v5, s[24:27], s60 offen offset:3072 lds
    v_mfma_f32_16x16x32_bf16 v[128:131], a[136:139], v[58:61], v[128:131]
    ds_read_b128 v[86:89], v23 offset:14336
    s_add_u32 m0, s64, 131072
    v_mfma_f32_16x16x32_bf16 v[136:139], a[140:143], v[58:61], v[136:139]
    v_mfma_f32_16x16x32_bf16 v[132:135], a[136:139], v[62:65], v[132:135]
    buffer_load_dwordx4 v12, s[40:43], s74 offen offset:0 lds
    v_mfma_f32_16x16x32_bf16 v[140:143], a[140:143], v[62:65], v[140:143]
    s_add_u32 s60, s76, s86
    v_mfma_f32_16x16x32_bf16 v[144:147], a[136:139], v[66:69], v[144:147]
    buffer_load_dwordx4 v13, s[40:43], s74 offen offset:1024 lds
    v_mfma_f32_16x16x32_bf16 v[152:155], a[140:143], v[66:69], v[152:155]
    s_waitcnt vmcnt(14) lgkmcnt(0)
    s_barrier
    v_mfma_f32_16x16x32_bf16 v[34:37], v[42:45], a[136:139], v[34:37]
    ds_read_b64_tr_b16 a[144:145], v30 offset:16384
    s_add_u32 m0, s62, 0
    v_mfma_f32_16x16x32_bf16 v[148:151], a[136:139], v[70:73], v[148:151]
    ds_read_b128 v[58:61], v22 offset:16384
    v_mfma_f32_16x16x32_bf16 v[156:159], a[140:143], v[70:73], v[156:159]
    ds_read_b64_tr_b16 a[146:147], v30 offset:16896
    v_mfma_f32_16x16x32_bf16 v[160:163], a[136:139], v[74:77], v[160:163]
    ds_read_b128 v[62:65], v22 offset:18432
    v_mfma_f32_16x16x32_bf16 v[168:171], a[140:143], v[74:77], v[168:171]
    ds_read_b64_tr_b16 a[148:149], v30 offset:18432
    v_mfma_f32_16x16x32_bf16 v[164:167], a[136:139], v[78:81], v[164:167]
    ds_read_b128 v[66:69], v22 offset:20480
    v_mfma_f32_16x16x32_bf16 v[172:175], a[140:143], v[78:81], v[172:175]
    ds_read_b64_tr_b16 a[150:151], v30 offset:18944
    v_mfma_f32_16x16x32_bf16 v[176:179], a[136:139], v[82:85], v[176:179]
    ds_read_b128 v[70:73], v22 offset:22528
    v_mfma_f32_16x16x32_bf16 v[184:187], a[140:143], v[82:85], v[184:187]
    buffer_load_dwordx4 v2, s[24:27], s60 offen offset:0 lds
    v_mfma_f32_16x16x32_bf16 v[38:41], v[42:45], a[140:143], v[38:41]
    ds_read_b64_tr_b16 a[152:153], v30 offset:24576
    s_add_u32 s74, s21, s5
    v_mfma_f32_16x16x32_bf16 v[180:183], a[136:139], v[86:89], v[180:183]
    ds_read_b128 v[74:77], v22 offset:24576
    v_mfma_f32_16x16x32_bf16 v[188:191], a[140:143], v[86:89], v[188:191]
    s_waitcnt lgkmcnt(3)
    buffer_load_dwordx4 v3, s[24:27], s60 offen offset:1024 lds
    v_mfma_f32_16x16x32_bf16 v[128:131], a[144:147], v[58:61], v[128:131]
    ds_read_b128 v[78:81], v22 offset:26624
    s_add_u32 s1, s22, s5
    v_mfma_f32_16x16x32_bf16 v[136:139], a[148:151], v[58:61], v[136:139]
    ds_read_b64_tr_b16 a[154:155], v30 offset:25088
    v_mfma_f32_16x16x32_bf16 v[132:135], a[144:147], v[62:65], v[132:135]
    ds_read_b128 v[82:85], v22 offset:28672
    v_mfma_f32_16x16x32_bf16 v[140:143], a[148:151], v[62:65], v[140:143]
    s_waitcnt lgkmcnt(5)
    buffer_load_dwordx4 v4, s[24:27], s60 offen offset:2048 lds
    v_mfma_f32_16x16x32_bf16 v[144:147], a[144:147], v[66:69], v[144:147]
    ds_read_b128 v[86:89], v22 offset:30720
    v_mfma_f32_16x16x32_bf16 v[152:155], a[148:151], v[66:69], v[152:155]
    ds_read_b128 v[58:61], v23 offset:16384
    v_mfma_f32_16x16x32_bf16 v[34:37], v[42:45], a[144:147], v[34:37]
    buffer_load_dwordx4 v5, s[24:27], s60 offen offset:3072 lds
    v_mfma_f32_16x16x32_bf16 v[148:151], a[144:147], v[70:73], v[148:151]
    ds_read_b128 v[62:65], v23 offset:18432
    s_add_u32 m0, s64, 139264
    v_mfma_f32_16x16x32_bf16 v[156:159], a[148:151], v[70:73], v[156:159]
    s_waitcnt lgkmcnt(2)
    ds_read_b64_tr_b16 a[156:157], v30 offset:26624
    v_mfma_f32_16x16x32_bf16 v[160:163], a[144:147], v[74:77], v[160:163]
    ds_read_b128 v[66:69], v23 offset:20480
    v_mfma_f32_16x16x32_bf16 v[168:171], a[148:151], v[74:77], v[168:171]
    ds_read_b64_tr_b16 a[158:159], v30 offset:27136
    v_mfma_f32_16x16x32_bf16 v[164:167], a[144:147], v[78:81], v[164:167]
    ds_read_b128 v[70:73], v23 offset:22528
    v_mfma_f32_16x16x32_bf16 v[172:175], a[148:151], v[78:81], v[172:175]
    ds_read_b128 v[74:77], v23 offset:24576
    v_mfma_f32_16x16x32_bf16 v[176:179], a[144:147], v[82:85], v[176:179]
    ds_read_b128 v[78:81], v23 offset:26624
    v_mfma_f32_16x16x32_bf16 v[184:187], a[148:151], v[82:85], v[184:187]
    buffer_load_dwordx4 v12, s[40:43], s74 offen offset:0 lds
    v_mfma_f32_16x16x32_bf16 v[38:41], v[42:45], a[148:151], v[38:41]
    s_add_u32 s60, s76, s87
    v_mfma_f32_16x16x32_bf16 v[180:183], a[144:147], v[86:89], v[180:183]
    ds_read_b128 v[82:85], v23 offset:28672
    v_mfma_f32_16x16x32_bf16 v[188:191], a[148:151], v[86:89], v[188:191]
    s_waitcnt lgkmcnt(4)
    buffer_load_dwordx4 v13, s[40:43], s74 offen offset:1024 lds
    v_mfma_f32_16x16x32_bf16 v[128:131], a[152:155], v[58:61], v[128:131]
    ds_read_b128 v[86:89], v23 offset:30720
    s_add_u32 m0, s64, 147456
    v_mfma_f32_16x16x32_bf16 v[136:139], a[156:159], v[58:61], v[136:139]
    s_waitcnt vmcnt(12)
    v_xor_b32 v105, s54, v105
    v_bitop3_b32 v105, v93, s54, v105 bitop3:0xbe
    v_bitop3_b32 v105, v97, s54, v105 bitop3:0xbe
    v_bitop3_b32 v105, v101, s54, v105 bitop3:0xbe
    v_cmp_ne_u32 vcc, 0, v105
    s_nop 0
    s_cbranch_vccnz slow_3
back_4:
    v_mfma_f32_16x16x32_bf16 v[132:135], a[152:155], v[62:65], v[132:135]
    buffer_load_dwordx4 v12, s[40:43], s1 offen offset:0 lds
    v_mfma_f32_16x16x32_bf16 v[140:143], a[156:159], v[62:65], v[140:143]
    s_xor_b32 s78, s78, 2048
    s_xor_b32 s79, s79, 2048
    v_cndmask_b32 v54, 0, v90, s[50:51]
    v_mfma_f32_16x16x32_bf16 v[144:147], a[152:155], v[66:69], v[144:147]
    v_mov_b32 v93, v91
    v_mfma_f32_16x16x32_bf16 v[152:155], a[156:159], v[66:69], v[152:155]
    s_waitcnt lgkmcnt(0)
    s_barrier
    v_mfma_f32_16x16x32_bf16 v[34:37], v[42:45], a[152:155], v[34:37]
    v_mfma_f32_16x16x32_bf16 v[148:151], a[152:155], v[70:73], v[148:151]
    ds_read_b128 v[58:61], v22 offset:32768
    v_mfma_f32_16x16x32_bf16 v[156:159], a[156:159], v[70:73], v[156:159]
    buffer_load_dwordx4 v13, s[40:43], s1 offen offset:1024 lds
    v_mfma_f32_16x16x32_bf16 v[160:163], a[152:155], v[74:77], v[160:163]
    ds_read_b128 v[62:65], v22 offset:34816
    s_add_u32 m0, s62, 16384
    v_mfma_f32_16x16x32_bf16 v[168:171], a[156:159], v[74:77], v[168:171]
    v_mfma_f32_16x16x32_bf16 v[164:167], a[152:155], v[78:81], v[164:167]
    ds_read_b128 v[66:69], v22 offset:36864
    v_mfma_f32_16x16x32_bf16 v[172:175], a[156:159], v[78:81], v[172:175]
    buffer_load_dwordx4 v2, s[24:27], s60 offen offset:0 lds
    v_mfma_f32_16x16x32_bf16 v[176:179], a[152:155], v[82:85], v[176:179]
    ds_read_b128 v[70:73], v22 offset:38912
    s_add_u32 s74, s23, s5
    v_mfma_f32_16x16x32_bf16 v[184:187], a[156:159], v[82:85], v[184:187]
    v_mfma_f32_16x16x32_bf16 v[38:41], v[42:45], a[156:159], v[38:41]
    v_mfma_f32_16x16x32_bf16 v[180:183], a[152:155], v[86:89], v[180:183]
    ds_read_b128 v[74:77], v23 offset:32768
    v_mfma_f32_16x16x32_bf16 v[188:191], a[156:159], v[86:89], v[188:191]
    s_waitcnt lgkmcnt(3)
    v_mfma_f32_16x16x32_bf16 v[192:195], a[0:3], v[58:61], 0
    ds_read_b128 v[78:81], v23 offset:34816
    v_cvt_pk_bf16_f32 v46, 0, v34
    s_nop 0
    v_cvt_pk_bf16_f32 v50, 0, v38
    v_mfma_f32_16x16x32_bf16 v[200:203], a[4:7], v[58:61], 0
    buffer_load_dwordx4 v3, s[24:27], s60 offen offset:1024 lds
    v_mfma_f32_16x16x32_bf16 v[196:199], a[0:3], v[62:65], 0
    ds_read_b128 v[82:85], v23 offset:36864
    v_sub_f32 v8, v34, v46
    v_sub_f32 v9, v38, v50
    v_mfma_f32_16x16x32_bf16 v[204:207], a[4:7], v[62:65], 0
    s_waitcnt lgkmcnt(3)
    v_cvt_pk_bf16_f32 v46, v34, v8
    v_cvt_pk_bf16_f32 v50, v38, v9
    v_mfma_f32_16x16x32_bf16 v[208:211], a[0:3], v[66:69], 0
    ds_read_b128 v[86:89], v23 offset:38912
    v_mfma_f32_16x16x32_bf16 v[128:131], v[46:49], v[54:57], v[128:131]
    v_mfma_f32_16x16x32_bf16 v[136:139], v[50:53], v[54:57], v[136:139]
    v_cndmask_b32 v54, 0, v90, s[52:53]
    v_mov_b32 v90, v92
    v_mfma_f32_16x16x32_bf16 v[216:219], a[4:7], v[66:69], 0
    ds_read_b128 v[58:61], v22 offset:40960
    v_mfma_f32_16x16x32_bf16 v[132:135], v[46:49], v[54:57], v[132:135]
    v_permlane16_swap_b32 v91, v93
    v_permlane16_swap_b32 v90, v92
    v_mfma_f32_16x16x32_bf16 v[140:143], v[50:53], v[54:57], v[140:143]
    buffer_load_dwordx4 v[34:37], v31, s[28:31], s78 offen offset:0 sc1
    v_mfma_f32_16x16x32_bf16 v[212:215], a[0:3], v[70:73], 0
    ds_read_b128 v[62:65], v22 offset:43008
    buffer_load_dwordx4 v[38:41], v31, s[28:31], s78 offen offset:512 sc1
    v_mfma_f32_16x16x32_bf16 v[220:223], a[4:7], v[70:73], 0
    s_waitcnt lgkmcnt(2)
    buffer_load_dwordx4 v4, s[24:27], s60 offen offset:2048 lds
    v_mfma_f32_16x16x32_bf16 v[192:195], a[8:11], v[74:77], v[192:195]
    ds_read_b128 v[66:69], v22 offset:45056
    v_mul_f32 v106, v128, v91
    v_mul_f32 v107, v129, v91
    v_mfma_f32_16x16x32_bf16 v[200:203], a[12:15], v[74:77], v[200:203]
    v_exp_f32 v106, v106
    v_mfma_f32_16x16x32_bf16 v[196:199], a[8:11], v[78:81], v[196:199]
    ds_read_b128 v[70:73], v22 offset:47104
    v_exp_f32 v107, v107
    v_mfma_f32_16x16x32_bf16 v[204:207], a[12:15], v[78:81], v[204:207]
    ds_read_b128 v[74:77], v23 offset:40960
    v_mul_f32 v108, v130, v91
    v_mfma_f32_16x16x32_bf16 v[208:211], a[8:11], v[82:85], v[208:211]
    ds_read_b128 v[78:81], v23 offset:43008
    v_cndmask_b32 v54, 0, v94, s[50:51]
    v_mov_b32 v97, v95
    v_mfma_f32_16x16x32_bf16 v[216:219], a[12:15], v[82:85], v[216:219]
    buffer_load_dwordx4 v5, s[24:27], s60 offen offset:3072 lds
    v_mfma_f32_16x16x32_bf16 v[212:215], a[8:11], v[86:89], v[212:215]
    ds_read_b128 v[82:85], v23 offset:45056
    v_exp_f32 v108, v108
    v_mfma_f32_16x16x32_bf16 v[220:223], a[12:15], v[86:89], v[220:223]
    s_waitcnt lgkmcnt(4)
    v_mul_f32 v136, v128, v136
    v_mul_f32 v109, v131, v91
    v_mfma_f32_16x16x32_bf16 v[144:147], v[46:49], v[54:57], v[144:147]
    s_add_u32 m0, s64, 155648
    v_mul_f32 v137, v129, v137
    v_mul_f32 v110, v132, v93
    v_mfma_f32_16x16x32_bf16 v[152:155], v[50:53], v[54:57], v[152:155]
    v_exp_f32 v109, v109
    v_mfma_f32_16x16x32_bf16 v[192:195], a[16:19], v[58:61], v[192:195]
    ds_read_b128 v[86:89], v23 offset:47104
    v_cndmask_b32 v54, 0, v94, s[52:53]
    v_mov_b32 v94, v96
    v_mfma_f32_16x16x32_bf16 v[200:203], a[20:23], v[58:61], v[200:203]
    buffer_load_dwordx4 v12, s[40:43], s74 offen offset:0 lds
    v_mfma_f32_16x16x32_bf16 v[196:199], a[16:19], v[62:65], v[196:199]
    s_add_u32 s60, s76, s88
    v_mul_f32 v138, v130, v138
    v_exp_f32 v110, v110
    v_mfma_f32_16x16x32_bf16 v[204:207], a[20:23], v[62:65], v[204:207]
    v_mul_f32 v111, v133, v93
    v_mfma_f32_16x16x32_bf16 v[148:151], v[46:49], v[54:57], v[148:151]
    v_permlane16_swap_b32 v95, v97
    v_permlane16_swap_b32 v94, v96
    v_mfma_f32_16x16x32_bf16 v[208:211], a[16:19], v[66:69], v[208:211]
    v_exp_f32 v111, v111
    v_mul_f32 v139, v131, v139
    v_mfma_f32_16x16x32_bf16 v[216:219], a[20:23], v[66:69], v[216:219]
    s_waitcnt vmcnt(17) lgkmcnt(0)
    s_barrier
    v_mfma_f32_16x16x32_bf16 v[212:215], a[16:19], v[70:73], v[212:215]
    ds_read_b128 v[58:61], v22 offset:49152
    v_mul_f32 v112, v134, v93
    v_mfma_f32_16x16x32_bf16 v[156:159], v[50:53], v[54:57], v[156:159]
    v_exp_f32 v112, v112
    v_mul_f32 v140, v132, v140
    v_mfma_f32_16x16x32_bf16 v[220:223], a[20:23], v[70:73], v[220:223]
    buffer_load_dwordx4 v13, s[40:43], s74 offen offset:1024 lds
    v_mfma_f32_16x16x32_bf16 v[192:195], a[24:27], v[74:77], v[192:195]
    ds_read_b128 v[62:65], v22 offset:51200
    v_mul_f32 v113, v135, v93
    v_mul_f32 v141, v133, v141
    v_mfma_f32_16x16x32_bf16 v[200:203], a[28:31], v[74:77], v[200:203]
    s_add_u32 m0, s62, 32768
    v_exp_f32 v113, v113
    v_mfma_f32_16x16x32_bf16 v[196:199], a[24:27], v[78:81], v[196:199]
    ds_read_b128 v[66:69], v22 offset:53248
    v_fma_f32 v106, v106, v90, v90
    v_mul_f32 v142, v134, v142
    v_mfma_f32_16x16x32_bf16 v[204:207], a[28:31], v[78:81], v[204:207]
    buffer_load_dwordx4 v2, s[24:27], s60 offen offset:0 lds
    v_mfma_f32_16x16x32_bf16 v[208:211], a[24:27], v[82:85], v[208:211]
    ds_read_b128 v[70:73], v22 offset:55296
    v_rcp_f32 v106, v106
    v_mfma_f32_16x16x32_bf16 v[216:219], a[28:31], v[82:85], v[216:219]
    s_add_u32 s74, s22, s4
    v_fma_f32 v107, v107, v90, v90
    v_mul_f32 v143, v135, v143
    v_mfma_f32_16x16x32_bf16 v[212:215], a[24:27], v[86:89], v[212:215]
    ds_read_b128 v[74:77], v23 offset:49152
    v_rcp_f32 v107, v107
    v_mfma_f32_16x16x32_bf16 v[220:223], a[28:31], v[86:89], v[220:223]
    s_waitcnt lgkmcnt(3)
    v_fma_f32 v108, v108, v90, v90
    v_fma_f32 v109, v109, v90, v90
    v_mfma_f32_16x16x32_bf16 v[192:195], a[32:35], v[58:61], v[192:195]
    ds_read_b128 v[78:81], v23 offset:51200
    v_rcp_f32 v108, v108
    v_mfma_f32_16x16x32_bf16 v[200:203], a[36:39], v[58:61], v[200:203]
    buffer_load_dwordx4 v3, s[24:27], s60 offen offset:1024 lds
    v_mfma_f32_16x16x32_bf16 v[196:199], a[32:35], v[62:65], v[196:199]
    ds_read_b128 v[82:85], v23 offset:53248
    v_rcp_f32 v109, v109
    v_mfma_f32_16x16x32_bf16 v[204:207], a[36:39], v[62:65], v[204:207]
    s_waitcnt lgkmcnt(3)
    v_mul_f32 v106, v136, v106
    v_fma_f32 v110, v110, v92, v92
    v_mfma_f32_16x16x32_bf16 v[208:211], a[32:35], v[66:69], v[208:211]
    ds_read_b128 v[86:89], v23 offset:55296
    v_rcp_f32 v110, v110
    v_mfma_f32_16x16x32_bf16 v[216:219], a[36:39], v[66:69], v[216:219]
    ds_read_b128 v[58:61], v22 offset:57344
    v_mul_f32 v107, v137, v107
    v_mfma_f32_16x16x32_bf16 v[212:215], a[32:35], v[70:73], v[212:215]
    ds_read_b128 v[62:65], v22 offset:59392
    v_fma_f32 v111, v111, v92, v92
    v_mul_f32 v108, v138, v108
    v_mfma_f32_16x16x32_bf16 v[220:223], a[36:39], v[70:73], v[220:223]
    s_waitcnt lgkmcnt(2)
    buffer_load_dwordx4 v4, s[24:27], s60 offen offset:2048 lds
    v_mfma_f32_16x16x32_bf16 v[192:195], a[40:43], v[74:77], v[192:195]
    ds_read_b128 v[66:69], v22 offset:61440
    v_rcp_f32 v111, v111
    v_mfma_f32_16x16x32_bf16 v[200:203], a[44:47], v[74:77], v[200:203]
    v_fma_f32 v112, v112, v92, v92
    v_mul_f32 v109, v139, v109
    v_mfma_f32_16x16x32_bf16 v[196:199], a[40:43], v[78:81], v[196:199]
    ds_read_b128 v[70:73], v22 offset:63488
    v_rcp_f32 v112, v112
    v_mfma_f32_16x16x32_bf16 v[204:207], a[44:47], v[78:81], v[204:207]
    ds_read_b128 v[74:77], v23 offset:57344
    v_fma_f32 v113, v113, v92, v92
    v_mfma_f32_16x16x32_bf16 v[208:211], a[40:43], v[82:85], v[208:211]
    ds_read_b128 v[78:81], v23 offset:59392
    v_rcp_f32 v113, v113
    v_mfma_f32_16x16x32_bf16 v[216:219], a[44:47], v[82:85], v[216:219]
    buffer_load_dwordx4 v5, s[24:27], s60 offen offset:3072 lds
    v_mfma_f32_16x16x32_bf16 v[212:215], a[40:43], v[86:89], v[212:215]
    ds_read_b128 v[82:85], v23 offset:61440
    v_mul_f32 v110, v140, v110
    v_cvt_pk_bf16_f32 v114, v106, v107
    v_mfma_f32_16x16x32_bf16 v[220:223], a[44:47], v[86:89], v[220:223]
    s_waitcnt lgkmcnt(4)
    v_mul_f32 v111, v141, v111
    v_cvt_pk_bf16_f32 v115, v108, v109
    v_mfma_f32_16x16x32_bf16 v[192:195], a[48:51], v[58:61], v[192:195]
    ds_read_b128 v[86:89], v23 offset:63488
    v_mul_f32 v112, v142, v112
    v_cvt_pk_bf16_f32 v116, v110, v111
    v_mfma_f32_16x16x32_bf16 v[200:203], a[52:55], v[58:61], v[200:203]
    s_add_u32 m0, s64, 98304
ffn_pg2:
    s_cbranch_execz ffn_pg6
    s_nop 0
    buffer_load_dwordx4 v12, s[40:43], s74 offen offset:0 lds
    v_mfma_f32_16x16x32_bf16 v[196:199], a[48:51], v[62:65], v[196:199]
    s_add_u32 s60, s77, s84
    v_mul_f32 v113, v143, v113
    v_cvt_pk_bf16_f32 v117, v112, v113
    v_permlane16_swap_b32 v114, v116
    v_mfma_f32_16x16x32_bf16 v[204:207], a[52:55], v[62:65], v[204:207]
    v_permlane16_swap_b32 v115, v117
    v_mfma_f32_16x16x32_bf16 v[208:211], a[48:51], v[66:69], v[208:211]
    buffer_store_dwordx4 v[114:117], v24, s[28:31], s80 offen sc1
    v_mul_f32 v106, v144, v95
    v_mfma_f32_16x16x32_bf16 v[216:219], a[52:55], v[66:69], v[216:219]
    s_waitcnt vmcnt(18) lgkmcnt(0)
    s_barrier
    v_mfma_f32_16x16x32_bf16 v[212:215], a[48:51], v[70:73], v[212:215]
    ds_read_b128 v[58:61], v22 offset:0
    v_exp_f32 v106, v106
    v_mfma_f32_16x16x32_bf16 v[220:223], a[52:55], v[70:73], v[220:223]
    buffer_load_dwordx4 v13, s[40:43], s74 offen offset:1024 lds
    v_mfma_f32_16x16x32_bf16 v[192:195], a[56:59], v[74:77], v[192:195]
    ds_read_b128 v[62:65], v22 offset:2048
    v_mul_f32 v107, v145, v95
    v_mul_f32 v108, v146, v95
    v_mfma_f32_16x16x32_bf16 v[200:203], a[60:63], v[74:77], v[200:203]
    s_add_u32 m0, s62, 49152
    v_exp_f32 v107, v107
    v_mfma_f32_16x16x32_bf16 v[196:199], a[56:59], v[78:81], v[196:199]
    ds_read_b128 v[66:69], v22 offset:4096
    v_cndmask_b32 v54, 0, v98, s[50:51]
    v_mov_b32 v101, v99
    v_mfma_f32_16x16x32_bf16 v[204:207], a[60:63], v[78:81], v[204:207]
    buffer_load_dwordx4 v2, s[24:27], s60 offen offset:0 lds
    v_mfma_f32_16x16x32_bf16 v[208:211], a[56:59], v[82:85], v[208:211]
    ds_read_b128 v[70:73], v22 offset:6144
    v_exp_f32 v108, v108
    v_mfma_f32_16x16x32_bf16 v[216:219], a[60:63], v[82:85], v[216:219]
    s_add_u32 s74, s23, s4
    v_mul_f32 v152, v144, v152
    v_mul_f32 v109, v147, v95
    v_mfma_f32_16x16x32_bf16 v[160:163], v[46:49], v[54:57], v[160:163]
    v_mul_f32 v153, v145, v153
    v_mul_f32 v110, v148, v97
    v_mfma_f32_16x16x32_bf16 v[168:171], v[50:53], v[54:57], v[168:171]
    v_exp_f32 v109, v109
    v_mfma_f32_16x16x32_bf16 v[212:215], a[56:59], v[86:89], v[212:215]
    ds_read_b128 v[74:77], v23 offset:0
    v_cndmask_b32 v54, 0, v98, s[52:53]
    v_mov_b32 v98, v100
    v_mfma_f32_16x16x32_bf16 v[220:223], a[60:63], v[86:89], v[220:223]
    s_waitcnt lgkmcnt(3)
    v_mul_f32 v154, v146, v154
    v_mul_f32 v111, v149, v97
    v_mfma_f32_16x16x32_bf16 v[164:167], v[46:49], v[54:57], v[164:167]
    v_exp_f32 v110, v110
    v_mfma_f32_16x16x32_bf16 v[192:195], a[64:67], v[58:61], v[192:195]
    ds_read_b128 v[78:81], v23 offset:2048
    v_permlane16_swap_b32 v99, v101
    v_permlane16_swap_b32 v98, v100
    v_mfma_f32_16x16x32_bf16 v[200:203], a[68:71], v[58:61], v[200:203]
    buffer_load_dwordx4 v3, s[24:27], s60 offen offset:1024 lds
    v_mfma_f32_16x16x32_bf16 v[196:199], a[64:67], v[62:65], v[196:199]
    ds_read_b128 v[82:85], v23 offset:4096
    v_exp_f32 v111, v111
    v_mfma_f32_16x16x32_bf16 v[204:207], a[68:71], v[62:65], v[204:207]
    s_waitcnt lgkmcnt(3)
    v_mul_f32 v155, v147, v155
    v_mul_f32 v112, v150, v97
    v_mfma_f32_16x16x32_bf16 v[172:175], v[50:53], v[54:57], v[172:175]
    v_exp_f32 v112, v112
    v_mfma_f32_16x16x32_bf16 v[208:211], a[64:67], v[66:69], v[208:211]
    ds_read_b128 v[86:89], v23 offset:6144
    v_mul_f32 v156, v148, v156
    v_mul_f32 v113, v151, v97
    v_mfma_f32_16x16x32_bf16 v[216:219], a[68:71], v[66:69], v[216:219]
    ds_read_b128 v[58:61], v22 offset:8192
    v_mul_f32 v157, v149, v157
    v_mfma_f32_16x16x32_bf16 v[212:215], a[64:67], v[70:73], v[212:215]
    ds_read_b128 v[62:65], v22 offset:10240
    v_exp_f32 v113, v113
    v_mfma_f32_16x16x32_bf16 v[220:223], a[68:71], v[70:73], v[220:223]
    s_waitcnt lgkmcnt(2)
    buffer_load_dwordx4 v4, s[24:27], s60 offen offset:2048 lds
    v_mfma_f32_16x16x32_bf16 v[192:195], a[72:75], v[74:77], v[192:195]
    ds_read_b128 v[66:69], v22 offset:12288
    v_fma_f32 v106, v106, v94, v94
    v_mul_f32 v158, v150, v158
    v_mfma_f32_16x16x32_bf16 v[200:203], a[76:79], v[74:77], v[200:203]
    v_rcp_f32 v106, v106
    v_mfma_f32_16x16x32_bf16 v[196:199], a[72:75], v[78:81], v[196:199]
    ds_read_b128 v[70:73], v22 offset:14336
    v_fma_f32 v107, v107, v94, v94
    v_mul_f32 v159, v151, v159
    v_mfma_f32_16x16x32_bf16 v[204:207], a[76:79], v[78:81], v[204:207]
    ds_read_b128 v[74:77], v23 offset:8192
    v_fma_f32 v108, v108, v94, v94
    v_mfma_f32_16x16x32_bf16 v[208:211], a[72:75], v[82:85], v[208:211]
    ds_read_b128 v[78:81], v23 offset:10240
    v_rcp_f32 v107, v107
    v_mfma_f32_16x16x32_bf16 v[216:219], a[76:79], v[82:85], v[216:219]
    buffer_load_dwordx4 v5, s[24:27], s60 offen offset:3072 lds
    v_mfma_f32_16x16x32_bf16 v[212:215], a[72:75], v[86:89], v[212:215]
    ds_read_b128 v[82:85], v23 offset:12288
    v_rcp_f32 v108, v108
    v_mfma_f32_16x16x32_bf16 v[220:223], a[76:79], v[86:89], v[220:223]
    s_waitcnt lgkmcnt(4)
    v_fma_f32 v109, v109, v94, v94
    v_mul_f32 v106, v152, v106
    v_mfma_f32_16x16x32_bf16 v[192:195], a[80:83], v[58:61], v[192:195]
    ds_read_b128 v[86:89], v23 offset:14336
    v_rcp_f32 v109, v109
    v_mfma_f32_16x16x32_bf16 v[200:203], a[84:87], v[58:61], v[200:203]
    s_add_u32 m0, s64, 106496
    s_nop 0
    buffer_load_dwordx4 v12, s[40:43], s74 offen offset:0 lds
    v_mfma_f32_16x16x32_bf16 v[196:199], a[80:83], v[62:65], v[196:199]
    s_add_u32 s60, s77, s85
    v_fma_f32 v110, v110, v96, v96
    v_rcp_f32 v110, v110
    v_mfma_f32_16x16x32_bf16 v[204:207], a[84:87], v[62:65], v[204:207]
    v_mul_f32 v107, v153, v107
    v_fma_f32 v111, v111, v96, v96
    v_mfma_f32_16x16x32_bf16 v[208:211], a[80:83], v[66:69], v[208:211]
    v_rcp_f32 v111, v111
    v_mul_f32 v108, v154, v108
    v_mfma_f32_16x16x32_bf16 v[216:219], a[84:87], v[66:69], v[216:219]
    s_waitcnt vmcnt(14) lgkmcnt(0)
    s_barrier
    v_mfma_f32_16x16x32_bf16 v[212:215], a[80:83], v[70:73], v[212:215]
    ds_read_b128 v[58:61], v22 offset:16384
    v_fma_f32 v112, v112, v96, v96
    v_mul_f32 v109, v155, v109
    v_mfma_f32_16x16x32_bf16 v[220:223], a[84:87], v[70:73], v[220:223]
    buffer_load_dwordx4 v13, s[40:43], s74 offen offset:1024 lds
    v_mfma_f32_16x16x32_bf16 v[192:195], a[88:91], v[74:77], v[192:195]
    ds_read_b128 v[62:65], v22 offset:18432
    v_rcp_f32 v112, v112
    v_mfma_f32_16x16x32_bf16 v[200:203], a[92:95], v[74:77], v[200:203]
    s_add_u32 m0, s62, 0
    v_fma_f32 v113, v113, v96, v96
    v_mul_f32 v110, v156, v110
    v_mfma_f32_16x16x32_bf16 v[196:199], a[88:91], v[78:81], v[196:199]
    ds_read_b128 v[66:69], v22 offset:20480
    v_rcp_f32 v113, v113
    v_mfma_f32_16x16x32_bf16 v[204:207], a[92:95], v[78:81], v[204:207]
    buffer_load_dwordx4 v2, s[24:27], s60 offen offset:0 lds
    v_mfma_f32_16x16x32_bf16 v[208:211], a[88:91], v[82:85], v[208:211]
    ds_read_b128 v[70:73], v22 offset:22528
    v_cvt_pk_bf16_f32 v118, v106, v107
    v_mul_f32 v111, v157, v111
    v_mfma_f32_16x16x32_bf16 v[216:219], a[92:95], v[82:85], v[216:219]
    s_add_u32 s74, s18, s5
    v_cvt_pk_bf16_f32 v119, v108, v109
    v_mul_f32 v112, v158, v112
    v_mfma_f32_16x16x32_bf16 v[212:215], a[88:91], v[86:89], v[212:215]
    ds_read_b128 v[74:77], v23 offset:16384
    v_cvt_pk_bf16_f32 v120, v110, v111
    v_mul_f32 v113, v159, v113
    v_mfma_f32_16x16x32_bf16 v[220:223], a[92:95], v[86:89], v[220:223]
    s_waitcnt lgkmcnt(3)
    v_cvt_pk_bf16_f32 v121, v112, v113
    v_permlane16_swap_b32 v118, v120
    v_mfma_f32_16x16x32_bf16 v[192:195], a[96:99], v[58:61], v[192:195]
    ds_read_b128 v[78:81], v23 offset:18432
    v_permlane16_swap_b32 v119, v121
    v_mfma_f32_16x16x32_bf16 v[200:203], a[100:103], v[58:61], v[200:203]
    buffer_load_dwordx4 v3, s[24:27], s60 offen offset:1024 lds
    v_mfma_f32_16x16x32_bf16 v[196:199], a[96:99], v[62:65], v[196:199]
    ds_read_b128 v[82:85], v23 offset:20480
    buffer_store_dwordx4 v[118:121], v25, s[28:31], s80 offen sc1
    v_mfma_f32_16x16x32_bf16 v[204:207], a[100:103], v[62:65], v[204:207]
    s_waitcnt lgkmcnt(3)
    buffer_load_dwordx4 v[90:93], v31, s[28:31], s79 offen offset:0 sc1
    v_mfma_f32_16x16x32_bf16 v[208:211], a[96:99], v[66:69], v[208:211]
    ds_read_b128 v[86:89], v23 offset:22528
    buffer_load_dwordx4 v[94:97], v31, s[28:31], s79 offen offset:512 sc1
    v_mfma_f32_16x16x32_bf16 v[216:219], a[100:103], v[66:69], v[216:219]
    ds_read_b128 v[58:61], v22 offset:24576
    v_mul_f32 v106, v160, v99
    v_mfma_f32_16x16x32_bf16 v[212:215], a[96:99], v[70:73], v[212:215]
    ds_read_b128 v[62:65], v22 offset:26624
    v_exp_f32 v106, v106
    v_mfma_f32_16x16x32_bf16 v[220:223], a[100:103], v[70:73], v[220:223]
    s_waitcnt lgkmcnt(2)
    buffer_load_dwordx4 v4, s[24:27], s60 offen offset:2048 lds
    v_mfma_f32_16x16x32_bf16 v[192:195], a[104:107], v[74:77], v[192:195]
    ds_read_b128 v[66:69], v22 offset:28672
    v_mul_f32 v107, v161, v99
    v_mul_f32 v108, v162, v99
    v_mfma_f32_16x16x32_bf16 v[200:203], a[108:111], v[74:77], v[200:203]
    v_exp_f32 v107, v107
    v_mfma_f32_16x16x32_bf16 v[196:199], a[104:107], v[78:81], v[196:199]
    ds_read_b128 v[70:73], v22 offset:30720
    v_cndmask_b32 v54, 0, v102, s[50:51]
    v_mov_b32 v105, v103
    v_mfma_f32_16x16x32_bf16 v[204:207], a[108:111], v[78:81], v[204:207]
    ds_read_b128 v[74:77], v23 offset:24576
    v_mul_f32 v168, v160, v168
    v_mfma_f32_16x16x32_bf16 v[208:211], a[104:107], v[82:85], v[208:211]
    ds_read_b128 v[78:81], v23 offset:26624
    v_exp_f32 v108, v108
    v_mfma_f32_16x16x32_bf16 v[216:219], a[108:111], v[82:85], v[216:219]
    buffer_load_dwordx4 v5, s[24:27], s60 offen offset:3072 lds
    v_mfma_f32_16x16x32_bf16 v[212:215], a[104:107], v[86:89], v[212:215]
    ds_read_b128 v[82:85], v23 offset:28672
    v_mul_f32 v109, v163, v99
    v_mfma_f32_16x16x32_bf16 v[176:179], v[46:49], v[54:57], v[176:179]
    s_add_u32 m0, s64, 114688
    v_mul_f32 v169, v161, v169
    v_exp_f32 v109, v109
    v_mfma_f32_16x16x32_bf16 v[220:223], a[108:111], v[86:89], v[220:223]
    s_waitcnt lgkmcnt(4)
    v_mul_f32 v110, v164, v101
    v_mfma_f32_16x16x32_bf16 v[184:187], v[50:53], v[54:57], v[184:187]
    v_cndmask_b32 v54, 0, v102, s[52:53]
    v_mov_b32 v102, v104
    v_mfma_f32_16x16x32_bf16 v[192:195], a[112:115], v[58:61], v[192:195]
    ds_read_b128 v[86:89], v23 offset:30720
    v_mul_f32 v170, v162, v170
    v_mul_f32 v111, v165, v101
    v_mfma_f32_16x16x32_bf16 v[180:183], v[46:49], v[54:57], v[180:183]
    v_exp_f32 v110, v110
    v_permlane16_swap_b32 v103, v105
    v_mfma_f32_16x16x32_bf16 v[200:203], a[116:119], v[58:61], v[200:203]
    buffer_load_dwordx4 v12, s[40:43], s74 offen offset:0 lds
    v_mfma_f32_16x16x32_bf16 v[196:199], a[112:115], v[62:65], v[196:199]
    s_add_u32 s60, s77, s86
    v_exp_f32 v111, v111
    v_permlane16_swap_b32 v102, v104
    v_mfma_f32_16x16x32_bf16 v[204:207], a[116:119], v[62:65], v[204:207]
    v_mul_f32 v171, v163, v171
    v_mul_f32 v112, v166, v101
    v_mfma_f32_16x16x32_bf16 v[188:191], v[50:53], v[54:57], v[188:191]
    v_exp_f32 v112, v112
    v_mfma_f32_16x16x32_bf16 v[208:211], a[112:115], v[66:69], v[208:211]
    v_mul_f32 v172, v164, v172
    v_mul_f32 v113, v167, v101
    v_mul_f32 v173, v165, v173
    v_mfma_f32_16x16x32_bf16 v[216:219], a[116:119], v[66:69], v[216:219]
    s_waitcnt vmcnt(17) lgkmcnt(0)
    s_barrier
    v_mfma_f32_16x16x32_bf16 v[212:215], a[112:115], v[70:73], v[212:215]
    ds_read_b128 v[58:61], v22 offset:32768
    v_exp_f32 v113, v113
    v_mfma_f32_16x16x32_bf16 v[220:223], a[116:119], v[70:73], v[220:223]
    buffer_load_dwordx4 v13, s[40:43], s74 offen offset:1024 lds
    v_mfma_f32_16x16x32_bf16 v[192:195], a[120:123], v[74:77], v[192:195]
    ds_read_b128 v[62:65], v22 offset:34816
    v_fma_f32 v106, v106, v98, v98
    v_mul_f32 v174, v166, v174
    v_mfma_f32_16x16x32_bf16 v[200:203], a[124:127], v[74:77], v[200:203]
    s_add_u32 m0, s62, 16384
    v_fma_f32 v107, v107, v98, v98
    v_mul_f32 v175, v167, v175
    v_mfma_f32_16x16x32_bf16 v[196:199], a[120:123], v[78:81], v[196:199]
    ds_read_b128 v[66:69], v22 offset:36864
    v_xor_b32 v41, s54, v41
    v_bitop3_b32 v41, v37, s54, v41 bitop3:0xbe
    v_cmp_ne_u32 vcc, 0, v41
    s_nop 0
    s_cbranch_vccnz slow_6
back_7:
    v_mfma_f32_16x16x32_bf16 v[204:207], a[124:127], v[78:81], v[204:207]
    buffer_load_dwordx4 v2, s[24:27], s60 offen offset:0 lds
    v_mfma_f32_16x16x32_bf16 v[208:211], a[120:123], v[82:85], v[208:211]
    ds_read_b128 v[70:73], v22 offset:38912
    v_rcp_f32 v106, v106
    v_mfma_f32_16x16x32_bf16 v[216:219], a[124:127], v[82:85], v[216:219]
    s_add_u32 s74, s19, s5
    v_rcp_f32 v107, v107
    v_mfma_f32_16x16x32_bf16 v[212:215], a[120:123], v[86:89], v[212:215]
    ds_read_b128 v[74:77], v23 offset:32768
    v_fma_f32 v108, v108, v98, v98
    v_cndmask_b32 v54, 0, v34, s[50:51]
    v_mfma_f32_16x16x32_bf16 v[220:223], a[124:127], v[86:89], v[220:223]
    s_waitcnt lgkmcnt(3)
    v_rcp_f32 v108, v108
    v_mfma_f32_16x16x32_bf16 v[192:195], a[128:131], v[58:61], v[192:195]
    ds_read_b128 v[78:81], v23 offset:34816
    v_mov_b32 v37, v35
    v_fma_f32 v109, v109, v98, v98
    v_mfma_f32_16x16x32_bf16 v[200:203], a[132:135], v[58:61], v[200:203]
    buffer_load_dwordx4 v3, s[24:27], s60 offen offset:1024 lds
    v_mfma_f32_16x16x32_bf16 v[196:199], a[128:131], v[62:65], v[196:199]
    ds_read_b128 v[82:85], v23 offset:36864
    v_mul_f32 v106, v168, v106
    v_mfma_f32_16x16x32_bf16 v[192:195], v[46:49], v[54:57], v[192:195]
    v_rcp_f32 v109, v109
    v_fma_f32 v110, v110, v100, v100
    v_mfma_f32_16x16x32_bf16 v[204:207], a[132:135], v[62:65], v[204:207]
    s_waitcnt lgkmcnt(3)
    v_mul_f32 v107, v169, v107
    v_mfma_f32_16x16x32_bf16 v[200:203], v[50:53], v[54:57], v[200:203]
    v_cndmask_b32 v54, 0, v34, s[52:53]
    v_mov_b32 v34, v36
    v_mfma_f32_16x16x32_bf16 v[208:211], a[128:131], v[66:69], v[208:211]
    ds_read_b128 v[86:89], v23 offset:38912
    v_rcp_f32 v110, v110
    v_mfma_f32_16x16x32_bf16 v[216:219], a[132:135], v[66:69], v[216:219]
    ds_read_b128 v[58:61], v22 offset:40960
    v_fma_f32 v111, v111, v100, v100
    v_mfma_f32_16x16x32_bf16 v[212:215], a[128:131], v[70:73], v[212:215]
    ds_read_b128 v[62:65], v22 offset:43008
    v_mul_f32 v108, v170, v108
    v_mfma_f32_16x16x32_bf16 v[196:199], v[46:49], v[54:57], v[196:199]
    v_rcp_f32 v111, v111
    v_permlane16_swap_b32 v35, v37
    v_mfma_f32_16x16x32_bf16 v[220:223], a[132:135], v[70:73], v[220:223]
    s_waitcnt lgkmcnt(2)
    buffer_load_dwordx4 v4, s[24:27], s60 offen offset:2048 lds
    v_mfma_f32_16x16x32_bf16 v[192:195], a[136:139], v[74:77], v[192:195]
    ds_read_b128 v[66:69], v22 offset:45056
    v_permlane16_swap_b32 v34, v36
    v_fma_f32 v112, v112, v100, v100
    v_mfma_f32_16x16x32_bf16 v[200:203], a[140:143], v[74:77], v[200:203]
    v_rcp_f32 v112, v112
    v_mfma_f32_16x16x32_bf16 v[196:199], a[136:139], v[78:81], v[196:199]
    ds_read_b128 v[70:73], v22 offset:47104
    v_mul_f32 v109, v171, v109
    v_mfma_f32_16x16x32_bf16 v[204:207], v[50:53], v[54:57], v[204:207]
    v_fma_f32 v113, v113, v100, v100
    v_rcp_f32 v113, v113
    v_mfma_f32_16x16x32_bf16 v[204:207], a[140:143], v[78:81], v[204:207]
    ds_read_b128 v[74:77], v23 offset:40960
    v_mul_f32 v110, v172, v110
    v_mfma_f32_16x16x32_bf16 v[208:211], a[136:139], v[82:85], v[208:211]
    ds_read_b128 v[78:81], v23 offset:43008
    v_cvt_pk_bf16_f32 v114, v106, v107
    v_mul_f32 v111, v173, v111
    v_mfma_f32_16x16x32_bf16 v[216:219], a[140:143], v[82:85], v[216:219]
    buffer_load_dwordx4 v5, s[24:27], s60 offen offset:3072 lds
    v_mfma_f32_16x16x32_bf16 v[212:215], a[136:139], v[86:89], v[212:215]
    ds_read_b128 v[82:85], v23 offset:45056
    v_cvt_pk_bf16_f32 v115, v108, v109
    v_mul_f32 v112, v174, v112
    v_mfma_f32_16x16x32_bf16 v[220:223], a[140:143], v[86:89], v[220:223]
    s_waitcnt lgkmcnt(4)
    v_cvt_pk_bf16_f32 v116, v110, v111
    v_mul_f32 v113, v175, v113
    s_waitcnt vmcnt(10)
    v_mov_b32 v8, s54
    s_mov_b64 exec, 1
    buffer_store_dword v8, off, s[28:31], s65 sc1
    s_mov_b64 exec, -1
    s_xor_b32 s65, s65, 512
    v_mfma_f32_16x16x32_bf16 v[192:195], a[144:147], v[58:61], v[192:195]
    ds_read_b128 v[86:89], v23 offset:47104
    v_cvt_pk_bf16_f32 v117, v112, v113
    v_permlane16_swap_b32 v114, v116
    v_mfma_f32_16x16x32_bf16 v[200:203], a[148:151], v[58:61], v[200:203]
    s_add_u32 m0, s64, 122880
    s_nop 0
    buffer_load_dwordx4 v12, s[40:43], s74 offen offset:0 lds
    v_mfma_f32_16x16x32_bf16 v[196:199], a[144:147], v[62:65], v[196:199]
    s_add_u32 s60, s77, s87
    v_permlane16_swap_b32 v115, v117
    buffer_store_dwordx4 v[114:117], v24, s[28:31], s81 offen sc1
    v_mfma_f32_16x16x32_bf16 v[204:207], a[148:151], v[62:65], v[204:207]
    v_mul_f32 v106, v176, v103
    v_mul_f32 v107, v177, v103
    v_mfma_f32_16x16x32_bf16 v[208:211], a[144:147], v[66:69], v[208:211]
    v_exp_f32 v106, v106
    v_mul_f32 v108, v178, v103
    v_mfma_f32_16x16x32_bf16 v[216:219], a[148:151], v[66:69], v[216:219]
    s_waitcnt lgkmcnt(0)
    s_barrier
    v_mfma_f32_16x16x32_bf16 v[212:215], a[144:147], v[70:73], v[212:215]
    ds_read_b128 v[58:61], v22 offset:49152
    v_exp_f32 v107, v107
    v_mfma_f32_16x16x32_bf16 v[220:223], a[148:151], v[70:73], v[220:223]
    buffer_load_dwordx4 v13, s[40:43], s74 offen offset:1024 lds
    v_mfma_f32_16x16x32_bf16 v[192:195], a[152:155], v[74:77], v[192:195]
    ds_read_b128 v[62:65], v22 offset:51200
    v_cndmask_b32 v54, 0, v38, s[50:51]
    v_mov_b32 v41, v39
    v_mfma_f32_16x16x32_bf16 v[200:203], a[156:159], v[74:77], v[200:203]
    s_add_u32 m0, s62, 32768
    v_exp_f32 v108, v108
    v_mfma_f32_16x16x32_bf16 v[196:199], a[152:155], v[78:81], v[196:199]
    ds_read_b128 v[66:69], v22 offset:53248
    v_mul_f32 v184, v176, v184
    v_mul_f32 v109, v179, v103
    v_mfma_f32_16x16x32_bf16 v[208:211], v[46:49], v[54:57], v[208:211]
    v_mul_f32 v185, v177, v185
    v_exp_f32 v109, v109
    v_mfma_f32_16x16x32_bf16 v[204:207], a[156:159], v[78:81], v[204:207]
    buffer_load_dwordx4 v2, s[24:27], s60 offen offset:0 lds
    v_mfma_f32_16x16x32_bf16 v[208:211], a[152:155], v[82:85], v[208:211]
    ds_read_b128 v[70:73], v22 offset:55296
    v_mul_f32 v110, v180, v105
    v_mfma_f32_16x16x32_bf16 v[216:219], v[50:53], v[54:57], v[216:219]
    s_add_u32 s74, s18, s4
    v_cndmask_b32 v54, 0, v38, s[52:53]
    v_mov_b32 v38, v40
    v_mul_f32 v186, v178, v186
    v_mfma_f32_16x16x32_bf16 v[216:219], a[156:159], v[82:85], v[216:219]
    v_exp_f32 v110, v110
    v_mfma_f32_16x16x32_bf16 v[212:215], a[152:155], v[86:89], v[212:215]
    ds_read_b128 v[74:77], v23 offset:49152
    v_mul_f32 v111, v181, v105
    v_mfma_f32_16x16x32_bf16 v[212:215], v[46:49], v[54:57], v[212:215]
    v_permlane16_swap_b32 v39, v41
    v_exp_f32 v111, v111
    v_mfma_f32_16x16x32_bf16 v[220:223], a[156:159], v[86:89], v[220:223]
    s_waitcnt lgkmcnt(3)
    buffer_load_dwordx4 v3, s[24:27], s60 offen offset:1024 lds
    v_mfma_f32_16x16x32_bf16 v[224:227], a[0:3], v[58:61], 0
    ds_read_b128 v[78:81], v23 offset:51200
    v_permlane16_swap_b32 v38, v40
    v_mul_f32 v187, v179, v187
    v_mfma_f32_16x16x32_bf16 v[232:235], a[4:7], v[58:61], 0
    s_add_u32 s1, s19, s4
    buffer_load_dwordx4 v4, s[24:27], s60 offen offset:2048 lds
    v_mfma_f32_16x16x32_bf16 v[228:231], a[0:3], v[62:65], 0
    ds_read_b128 v[82:85], v23 offset:53248
    v_mul_f32 v112, v182, v105
    v_mfma_f32_16x16x32_bf16 v[220:223], v[50:53], v[54:57], v[220:223]
    v_exp_f32 v112, v112
    v_mul_f32 v188, v180, v188
    v_mfma_f32_16x16x32_bf16 v[236:239], a[4:7], v[62:65], 0
    s_waitcnt lgkmcnt(3)
    v_mul_f32 v113, v183, v105
    v_mul_f32 v189, v181, v189
    v_mfma_f32_16x16x32_bf16 v[240:243], a[0:3], v[66:69], 0
    ds_read_b128 v[86:89], v23 offset:55296
    v_exp_f32 v113, v113
    v_mfma_f32_16x16x32_bf16 v[248:251], a[4:7], v[66:69], 0
    ds_read_b128 v[58:61], v22 offset:57344
    v_fma_f32 v106, v106, v102, v102
    v_mfma_f32_16x16x32_bf16 v[244:247], a[0:3], v[70:73], 0
    ds_read_b128 v[62:65], v22 offset:59392
    v_rcp_f32 v106, v106
    v_mfma_f32_16x16x32_bf16 v[252:255], a[4:7], v[70:73], 0
    s_waitcnt lgkmcnt(2)
    buffer_load_dwordx4 v5, s[24:27], s60 offen offset:3072 lds
    v_mfma_f32_16x16x32_bf16 v[224:227], a[8:11], v[74:77], v[224:227]
    ds_read_b128 v[66:69], v22 offset:61440
    v_mul_f32 v190, v182, v190
    v_fma_f32 v107, v107, v102, v102
    v_mfma_f32_16x16x32_bf16 v[232:235], a[12:15], v[74:77], v[232:235]
    s_add_u32 m0, s64, 65536
    v_rcp_f32 v107, v107
    v_mfma_f32_16x16x32_bf16 v[228:231], a[8:11], v[78:81], v[228:231]
    ds_read_b128 v[70:73], v22 offset:63488
    v_mul_f32 v191, v183, v191
    v_fma_f32 v108, v108, v102, v102
    v_mfma_f32_16x16x32_bf16 v[236:239], a[12:15], v[78:81], v[236:239]
    ds_read_b128 v[74:77], v23 offset:57344
    v_fma_f32 v109, v109, v102, v102
    v_mfma_f32_16x16x32_bf16 v[240:243], a[8:11], v[82:85], v[240:243]
    ds_read_b128 v[78:81], v23 offset:59392
    v_rcp_f32 v108, v108
    v_mfma_f32_16x16x32_bf16 v[248:251], a[12:15], v[82:85], v[248:251]
    buffer_load_dwordx4 v12, s[40:43], s74 offen offset:0 lds
    v_mfma_f32_16x16x32_bf16 v[244:247], a[8:11], v[86:89], v[244:247]
    ds_read_b128 v[82:85], v23 offset:61440
    v_rcp_f32 v109, v109
    v_mfma_f32_16x16x32_bf16 v[252:255], a[12:15], v[86:89], v[252:255]
    s_waitcnt lgkmcnt(4)
    v_mul_f32 v106, v184, v106
    v_fma_f32 v110, v110, v104, v104
    v_mfma_f32_16x16x32_bf16 v[224:227], a[16:19], v[58:61], v[224:227]
    ds_read_b128 v[86:89], v23 offset:63488
    v_rcp_f32 v110, v110
    v_mfma_f32_16x16x32_bf16 v[232:235], a[20:23], v[58:61], v[232:235]
    s_add_u32 s60, s77, s88
    buffer_load_dwordx4 v13, s[40:43], s74 offen offset:1024 lds
    v_mfma_f32_16x16x32_bf16 v[228:231], a[16:19], v[62:65], v[228:231]
    s_add_u32 m0, s64, 73728
    v_mul_f32 v107, v185, v107
    v_fma_f32 v111, v111, v104, v104
    v_mul_f32 v108, v186, v108
    v_mfma_f32_16x16x32_bf16 v[236:239], a[20:23], v[62:65], v[236:239]
    v_rcp_f32 v111, v111
    v_mfma_f32_16x16x32_bf16 v[240:243], a[16:19], v[66:69], v[240:243]
    v_fma_f32 v112, v112, v104, v104
    v_rcp_f32 v112, v112
    v_mfma_f32_16x16x32_bf16 v[248:251], a[20:23], v[66:69], v[248:251]
    s_waitcnt vmcnt(16) lgkmcnt(0)
    s_barrier
    v_mfma_f32_16x16x32_bf16 v[244:247], a[16:19], v[70:73], v[244:247]
    ds_read_b128 v[58:61], v22 offset:0
    v_mul_f32 v109, v187, v109
    v_fma_f32 v113, v113, v104, v104
    v_mfma_f32_16x16x32_bf16 v[252:255], a[20:23], v[70:73], v[252:255]
    buffer_load_dwordx4 v12, s[40:43], s1 offen offset:0 lds
    v_mfma_f32_16x16x32_bf16 v[224:227], a[24:27], v[74:77], v[224:227]
    ds_read_b128 v[62:65], v22 offset:2048
    v_rcp_f32 v113, v113
    v_mfma_f32_16x16x32_bf16 v[232:235], a[28:31], v[74:77], v[232:235]
    v_mul_f32 v110, v188, v110
    v_cvt_pk_bf16_f32 v118, v106, v107
    v_mfma_f32_16x16x32_bf16 v[228:231], a[24:27], v[78:81], v[228:231]
    ds_read_b128 v[66:69], v22 offset:4096
    v_mul_f32 v111, v189, v111
    v_cvt_pk_bf16_f32 v119, v108, v109
    v_mfma_f32_16x16x32_bf16 v[236:239], a[28:31], v[78:81], v[236:239]
    buffer_load_dwordx4 v13, s[40:43], s1 offen offset:1024 lds
    v_mfma_f32_16x16x32_bf16 v[240:243], a[24:27], v[82:85], v[240:243]
    ds_read_b128 v[70:73], v22 offset:6144
    v_mul_f32 v112, v190, v112
    v_cvt_pk_bf16_f32 v120, v110, v111
    v_mfma_f32_16x16x32_bf16 v[248:251], a[28:31], v[82:85], v[248:251]
    s_add_u32 m0, s62, 49152
    v_mul_f32 v113, v191, v113
    v_cvt_pk_bf16_f32 v121, v112, v113
    v_mfma_f32_16x16x32_bf16 v[244:247], a[24:27], v[86:89], v[244:247]
    ds_read_b128 v[74:77], v23 offset:0
    v_permlane16_swap_b32 v118, v120
    v_mfma_f32_16x16x32_bf16 v[252:255], a[28:31], v[86:89], v[252:255]
    s_waitcnt lgkmcnt(3)
    buffer_load_dwordx4 v2, s[24:27], s60 offen offset:0 lds
    v_mfma_f32_16x16x32_bf16 v[224:227], a[32:35], v[58:61], v[224:227]
    ds_read_b128 v[78:81], v23 offset:2048
    v_permlane16_swap_b32 v119, v121
    v_mfma_f32_16x16x32_bf16 v[232:235], a[36:39], v[58:61], v[232:235]
    s_add_u32 s74, s20, s4
    buffer_load_dwordx4 v3, s[24:27], s60 offen offset:1024 lds
    v_mfma_f32_16x16x32_bf16 v[228:231], a[32:35], v[62:65], v[228:231]
    ds_read_b128 v[82:85], v23 offset:4096
    buffer_store_dwordx4 v[118:121], v25, s[28:31], s81 offen sc1
    v_mfma_f32_16x16x32_bf16 v[236:239], a[36:39], v[62:65], v[236:239]
    s_waitcnt lgkmcnt(3)
    v_mul_f32 v106, v192, v35
    v_mul_f32 v107, v193, v35
    v_mfma_f32_16x16x32_bf16 v[240:243], a[32:35], v[66:69], v[240:243]
    ds_read_b128 v[86:89], v23 offset:6144
    v_exp_f32 v106, v106
    v_mfma_f32_16x16x32_bf16 v[248:251], a[36:39], v[66:69], v[248:251]
    ds_read_b128 v[58:61], v22 offset:8192
    v_mul_f32 v108, v194, v35
    v_mfma_f32_16x16x32_bf16 v[244:247], a[32:35], v[70:73], v[244:247]
    ds_read_b128 v[62:65], v22 offset:10240
    v_exp_f32 v107, v107
    v_mfma_f32_16x16x32_bf16 v[252:255], a[36:39], v[70:73], v[252:255]
    s_waitcnt lgkmcnt(2)
    s_add_u32 s1, s21, s4
    buffer_load_dwordx4 v4, s[24:27], s60 offen offset:2048 lds
    v_mfma_f32_16x16x32_bf16 v[224:227], a[40:43], v[74:77], v[224:227]
    ds_read_b128 v[66:69], v22 offset:12288
    v_mul_f32 v200, v192, v200
    v_mul_f32 v109, v195, v35
    v_mfma_f32_16x16x32_bf16 v[232:235], a[44:47], v[74:77], v[232:235]
    v_mul_f32 v201, v193, v201
    v_xor_b32 v97, s54, v97
    v_bitop3_b32 v97, v93, s54, v97 bitop3:0xbe
    v_cmp_ne_u32 vcc, 0, v97
    s_nop 0
    s_cbranch_vccnz slow_9
back_10:
    v_mfma_f32_16x16x32_bf16 v[228:231], a[40:43], v[78:81], v[228:231]
    ds_read_b128 v[70:73], v22 offset:14336
    v_exp_f32 v108, v108
    v_mfma_f32_16x16x32_bf16 v[236:239], a[44:47], v[78:81], v[236:239]
    ds_read_b128 v[74:77], v23 offset:8192
    v_mul_f32 v110, v196, v37
    v_mfma_f32_16x16x32_bf16 v[240:243], a[40:43], v[82:85], v[240:243]
    ds_read_b128 v[78:81], v23 offset:10240
    v_exp_f32 v109, v109
    v_mfma_f32_16x16x32_bf16 v[248:251], a[44:47], v[82:85], v[248:251]
    buffer_load_dwordx4 v5, s[24:27], s60 offen offset:3072 lds
    v_mfma_f32_16x16x32_bf16 v[244:247], a[40:43], v[86:89], v[244:247]
    ds_read_b128 v[82:85], v23 offset:12288
    v_cndmask_b32 v54, 0, v90, s[50:51]
    v_mov_b32 v93, v91
    v_mfma_f32_16x16x32_bf16 v[252:255], a[44:47], v[86:89], v[252:255]
    s_waitcnt lgkmcnt(4)
    v_exp_f32 v110, v110
    v_mfma_f32_16x16x32_bf16 v[224:227], a[48:51], v[58:61], v[224:227]
    ds_read_b128 v[86:89], v23 offset:14336
    v_mul_f32 v202, v194, v202
    v_mul_f32 v111, v197, v37
    v_mfma_f32_16x16x32_bf16 v[224:227], v[46:49], v[54:57], v[224:227]
    s_add_u32 m0, s64, 81920
    v_mul_f32 v203, v195, v203
    v_exp_f32 v111, v111
    v_mfma_f32_16x16x32_bf16 v[232:235], a[52:55], v[58:61], v[232:235]
    buffer_load_dwordx4 v12, s[40:43], s74 offen offset:0 lds
    v_mfma_f32_16x16x32_bf16 v[228:231], a[48:51], v[62:65], v[228:231]
    v_mul_f32 v112, v198, v37
    v_mfma_f32_16x16x32_bf16 v[232:235], v[50:53], v[54:57], v[232:235]
    v_cndmask_b32 v54, 0, v90, s[52:53]
    v_mov_b32 v90, v92
    v_mul_f32 v204, v196, v204
    v_mfma_f32_16x16x32_bf16 v[236:239], a[52:55], v[62:65], v[236:239]
    v_exp_f32 v112, v112
    v_mfma_f32_16x16x32_bf16 v[240:243], a[48:51], v[66:69], v[240:243]
    v_mul_f32 v113, v199, v37
    v_mfma_f32_16x16x32_bf16 v[228:231], v[46:49], v[54:57], v[228:231]
    v_permlane16_swap_b32 v91, v93
    v_exp_f32 v113, v113
    v_mfma_f32_16x16x32_bf16 v[248:251], a[52:55], v[66:69], v[248:251]
    s_waitcnt vmcnt(18) lgkmcnt(0)
    s_barrier
    v_mfma_f32_16x16x32_bf16 v[244:247], a[48:51], v[70:73], v[244:247]
    ds_read_b128 v[58:61], v22 offset:16384
    v_permlane16_swap_b32 v90, v92
    v_mul_f32 v205, v197, v205
    v_mfma_f32_16x16x32_bf16 v[252:255], a[52:55], v[70:73], v[252:255]
    buffer_load_dwordx4 v13, s[40:43], s74 offen offset:1024 lds
    v_mfma_f32_16x16x32_bf16 v[224:227], a[56:59], v[74:77], v[224:227]
    ds_read_b128 v[62:65], v22 offset:18432
    v_fma_f32 v106, v106, v34, v34
    v_mfma_f32_16x16x32_bf16 v[236:239], v[50:53], v[54:57], v[236:239]
    v_rcp_f32 v106, v106
    v_mul_f32 v206, v198, v206
    v_mfma_f32_16x16x32_bf16 v[232:235], a[60:63], v[74:77], v[232:235]
    v_fma_f32 v107, v107, v34, v34
    v_mul_f32 v207, v199, v207
    v_mfma_f32_16x16x32_bf16 v[228:231], a[56:59], v[78:81], v[228:231]
    ds_read_b128 v[66:69], v22 offset:20480
    v_rcp_f32 v107, v107
    v_mfma_f32_16x16x32_bf16 v[236:239], a[60:63], v[78:81], v[236:239]
    buffer_load_dword v20, v18, s[28:31], s66 offen sc1
    v_mfma_f32_16x16x32_bf16 v[240:243], a[56:59], v[82:85], v[240:243]
    ds_read_b128 v[70:73], v22 offset:22528
    v_fma_f32 v108, v108, v34, v34
    v_fma_f32 v109, v109, v34, v34
    v_mfma_f32_16x16x32_bf16 v[248:251], a[60:63], v[82:85], v[248:251]
    s_add_u32 m0, s64, 90112
    v_rcp_f32 v108, v108
    v_mfma_f32_16x16x32_bf16 v[244:247], a[56:59], v[86:89], v[244:247]
    ds_read_b128 v[74:77], v23 offset:16384
    v_rcp_f32 v109, v109
    v_mfma_f32_16x16x32_bf16 v[252:255], a[60:63], v[86:89], v[252:255]
    s_waitcnt lgkmcnt(3)
    v_mul_f32 v106, v200, v106
    v_fma_f32 v110, v110, v36, v36
    v_mfma_f32_16x16x32_bf16 v[224:227], a[64:67], v[58:61], v[224:227]
    ds_read_b128 v[78:81], v23 offset:18432
    v_rcp_f32 v110, v110
    v_mfma_f32_16x16x32_bf16 v[232:235], a[68:71], v[58:61], v[232:235]
    buffer_load_dwordx4 v12, s[40:43], s1 offen offset:0 lds
    v_mfma_f32_16x16x32_bf16 v[228:231], a[64:67], v[62:65], v[228:231]
ffn_pg3:
    s_cbranch_execz ffn_ret
    ds_read_b128 v[82:85], v23 offset:20480
    v_mul_f32 v107, v201, v107
    v_fma_f32 v111, v111, v36, v36
    v_mfma_f32_16x16x32_bf16 v[236:239], a[68:71], v[62:65], v[236:239]
    s_waitcnt lgkmcnt(3)
    v_rcp_f32 v111, v111
    v_mfma_f32_16x16x32_bf16 v[240:243], a[64:67], v[66:69], v[240:243]
    ds_read_b128 v[86:89], v23 offset:22528
    v_mul_f32 v108, v202, v108
    v_fma_f32 v112, v112, v36, v36
    v_mfma_f32_16x16x32_bf16 v[248:251], a[68:71], v[66:69], v[248:251]
    ds_read_b128 v[58:61], v22 offset:24576
    v_mul_f32 v109, v203, v109
    v_mfma_f32_16x16x32_bf16 v[244:247], a[64:67], v[70:73], v[244:247]
    ds_read_b128 v[62:65], v22 offset:26624
    v_rcp_f32 v112, v112
    v_mfma_f32_16x16x32_bf16 v[252:255], a[68:71], v[70:73], v[252:255]
    s_waitcnt lgkmcnt(2)
    buffer_load_dwordx4 v13, s[40:43], s1 offen offset:1024 lds
    v_mfma_f32_16x16x32_bf16 v[224:227], a[72:75], v[74:77], v[224:227]
    ds_read_b128 v[66:69], v22 offset:28672
    v_fma_f32 v113, v113, v36, v36
    v_mul_f32 v110, v204, v110
    v_mfma_f32_16x16x32_bf16 v[232:235], a[76:79], v[74:77], v[232:235]
    s_add_u32 s74, s18, s0
    v_rcp_f32 v113, v113
    v_mfma_f32_16x16x32_bf16 v[228:231], a[72:75], v[78:81], v[228:231]
    ds_read_b128 v[70:73], v22 offset:30720
    v_cvt_pk_bf16_f32 v114, v106, v107
    v_mul_f32 v111, v205, v111
    v_mfma_f32_16x16x32_bf16 v[236:239], a[76:79], v[78:81], v[236:239]
    ds_read_b128 v[74:77], v23 offset:24576
    v_cvt_pk_bf16_f32 v115, v108, v109
    v_mfma_f32_16x16x32_bf16 v[240:243], a[72:75], v[82:85], v[240:243]
    ds_read_b128 v[78:81], v23 offset:26624
    v_mul_f32 v112, v206, v112
    v_cvt_pk_bf16_f32 v116, v110, v111
    v_mfma_f32_16x16x32_bf16 v[248:251], a[76:79], v[82:85], v[248:251]
    s_add_u32 m0, s64, 0
    s_nop 0
    buffer_load_dwordx4 v12, s[40:43], s74 offen offset:0 lds
    v_mfma_f32_16x16x32_bf16 v[244:247], a[72:75], v[86:89], v[244:247]
    ds_read_b128 v[82:85], v23 offset:28672
    v_mul_f32 v113, v207, v113
    v_cvt_pk_bf16_f32 v117, v112, v113
    v_mfma_f32_16x16x32_bf16 v[252:255], a[76:79], v[86:89], v[252:255]
    s_waitcnt lgkmcnt(4)
    v_permlane16_swap_b32 v114, v116
    s_waitcnt vmcnt(8)
    v_mov_b32 v8, s54
    s_mov_b64 exec, 1
    buffer_store_dword v8, off, s[28:31], s65 sc1
    s_mov_b64 exec, -1
    s_xor_b32 s65, s65, 1536
    v_mfma_f32_16x16x32_bf16 v[224:227], a[80:83], v[58:61], v[224:227]
    ds_read_b128 v[86:89], v23 offset:30720
    v_permlane16_swap_b32 v115, v117
    v_mfma_f32_16x16x32_bf16 v[232:235], a[84:87], v[58:61], v[232:235]
    buffer_load_dwordx4 v13, s[40:43], s74 offen offset:1024 lds
    v_mfma_f32_16x16x32_bf16 v[228:231], a[80:83], v[62:65], v[228:231]
    s_add_u32 s1, s19, s0
    buffer_store_dwordx4 v[114:117], v24, s[28:31], s82 offen sc1
    v_mfma_f32_16x16x32_bf16 v[236:239], a[84:87], v[62:65], v[236:239]
    s_add_u32 m0, s64, 8192
    v_mul_f32 v106, v208, v39
    v_mul_f32 v107, v209, v39
    v_mfma_f32_16x16x32_bf16 v[240:243], a[80:83], v[66:69], v[240:243]
    v_exp_f32 v106, v106
    v_mul_f32 v108, v210, v39
    v_mfma_f32_16x16x32_bf16 v[248:251], a[84:87], v[66:69], v[248:251]
    s_waitcnt lgkmcnt(0)
    s_barrier
    v_mfma_f32_16x16x32_bf16 v[244:247], a[80:83], v[70:73], v[244:247]
    ds_read_b128 v[58:61], v22 offset:32768
    v_exp_f32 v107, v107
    v_mfma_f32_16x16x32_bf16 v[252:255], a[84:87], v[70:73], v[252:255]
    buffer_load_dwordx4 v12, s[40:43], s1 offen offset:0 lds
    v_mfma_f32_16x16x32_bf16 v[224:227], a[88:91], v[74:77], v[224:227]
    ds_read_b128 v[62:65], v22 offset:34816
    v_cndmask_b32 v54, 0, v94, s[50:51]
    v_mov_b32 v97, v95
    v_mfma_f32_16x16x32_bf16 v[232:235], a[92:95], v[74:77], v[232:235]
    v_exp_f32 v108, v108
    v_mfma_f32_16x16x32_bf16 v[228:231], a[88:91], v[78:81], v[228:231]
    ds_read_b128 v[66:69], v22 offset:36864
    v_mul_f32 v216, v208, v216
    v_mul_f32 v109, v211, v39
    v_mfma_f32_16x16x32_bf16 v[240:243], v[46:49], v[54:57], v[240:243]
    v_mul_f32 v217, v209, v217
    v_exp_f32 v109, v109
    v_mfma_f32_16x16x32_bf16 v[236:239], a[92:95], v[78:81], v[236:239]
    buffer_load_dwordx4 v13, s[40:43], s1 offen offset:1024 lds
    v_mfma_f32_16x16x32_bf16 v[240:243], a[88:91], v[82:85], v[240:243]
    ds_read_b128 v[70:73], v22 offset:38912
    v_mul_f32 v110, v212, v41
    v_mfma_f32_16x16x32_bf16 v[248:251], v[50:53], v[54:57], v[248:251]
    s_add_u32 s74, s20, s0
    v_cndmask_b32 v54, 0, v94, s[52:53]
    v_mov_b32 v94, v96
    v_mul_f32 v218, v210, v218
    v_mfma_f32_16x16x32_bf16 v[248:251], a[92:95], v[82:85], v[248:251]
    s_add_u32 m0, s64, 16384
    v_exp_f32 v110, v110
    v_mfma_f32_16x16x32_bf16 v[244:247], a[88:91], v[86:89], v[244:247]
    ds_read_b128 v[74:77], v23 offset:32768
    v_mul_f32 v111, v213, v41
    v_mfma_f32_16x16x32_bf16 v[244:247], v[46:49], v[54:57], v[244:247]
    v_permlane16_swap_b32 v95, v97
    v_exp_f32 v111, v111
    v_mfma_f32_16x16x32_bf16 v[252:255], a[92:95], v[86:89], v[252:255]
    s_waitcnt lgkmcnt(3)
    v_permlane16_swap_b32 v94, v96
    v_mul_f32 v219, v211, v219
    s_waitcnt vmcnt(8)
    v_cmp_ne_u32 vcc, s54, v20
    s_nop 0
    s_cbranch_vccnz slow_12
back_13:
    s_xor_b32 s66, s66, 256
    v_mfma_f32_16x16x32_bf16 v[224:227], a[96:99], v[58:61], v[224:227]
    ds_read_b128 v[78:81], v23 offset:34816
    v_mul_f32 v112, v214, v41
    v_mfma_f32_16x16x32_bf16 v[252:255], v[50:53], v[54:57], v[252:255]
    v_exp_f32 v112, v112
    v_mul_f32 v220, v212, v220
    v_mfma_f32_16x16x32_bf16 v[232:235], a[100:103], v[58:61], v[232:235]
    buffer_load_dwordx4 v12, s[40:43], s74 offen offset:0 lds
    v_mfma_f32_16x16x32_bf16 v[228:231], a[96:99], v[62:65], v[228:231]
    ds_read_b128 v[82:85], v23 offset:36864
    v_mul_f32 v113, v215, v41
    v_mul_f32 v221, v213, v221
    v_mfma_f32_16x16x32_bf16 v[236:239], a[100:103], v[62:65], v[236:239]
    s_waitcnt lgkmcnt(3)
    buffer_load_dwordx4 v13, s[40:43], s74 offen offset:1024 lds
    v_mfma_f32_16x16x32_bf16 v[240:243], a[96:99], v[66:69], v[240:243]
    ds_read_b128 v[86:89], v23 offset:38912
    v_exp_f32 v113, v113
    v_mfma_f32_16x16x32_bf16 v[248:251], a[100:103], v[66:69], v[248:251]
    ds_read_b128 v[58:61], v22 offset:40960
    v_fma_f32 v106, v106, v38, v38
    v_mfma_f32_16x16x32_bf16 v[244:247], a[96:99], v[70:73], v[244:247]
    ds_read_b128 v[62:65], v22 offset:43008
    v_rcp_f32 v106, v106
    v_mfma_f32_16x16x32_bf16 v[252:255], a[100:103], v[70:73], v[252:255]
    s_waitcnt lgkmcnt(2)
    s_add_u32 s1, s21, s0
    s_add_u32 m0, s64, 24576
    s_nop 0
    buffer_load_dwordx4 v12, s[40:43], s1 offen offset:0 lds
    v_mfma_f32_16x16x32_bf16 v[224:227], a[104:107], v[74:77], v[224:227]
    ds_read_b128 v[66:69], v22 offset:45056
    v_mul_f32 v222, v214, v222
    v_fma_f32 v107, v107, v38, v38
    v_mfma_f32_16x16x32_bf16 v[232:235], a[108:111], v[74:77], v[232:235]
    v_rcp_f32 v107, v107
    v_mfma_f32_16x16x32_bf16 v[228:231], a[104:107], v[78:81], v[228:231]
    ds_read_b128 v[70:73], v22 offset:47104
    v_mul_f32 v223, v215, v223
    v_fma_f32 v108, v108, v38, v38
    v_mfma_f32_16x16x32_bf16 v[236:239], a[108:111], v[78:81], v[236:239]
    ds_read_b128 v[74:77], v23 offset:40960
    v_fma_f32 v109, v109, v38, v38
    v_mfma_f32_16x16x32_bf16 v[240:243], a[104:107], v[82:85], v[240:243]
    ds_read_b128 v[78:81], v23 offset:43008
    v_rcp_f32 v108, v108
    v_mfma_f32_16x16x32_bf16 v[248:251], a[108:111], v[82:85], v[248:251]
    buffer_load_dwordx4 v13, s[40:43], s1 offen offset:1024 lds
    v_mfma_f32_16x16x32_bf16 v[244:247], a[104:107], v[86:89], v[244:247]
    ds_read_b128 v[82:85], v23 offset:45056
    v_rcp_f32 v109, v109
    v_mfma_f32_16x16x32_bf16 v[252:255], a[108:111], v[86:89], v[252:255]
    s_waitcnt lgkmcnt(4)
    v_mul_f32 v106, v216, v106
    v_fma_f32 v110, v110, v40, v40
    v_mfma_f32_16x16x32_bf16 v[224:227], a[112:115], v[58:61], v[224:227]
    ds_read_b128 v[86:89], v23 offset:47104
    v_rcp_f32 v110, v110
    v_mfma_f32_16x16x32_bf16 v[232:235], a[116:119], v[58:61], v[232:235]
    s_add_u32 s75, s12, s8
    buffer_load_dwordx4 a[160:163], v21, s[28:31], s75 offen offset:0 sc1
    v_mfma_f32_16x16x32_bf16 v[228:231], a[112:115], v[62:65], v[228:231]
    v_mul_f32 v107, v217, v107
    v_fma_f32 v111, v111, v40, v40
    v_mul_f32 v108, v218, v108
    v_mfma_f32_16x16x32_bf16 v[236:239], a[116:119], v[62:65], v[236:239]
    v_rcp_f32 v111, v111
    v_mfma_f32_16x16x32_bf16 v[240:243], a[112:115], v[66:69], v[240:243]
    buffer_load_dwordx4 a[164:167], v21, s[28:31], s75 offen offset:256 sc1
    v_fma_f32 v112, v112, v40, v40
    v_mfma_f32_16x16x32_bf16 v[248:251], a[116:119], v[66:69], v[248:251]
    s_waitcnt lgkmcnt(0)
    s_barrier
    v_mfma_f32_16x16x32_bf16 v[244:247], a[112:115], v[70:73], v[244:247]
    ds_read_b128 v[58:61], v22 offset:49152
    v_rcp_f32 v112, v112
    v_mfma_f32_16x16x32_bf16 v[252:255], a[116:119], v[70:73], v[252:255]
    buffer_load_dwordx4 a[168:171], v21, s[28:31], s75 offen offset:2048 sc1
    v_mfma_f32_16x16x32_bf16 v[224:227], a[120:123], v[74:77], v[224:227]
    ds_read_b128 v[62:65], v22 offset:51200
    v_mul_f32 v109, v219, v109
    v_fma_f32 v113, v113, v40, v40
    v_mfma_f32_16x16x32_bf16 v[232:235], a[124:127], v[74:77], v[232:235]
    v_rcp_f32 v113, v113
    v_mfma_f32_16x16x32_bf16 v[228:231], a[120:123], v[78:81], v[228:231]
    ds_read_b128 v[66:69], v22 offset:53248
    v_mul_f32 v110, v220, v110
    v_cvt_pk_bf16_f32 v118, v106, v107
    v_mfma_f32_16x16x32_bf16 v[236:239], a[124:127], v[78:81], v[236:239]
    buffer_load_dwordx4 a[172:175], v21, s[28:31], s75 offen offset:2304 sc1
    v_mfma_f32_16x16x32_bf16 v[240:243], a[120:123], v[82:85], v[240:243]
    ds_read_b128 v[70:73], v22 offset:55296
    v_mul_f32 v111, v221, v111
    v_cvt_pk_bf16_f32 v119, v108, v109
    v_mfma_f32_16x16x32_bf16 v[248:251], a[124:127], v[82:85], v[248:251]
    s_add_u32 s75, s13, s8
    v_mul_f32 v112, v222, v112
    v_cvt_pk_bf16_f32 v120, v110, v111
    v_mfma_f32_16x16x32_bf16 v[244:247], a[120:123], v[86:89], v[244:247]
    ds_read_b128 v[74:77], v23 offset:49152
    v_mul_f32 v113, v223, v113
    v_cvt_pk_bf16_f32 v121, v112, v113
    v_mfma_f32_16x16x32_bf16 v[252:255], a[124:127], v[86:89], v[252:255]
    s_waitcnt lgkmcnt(3)
    buffer_load_dwordx4 a[176:179], v21, s[28:31], s75 offen offset:0 sc1
    v_mfma_f32_16x16x32_bf16 v[224:227], a[128:131], v[58:61], v[224:227]
    ds_read_b128 v[78:81], v23 offset:51200
    v_permlane16_swap_b32 v118, v120
    v_mfma_f32_16x16x32_bf16 v[232:235], a[132:135], v[58:61], v[232:235]
    buffer_load_dwordx4 a[180:183], v21, s[28:31], s75 offen offset:256 sc1
    v_mfma_f32_16x16x32_bf16 v[228:231], a[128:131], v[62:65], v[228:231]
    ds_read_b128 v[82:85], v23 offset:53248
    v_permlane16_swap_b32 v119, v121
    v_mfma_f32_16x16x32_bf16 v[236:239], a[132:135], v[62:65], v[236:239]
    s_waitcnt lgkmcnt(3)
    s_add_u32 s74, s18, s89
    s_add_u32 m0, s64, 32768
    s_nop 0
    buffer_load_dwordx4 v12, s[40:43], s74 offen offset:0 lds
    v_mfma_f32_16x16x32_bf16 v[240:243], a[128:131], v[66:69], v[240:243]
    ds_read_b128 v[86:89], v23 offset:55296
    buffer_store_dwordx4 v[118:121], v25, s[28:31], s82 offen sc1
    v_mfma_f32_16x16x32_bf16 v[248:251], a[132:135], v[66:69], v[248:251]
    ds_read_b128 v[58:61], v22 offset:57344
    v_mfma_f32_16x16x32_bf16 v[244:247], a[128:131], v[70:73], v[244:247]
    ds_read_b128 v[62:65], v22 offset:59392
    v_mfma_f32_16x16x32_bf16 v[252:255], a[132:135], v[70:73], v[252:255]
    s_waitcnt lgkmcnt(2)
    buffer_load_dwordx4 v13, s[40:43], s74 offen offset:1024 lds
    v_mfma_f32_16x16x32_bf16 v[224:227], a[136:139], v[74:77], v[224:227]
    ds_read_b128 v[66:69], v22 offset:61440
    s_add_u32 s1, s19, s89
    s_add_u32 m0, s64, 40960
    v_mfma_f32_16x16x32_bf16 v[232:235], a[140:143], v[74:77], v[232:235]
    v_mfma_f32_16x16x32_bf16 v[228:231], a[136:139], v[78:81], v[228:231]
    ds_read_b128 v[70:73], v22 offset:63488
    v_mfma_f32_16x16x32_bf16 v[236:239], a[140:143], v[78:81], v[236:239]
    ds_read_b128 v[74:77], v23 offset:57344
    v_mfma_f32_16x16x32_bf16 v[240:243], a[136:139], v[82:85], v[240:243]
    ds_read_b128 v[78:81], v23 offset:59392
    v_mfma_f32_16x16x32_bf16 v[248:251], a[140:143], v[82:85], v[248:251]
    buffer_load_dwordx4 v12, s[40:43], s1 offen offset:0 lds
    v_mfma_f32_16x16x32_bf16 v[244:247], a[136:139], v[86:89], v[244:247]
    ds_read_b128 v[82:85], v23 offset:61440
    v_mfma_f32_16x16x32_bf16 v[252:255], a[140:143], v[86:89], v[252:255]
    s_waitcnt lgkmcnt(4)
    v_mfma_f32_16x16x32_bf16 v[224:227], a[144:147], v[58:61], v[224:227]
    ds_read_b128 v[86:89], v23 offset:63488
    v_mfma_f32_16x16x32_bf16 v[232:235], a[148:151], v[58:61], v[232:235]
    buffer_load_dword v20, v18, s[28:31], s66 offen sc1
    v_mfma_f32_16x16x32_bf16 v[228:231], a[144:147], v[62:65], v[228:231]
    v_mfma_f32_16x16x32_bf16 v[236:239], a[148:151], v[62:65], v[236:239]
    v_mfma_f32_16x16x32_bf16 v[240:243], a[144:147], v[66:69], v[240:243]
    buffer_load_dwordx4 v13, s[40:43], s1 offen offset:1024 lds
    v_mfma_f32_16x16x32_bf16 v[248:251], a[148:151], v[66:69], v[248:251]
    s_waitcnt vmcnt(22) lgkmcnt(0)
    s_barrier
    v_mfma_f32_16x16x32_bf16 v[244:247], a[144:147], v[70:73], v[244:247]
    v_mfma_f32_16x16x32_bf16 v[252:255], a[148:151], v[70:73], v[252:255]
    buffer_load_dwordx4 a[184:187], v21, s[28:31], s75 offen offset:2048 sc1
    v_mfma_f32_16x16x32_bf16 v[224:227], a[152:155], v[74:77], v[224:227]
    v_mfma_f32_16x16x32_bf16 v[232:235], a[156:159], v[74:77], v[232:235]
    v_mfma_f32_16x16x32_bf16 v[228:231], a[152:155], v[78:81], v[228:231]
    v_mfma_f32_16x16x32_bf16 v[236:239], a[156:159], v[78:81], v[236:239]
    buffer_load_dwordx4 a[188:191], v21, s[28:31], s75 offen offset:2304 sc1
    v_mfma_f32_16x16x32_bf16 v[240:243], a[152:155], v[82:85], v[240:243]
    s_add_u32 s75, s14, s8
    v_mfma_f32_16x16x32_bf16 v[248:251], a[156:159], v[82:85], v[248:251]
    v_mfma_f32_16x16x32_bf16 v[244:247], a[152:155], v[86:89], v[244:247]
    v_mfma_f32_16x16x32_bf16 v[252:255], a[156:159], v[86:89], v[252:255]
    buffer_load_dwordx4 a[192:195], v21, s[28:31], s75 offen offset:0 sc1
    v_pk_mul_f32 v[106:107], v[224:225], v[90:91] op_sel:[0,1] op_sel_hi:[1,1]
    v_pk_mul_f32 v[108:109], v[226:227], v[90:91] op_sel:[0,1] op_sel_hi:[1,1]
    v_pk_mul_f32 v[110:111], v[228:229], v[92:93] op_sel:[0,1] op_sel_hi:[1,1]
    v_pk_mul_f32 v[112:113], v[230:231], v[92:93] op_sel:[0,1] op_sel_hi:[1,1]
    v_exp_f32 v106, v106
    v_exp_f32 v107, v107
    v_exp_f32 v108, v108
    v_exp_f32 v109, v109
    v_exp_f32 v110, v110
    buffer_load_dwordx4 a[196:199], v21, s[28:31], s75 offen offset:256 sc1
    v_exp_f32 v111, v111
    v_exp_f32 v112, v112
    v_exp_f32 v113, v113
    v_pk_mul_f32 v[232:233], v[224:225], v[232:233]
    v_pk_mul_f32 v[234:235], v[226:227], v[234:235]
    v_pk_mul_f32 v[236:237], v[228:229], v[236:237]
    v_pk_mul_f32 v[238:239], v[230:231], v[238:239]
    v_pk_fma_f32 v[106:107], v[106:107], v[90:91], v[90:91] op_sel:[0,0,0] op_sel_hi:[1,0,0]
    v_pk_fma_f32 v[108:109], v[108:109], v[90:91], v[90:91] op_sel:[0,0,0] op_sel_hi:[1,0,0]
    v_pk_fma_f32 v[110:111], v[110:111], v[92:93], v[92:93] op_sel:[0,0,0] op_sel_hi:[1,0,0]
    buffer_load_dwordx4 a[200:203], v21, s[28:31], s75 offen offset:2048 sc1
    v_pk_fma_f32 v[112:113], v[112:113], v[92:93], v[92:93] op_sel:[0,0,0] op_sel_hi:[1,0,0]
    v_rcp_f32 v106, v106
    v_rcp_f32 v107, v107
    v_rcp_f32 v108, v108
    v_rcp_f32 v109, v109
    v_rcp_f32 v110, v110
    v_rcp_f32 v111, v111
    buffer_load_dwordx4 a[204:207], v21, s[28:31], s75 offen offset:2304 sc1
    v_rcp_f32 v112, v112
    v_rcp_f32 v113, v113
    v_pk_mul_f32 v[106:107], v[232:233], v[106:107]
    v_pk_mul_f32 v[108:109], v[234:235], v[108:109]
    v_pk_mul_f32 v[110:111], v[236:237], v[110:111]
    v_pk_mul_f32 v[112:113], v[238:239], v[112:113]
    v_cvt_pk_bf16_f32 v114, v106, v107
    v_cvt_pk_bf16_f32 v116, v110, v111
    v_cvt_pk_bf16_f32 v115, v108, v109
    v_cvt_pk_bf16_f32 v117, v112, v113
    v_permlane16_swap_b32 v114, v116
    s_add_u32 s75, s15, s8
    buffer_load_dwordx4 a[0:3], v21, s[28:31], s75 offen offset:0 sc1
    v_permlane16_swap_b32 v115, v117
    buffer_store_dwordx4 v[114:117], v24, s[28:31], s83 offen sc1
    v_pk_mul_f32 v[106:107], v[240:241], v[94:95] op_sel:[0,1] op_sel_hi:[1,1]
    v_pk_mul_f32 v[108:109], v[242:243], v[94:95] op_sel:[0,1] op_sel_hi:[1,1]
    v_pk_mul_f32 v[110:111], v[244:245], v[96:97] op_sel:[0,1] op_sel_hi:[1,1]
    v_pk_mul_f32 v[112:113], v[246:247], v[96:97] op_sel:[0,1] op_sel_hi:[1,1]
    v_exp_f32 v106, v106
    v_exp_f32 v107, v107
    v_exp_f32 v108, v108
    buffer_load_dwordx4 a[4:7], v21, s[28:31], s75 offen offset:256 sc1
    v_exp_f32 v109, v109
    v_exp_f32 v110, v110
    v_exp_f32 v111, v111
    v_exp_f32 v112, v112
    v_exp_f32 v113, v113
    v_pk_mul_f32 v[248:249], v[240:241], v[248:249]
    v_pk_mul_f32 v[250:251], v[242:243], v[250:251]
    v_pk_mul_f32 v[252:253], v[244:245], v[252:253]
    buffer_load_dwordx4 a[8:11], v21, s[28:31], s75 offen offset:2048 sc1
    v_pk_mul_f32 v[254:255], v[246:247], v[254:255]
    v_pk_fma_f32 v[106:107], v[106:107], v[94:95], v[94:95] op_sel:[0,0,0] op_sel_hi:[1,0,0]
    v_pk_fma_f32 v[108:109], v[108:109], v[94:95], v[94:95] op_sel:[0,0,0] op_sel_hi:[1,0,0]
    v_pk_fma_f32 v[110:111], v[110:111], v[96:97], v[96:97] op_sel:[0,0,0] op_sel_hi:[1,0,0]
    v_pk_fma_f32 v[112:113], v[112:113], v[96:97], v[96:97] op_sel:[0,0,0] op_sel_hi:[1,0,0]
    v_rcp_f32 v106, v106
    v_rcp_f32 v107, v107
    v_rcp_f32 v108, v108
    v_rcp_f32 v109, v109
    buffer_load_dwordx4 a[12:15], v21, s[28:31], s75 offen offset:2304 sc1
    v_rcp_f32 v110, v110
    v_rcp_f32 v111, v111
    v_rcp_f32 v112, v112
    ds_read_b64_tr_b16 v[58:59], v26 offset:0
    ds_read_b64_tr_b16 v[60:61], v26 offset:512
    ds_read_b64_tr_b16 v[62:63], v27 offset:0
    ds_read_b64_tr_b16 v[64:65], v27 offset:512
    ds_read_b64_tr_b16 v[66:67], v28 offset:0
    ds_read_b64_tr_b16 v[68:69], v28 offset:512
    ds_read_b64_tr_b16 v[70:71], v29 offset:0
    ds_read_b64_tr_b16 v[72:73], v29 offset:512
    v_rcp_f32 v113, v113
    v_pk_mul_f32 v[106:107], v[248:249], v[106:107]
    v_pk_mul_f32 v[108:109], v[250:251], v[108:109]
    v_pk_mul_f32 v[110:111], v[252:253], v[110:111]
    v_pk_mul_f32 v[112:113], v[254:255], v[112:113]
    v_cvt_pk_bf16_f32 v118, v106, v107
    s_add_u32 s75, s16, s8
    buffer_load_dwordx4 a[16:19], v21, s[28:31], s75 offen offset:0 sc1
    v_cvt_pk_bf16_f32 v120, v110, v111
    v_cvt_pk_bf16_f32 v119, v108, v109
    v_cvt_pk_bf16_f32 v121, v112, v113
    v_permlane16_swap_b32 v118, v120
    s_nop 0
    v_permlane16_swap_b32 v119, v121
    buffer_store_dwordx4 v[118:121], v25, s[28:31], s83 offen sc1
    s_cmp_ge_u32 s49, 20
    s_cbranch_scc1 k_help
    s_waitcnt vmcnt(23) lgkmcnt(4)
    v_mfma_f32_16x16x32_bf16 v[128:131], v[58:61], a[160:163], 0
    ds_read_b64_tr_b16 v[74:75], v26 offset:4096
    s_add_u32 s74, s20, s89
    v_mfma_f32_16x16x32_bf16 v[132:135], v[58:61], a[164:167], 0
    ds_read_b64_tr_b16 v[76:77], v26 offset:4608
    s_add_u32 m0, s64, 49152
    v_mfma_f32_16x16x32_bf16 v[136:139], v[62:65], a[160:163], 0
    ds_read_b64_tr_b16 v[78:79], v27 offset:4096
    s_lshr_b32 s53, s3, 1
    v_mfma_f32_16x16x32_bf16 v[140:143], v[62:65], a[164:167], 0
    s_waitcnt lgkmcnt(3)
    ds_read_b64_tr_b16 v[80:81], v27 offset:4608
    buffer_load_dwordx4 v12, s[40:43], s74 offen offset:0 lds
    v_mfma_f32_16x16x32_bf16 v[144:147], v[66:69], a[160:163], 0
    ds_read_b64_tr_b16 v[82:83], v28 offset:4096
    s_mul_i32 s50, s53, 49152
    v_mfma_f32_16x16x32_bf16 v[148:151], v[66:69], a[164:167], 0
    ds_read_b64_tr_b16 v[84:85], v28 offset:4608
    s_sub_u32 s50, 114688, s50
    v_mfma_f32_16x16x32_bf16 v[152:155], v[70:73], a[160:163], 0
    ds_read_b64_tr_b16 v[86:87], v29 offset:4096
    v_add_u32 v42, s50, v32
    v_mfma_f32_16x16x32_bf16 v[156:159], v[70:73], a[164:167], 0
    s_waitcnt vmcnt(22) lgkmcnt(3)
    ds_read_b64_tr_b16 v[88:89], v29 offset:4608
    buffer_load_dwordx4 v13, s[40:43], s74 offen offset:1024 lds
    s_waitcnt vmcnt(19)
    v_mov_b32 v8, s54
    s_mov_b64 exec, 1
    buffer_store_dword v8, off, s[28:31], s65 sc1
    s_mov_b64 exec, -1
    s_xor_b32 s65, s65, 512
    v_mfma_f32_16x16x32_bf16 v[128:131], v[74:77], a[168:171], v[128:131]
    ds_read_b64_tr_b16 v[58:59], v26 offset:8192
    s_add_u32 s1, s21, s89
    v_mfma_f32_16x16x32_bf16 v[132:135], v[74:77], a[172:175], v[132:135]
    ds_read_b64_tr_b16 v[60:61], v26 offset:8704
    s_add_u32 m0, s64, 57344
    v_mfma_f32_16x16x32_bf16 v[136:139], v[78:81], a[168:171], v[136:139]
    ds_read_b64_tr_b16 v[62:63], v27 offset:8192
    v_xor_b32 v43, 32, v42
    v_mfma_f32_16x16x32_bf16 v[140:143], v[78:81], a[172:175], v[140:143]
    s_waitcnt lgkmcnt(3)
    ds_read_b64_tr_b16 v[64:65], v27 offset:8704
    buffer_load_dwordx4 v12, s[40:43], s1 offen offset:0 lds
    v_mfma_f32_16x16x32_bf16 v[144:147], v[82:85], a[168:171], v[144:147]
    ds_read_b64_tr_b16 v[66:67], v28 offset:8192
    v_xor_b32 v44, 64, v42
    v_mfma_f32_16x16x32_bf16 v[148:151], v[82:85], a[172:175], v[148:151]
    ds_read_b64_tr_b16 v[68:69], v28 offset:8704
    buffer_load_dwordx4 a[20:23], v21, s[28:31], s75 offen offset:256 sc1
    v_mfma_f32_16x16x32_bf16 v[152:155], v[86:89], a[168:171], v[152:155]
    ds_read_b64_tr_b16 v[70:71], v29 offset:8192
    v_xor_b32 v45, 96, v42
    v_mfma_f32_16x16x32_bf16 v[156:159], v[86:89], a[172:175], v[156:159]
    s_waitcnt lgkmcnt(3)
    ds_read_b64_tr_b16 v[72:73], v29 offset:8704
    buffer_load_dwordx4 v13, s[40:43], s1 offen offset:1024 lds
    v_mfma_f32_16x16x32_bf16 v[128:131], v[58:61], a[176:179], v[128:131]
    ds_read_b64_tr_b16 v[74:75], v26 offset:12288
    s_lshl_b32 s50, s53, 15
    v_mfma_f32_16x16x32_bf16 v[132:135], v[58:61], a[180:183], v[132:135]
    ds_read_b64_tr_b16 v[76:77], v26 offset:12800
    buffer_load_dwordx4 a[24:27], v21, s[28:31], s75 offen offset:2048 sc1
    v_mfma_f32_16x16x32_bf16 v[136:139], v[62:65], a[176:179], v[136:139]
    ds_read_b64_tr_b16 v[78:79], v27 offset:12288
    v_add_u32 v54, s50, v32
    v_mfma_f32_16x16x32_bf16 v[140:143], v[62:65], a[180:183], v[140:143]
    s_waitcnt lgkmcnt(3)
    ds_read_b64_tr_b16 v[80:81], v27 offset:12800
    v_mfma_f32_16x16x32_bf16 v[144:147], v[66:69], a[176:179], v[144:147]
    ds_read_b64_tr_b16 v[82:83], v28 offset:12288
    v_xor_b32 v55, 32, v54
    v_mfma_f32_16x16x32_bf16 v[148:151], v[66:69], a[180:183], v[148:151]
    ds_read_b64_tr_b16 v[84:85], v28 offset:12800
    buffer_load_dwordx4 a[28:31], v21, s[28:31], s75 offen offset:2304 sc1
    v_mfma_f32_16x16x32_bf16 v[152:155], v[70:73], a[176:179], v[152:155]
    ds_read_b64_tr_b16 v[86:87], v29 offset:12288
    v_xor_b32 v56, 64, v54
    v_mfma_f32_16x16x32_bf16 v[156:159], v[70:73], a[180:183], v[156:159]
    s_waitcnt vmcnt(19) lgkmcnt(3)
    ds_read_b64_tr_b16 v[88:89], v29 offset:12800
    v_mfma_f32_16x16x32_bf16 v[128:131], v[74:77], a[184:187], v[128:131]
    ds_read_b64_tr_b16 v[58:59], v26 offset:16384
    s_add_u32 s75, s17, s8
    v_mfma_f32_16x16x32_bf16 v[132:135], v[74:77], a[188:191], v[132:135]
    ds_read_b64_tr_b16 v[60:61], v26 offset:16896
    buffer_load_dwordx4 a[32:35], v21, s[28:31], s75 offen offset:0 sc1
    v_mfma_f32_16x16x32_bf16 v[136:139], v[78:81], a[184:187], v[136:139]
    ds_read_b64_tr_b16 v[62:63], v27 offset:16384
    v_xor_b32 v57, 96, v54
    v_mfma_f32_16x16x32_bf16 v[140:143], v[78:81], a[188:191], v[140:143]
    s_waitcnt lgkmcnt(3)
    ds_read_b64_tr_b16 v[64:65], v27 offset:16896
    v_mfma_f32_16x16x32_bf16 v[144:147], v[82:85], a[184:187], v[144:147]
    ds_read_b64_tr_b16 v[66:67], v28 offset:16384
    s_xor_b32 s50, s50, 32768
    v_mfma_f32_16x16x32_bf16 v[148:151], v[82:85], a[188:191], v[148:151]
    ds_read_b64_tr_b16 v[68:69], v28 offset:16896
    buffer_load_dwordx4 a[36:39], v21, s[28:31], s75 offen offset:256 sc1
    v_mfma_f32_16x16x32_bf16 v[152:155], v[86:89], a[184:187], v[152:155]
    ds_read_b64_tr_b16 v[70:71], v29 offset:16384
    v_add_u32 v106, s50, v32
    v_mfma_f32_16x16x32_bf16 v[156:159], v[86:89], a[188:191], v[156:159]
    s_waitcnt vmcnt(19) lgkmcnt(3)
    ds_read_b64_tr_b16 v[72:73], v29 offset:16896
    v_mfma_f32_16x16x32_bf16 v[128:131], v[58:61], a[192:195], v[128:131]
    ds_read_b64_tr_b16 v[74:75], v26 offset:20480
    v_xor_b32 v107, 32, v106
    v_mfma_f32_16x16x32_bf16 v[132:135], v[58:61], a[196:199], v[132:135]
    ds_read_b64_tr_b16 v[76:77], v26 offset:20992
    buffer_load_dwordx4 a[40:43], v21, s[28:31], s75 offen offset:2048 sc1
    v_mfma_f32_16x16x32_bf16 v[136:139], v[62:65], a[192:195], v[136:139]
    ds_read_b64_tr_b16 v[78:79], v27 offset:20480
    v_xor_b32 v108, 64, v106
    v_mfma_f32_16x16x32_bf16 v[140:143], v[62:65], a[196:199], v[140:143]
    s_waitcnt lgkmcnt(3)
    ds_read_b64_tr_b16 v[80:81], v27 offset:20992
    v_mfma_f32_16x16x32_bf16 v[144:147], v[66:69], a[192:195], v[144:147]
    ds_read_b64_tr_b16 v[82:83], v28 offset:20480
    v_xor_b32 v109, 96, v106
    v_mfma_f32_16x16x32_bf16 v[148:151], v[66:69], a[196:199], v[148:151]
    ds_read_b64_tr_b16 v[84:85], v28 offset:20992
    buffer_load_dwordx4 a[44:47], v21, s[28:31], s75 offen offset:2304 sc1
    v_mfma_f32_16x16x32_bf16 v[152:155], v[70:73], a[192:195], v[152:155]
    ds_read_b64_tr_b16 v[86:87], v29 offset:20480
    s_lshl_b32 s50, s53, 14
    v_mfma_f32_16x16x32_bf16 v[156:159], v[70:73], a[196:199], v[156:159]
    s_waitcnt vmcnt(19) lgkmcnt(3)
    ds_read_b64_tr_b16 v[88:89], v29 offset:20992
    v_cmp_ne_u32 vcc, s54, v20
    s_nop 0
    s_cbranch_vccnz slow_15
back_16:
    s_xor_b32 s66, s66, 384
    v_mfma_f32_16x16x32_bf16 v[128:131], v[74:77], a[200:203], v[128:131]
    ds_read_b64_tr_b16 v[58:59], v26 offset:24576
    s_add_u32 s75, s12, s9
    v_mfma_f32_16x16x32_bf16 v[132:135], v[74:77], a[204:207], v[132:135]
    ds_read_b64_tr_b16 v[60:61], v26 offset:25088
    buffer_load_dwordx4 a[48:51], v21, s[28:31], s75 offen offset:0 sc1
    v_mfma_f32_16x16x32_bf16 v[136:139], v[78:81], a[200:203], v[136:139]
    ds_read_b64_tr_b16 v[62:63], v27 offset:24576
    s_add_u32 s50, s50, 131072
    v_mfma_f32_16x16x32_bf16 v[140:143], v[78:81], a[204:207], v[140:143]
    s_waitcnt lgkmcnt(3)
    ds_read_b64_tr_b16 v[64:65], v27 offset:25088
    v_mfma_f32_16x16x32_bf16 v[144:147], v[82:85], a[200:203], v[144:147]
    ds_read_b64_tr_b16 v[66:67], v28 offset:24576
    v_add_u32 v110, s50, v32
    v_mfma_f32_16x16x32_bf16 v[148:151], v[82:85], a[204:207], v[148:151]
    ds_read_b64_tr_b16 v[68:69], v28 offset:25088
    buffer_load_dwordx4 a[52:55], v21, s[28:31], s75 offen offset:256 sc1
    v_mfma_f32_16x16x32_bf16 v[152:155], v[86:89], a[200:203], v[152:155]
    ds_read_b64_tr_b16 v[70:71], v29 offset:24576
    v_xor_b32 v111, 32, v110
    v_mfma_f32_16x16x32_bf16 v[156:159], v[86:89], a[204:207], v[156:159]
    s_waitcnt vmcnt(18) lgkmcnt(3)
    ds_read_b64_tr_b16 v[72:73], v29 offset:25088
    v_mfma_f32_16x16x32_bf16 v[128:131], v[58:61], a[0:3], v[128:131]
    ds_read_b64_tr_b16 v[74:75], v26 offset:28672
    v_xor_b32 v112, 64, v110
    v_mfma_f32_16x16x32_bf16 v[132:135], v[58:61], a[4:7], v[132:135]
    ds_read_b64_tr_b16 v[76:77], v26 offset:29184
    buffer_load_dwordx4 a[56:59], v21, s[28:31], s75 offen offset:2048 sc1
    v_mfma_f32_16x16x32_bf16 v[136:139], v[62:65], a[0:3], v[136:139]
    ds_read_b64_tr_b16 v[78:79], v27 offset:28672
    v_xor_b32 v113, 96, v110
    v_mfma_f32_16x16x32_bf16 v[140:143], v[62:65], a[4:7], v[140:143]
    s_waitcnt lgkmcnt(3)
    ds_read_b64_tr_b16 v[80:81], v27 offset:29184
    v_mfma_f32_16x16x32_bf16 v[144:147], v[66:69], a[0:3], v[144:147]
    ds_read_b64_tr_b16 v[82:83], v28 offset:28672
    s_add_u32 s50, s62, 81920
    v_mfma_f32_16x16x32_bf16 v[148:151], v[66:69], a[4:7], v[148:151]
    ds_read_b64_tr_b16 v[84:85], v28 offset:29184
    buffer_load_dwordx4 a[60:63], v21, s[28:31], s75 offen offset:2304 sc1
    v_mfma_f32_16x16x32_bf16 v[152:155], v[70:73], a[0:3], v[152:155]
    ds_read_b64_tr_b16 v[86:87], v29 offset:28672
    v_add_u32 v38, s50, v24
    v_mfma_f32_16x16x32_bf16 v[156:159], v[70:73], a[4:7], v[156:159]
    s_waitcnt vmcnt(18) lgkmcnt(3)
    ds_read_b64_tr_b16 v[88:89], v29 offset:29184
    s_waitcnt vmcnt(16)
    v_mov_b32 v8, s54
    s_mov_b64 exec, 1
    buffer_store_dword v8, off, s[28:31], s65 sc1
    s_mov_b64 exec, -1
    v_mfma_f32_16x16x32_bf16 v[128:131], v[74:77], a[8:11], v[128:131]
    ds_read_b64_tr_b16 v[58:59], v26 offset:32768
    s_add_u32 s75, s13, s9
    v_mfma_f32_16x16x32_bf16 v[132:135], v[74:77], a[12:15], v[132:135]
    ds_read_b64_tr_b16 v[60:61], v26 offset:33280
    buffer_load_dwordx4 a[64:67], v21, s[28:31], s75 offen offset:0 sc1
    v_mfma_f32_16x16x32_bf16 v[136:139], v[78:81], a[8:11], v[136:139]
    ds_read_b64_tr_b16 v[62:63], v27 offset:32768
    v_mov_b32 v34, v33
    v_mfma_f32_16x16x32_bf16 v[140:143], v[78:81], a[12:15], v[140:143]
    s_waitcnt lgkmcnt(3)
    ds_read_b64_tr_b16 v[64:65], v27 offset:33280
    v_mfma_f32_16x16x32_bf16 v[144:147], v[82:85], a[8:11], v[144:147]
    ds_read_b64_tr_b16 v[66:67], v28 offset:32768
    v_xor_b32 v35, 32, v33
    v_mfma_f32_16x16x32_bf16 v[148:151], v[82:85], a[12:15], v[148:151]
    ds_read_b64_tr_b16 v[68:69], v28 offset:33280
    buffer_load_dwordx4 a[68:71], v21, s[28:31], s75 offen offset:256 sc1
    v_mfma_f32_16x16x32_bf16 v[152:155], v[86:89], a[8:11], v[152:155]
    ds_read_b64_tr_b16 v[70:71], v29 offset:32768
    v_xor_b32 v36, 64, v33
    v_mfma_f32_16x16x32_bf16 v[156:159], v[86:89], a[12:15], v[156:159]
    s_waitcnt vmcnt(14) lgkmcnt(3)
    ds_read_b64_tr_b16 v[72:73], v29 offset:33280
    v_mfma_f32_16x16x32_bf16 v[128:131], v[58:61], a[16:19], v[128:131]
    ds_read_b64_tr_b16 v[74:75], v26 offset:36864
    v_xor_b32 v37, 96, v33
    v_mfma_f32_16x16x32_bf16 v[132:135], v[58:61], a[20:23], v[132:135]
    ds_read_b64_tr_b16 v[76:77], v26 offset:37376
    buffer_load_dwordx4 a[72:75], v21, s[28:31], s75 offen offset:2048 sc1
ffn_pg4:
    s_cbranch_execz ffn_ret
    v_mfma_f32_16x16x32_bf16 v[136:139], v[62:65], a[16:19], v[136:139]
    ds_read_b64_tr_b16 v[78:79], v27 offset:36864
    v_mov_b32 v46, 0xbfb8aa3b
    v_mfma_f32_16x16x32_bf16 v[140:143], v[62:65], a[20:23], v[140:143]
    s_waitcnt lgkmcnt(3)
    ds_read_b64_tr_b16 v[80:81], v27 offset:37376
    v_mfma_f32_16x16x32_bf16 v[144:147], v[66:69], a[16:19], v[144:147]
    ds_read_b64_tr_b16 v[82:83], v28 offset:36864
    v_mov_b32 v47, 0x49200000
    v_mfma_f32_16x16x32_bf16 v[148:151], v[66:69], a[20:23], v[148:151]
    ds_read_b64_tr_b16 v[84:85], v28 offset:37376
    buffer_load_dwordx4 a[76:79], v21, s[28:31], s75 offen offset:2304 sc1
    v_mfma_f32_16x16x32_bf16 v[152:155], v[70:73], a[16:19], v[152:155]
    ds_read_b64_tr_b16 v[86:87], v29 offset:36864
    s_lshl_b32 s63, s3, 13
    v_mfma_f32_16x16x32_bf16 v[156:159], v[70:73], a[20:23], v[156:159]
    s_waitcnt vmcnt(13) lgkmcnt(3)
    ds_read_b64_tr_b16 v[88:89], v29 offset:37376
    v_mfma_f32_16x16x32_bf16 v[128:131], v[74:77], a[24:27], v[128:131]
    ds_read_b64_tr_b16 v[58:59], v26 offset:40960
    s_add_u32 s75, s14, s9
    v_mfma_f32_16x16x32_bf16 v[132:135], v[74:77], a[28:31], v[132:135]
    ds_read_b64_tr_b16 v[60:61], v26 offset:41472
    buffer_load_dwordx4 a[80:83], v21, s[28:31], s75 offen offset:0 sc1
    v_mfma_f32_16x16x32_bf16 v[136:139], v[78:81], a[24:27], v[136:139]
    ds_read_b64_tr_b16 v[62:63], v27 offset:40960
    v_mfma_f32_16x16x32_bf16 v[140:143], v[78:81], a[28:31], v[140:143]
    s_waitcnt lgkmcnt(3)
    ds_read_b64_tr_b16 v[64:65], v27 offset:41472
    v_mfma_f32_16x16x32_bf16 v[144:147], v[82:85], a[24:27], v[144:147]
    ds_read_b64_tr_b16 v[66:67], v28 offset:40960
    v_mfma_f32_16x16x32_bf16 v[148:151], v[82:85], a[28:31], v[148:151]
    ds_read_b64_tr_b16 v[68:69], v28 offset:41472
    buffer_load_dwordx4 a[84:87], v21, s[28:31], s75 offen offset:256 sc1
    v_mfma_f32_16x16x32_bf16 v[152:155], v[86:89], a[24:27], v[152:155]
    ds_read_b64_tr_b16 v[70:71], v29 offset:40960
    v_mfma_f32_16x16x32_bf16 v[156:159], v[86:89], a[28:31], v[156:159]
    s_waitcnt vmcnt(13) lgkmcnt(3)
    ds_read_b64_tr_b16 v[72:73], v29 offset:41472
    v_mfma_f32_16x16x32_bf16 v[128:131], v[58:61], a[32:35], v[128:131]
    ds_read_b64_tr_b16 v[74:75], v26 offset:45056
    v_mfma_f32_16x16x32_bf16 v[132:135], v[58:61], a[36:39], v[132:135]
    ds_read_b64_tr_b16 v[76:77], v26 offset:45568
    buffer_load_dwordx4 a[88:91], v21, s[28:31], s75 offen offset:2048 sc1
    v_mfma_f32_16x16x32_bf16 v[136:139], v[62:65], a[32:35], v[136:139]
    ds_read_b64_tr_b16 v[78:79], v27 offset:45056
    v_mfma_f32_16x16x32_bf16 v[140:143], v[62:65], a[36:39], v[140:143]
    s_waitcnt lgkmcnt(3)
    ds_read_b64_tr_b16 v[80:81], v27 offset:45568
    v_mfma_f32_16x16x32_bf16 v[144:147], v[66:69], a[32:35], v[144:147]
    ds_read_b64_tr_b16 v[82:83], v28 offset:45056
    v_mfma_f32_16x16x32_bf16 v[148:151], v[66:69], a[36:39], v[148:151]
    ds_read_b64_tr_b16 v[84:85], v28 offset:45568
    buffer_load_dwordx4 a[92:95], v21, s[28:31], s75 offen offset:2304 sc1
    v_mfma_f32_16x16x32_bf16 v[152:155], v[70:73], a[32:35], v[152:155]
    ds_read_b64_tr_b16 v[86:87], v29 offset:45056
    v_mfma_f32_16x16x32_bf16 v[156:159], v[70:73], a[36:39], v[156:159]
    s_waitcnt vmcnt(13) lgkmcnt(3)
    ds_read_b64_tr_b16 v[88:89], v29 offset:45568
    buffer_load_dword v20, v18, s[28:31], s66 offen sc1
    v_mfma_f32_16x16x32_bf16 v[128:131], v[74:77], a[40:43], v[128:131]
    ds_read_b64_tr_b16 v[58:59], v42 offset:0
    s_add_u32 s75, s15, s9
    v_mfma_f32_16x16x32_bf16 v[132:135], v[74:77], a[44:47], v[132:135]
    ds_read_b64_tr_b16 v[60:61], v42 offset:512
    buffer_load_dwordx4 a[96:99], v21, s[28:31], s75 offen offset:0 sc1
    v_mfma_f32_16x16x32_bf16 v[136:139], v[78:81], a[40:43], v[136:139]
    ds_read_b64_tr_b16 v[62:63], v43 offset:0
    v_mfma_f32_16x16x32_bf16 v[140:143], v[78:81], a[44:47], v[140:143]
    s_waitcnt lgkmcnt(3)
    ds_read_b64_tr_b16 v[64:65], v43 offset:512
    v_mfma_f32_16x16x32_bf16 v[144:147], v[82:85], a[40:43], v[144:147]
    ds_read_b64_tr_b16 v[66:67], v44 offset:0
    v_mfma_f32_16x16x32_bf16 v[148:151], v[82:85], a[44:47], v[148:151]
    ds_read_b64_tr_b16 v[68:69], v44 offset:512
    buffer_load_dwordx4 a[100:103], v21, s[28:31], s75 offen offset:256 sc1
    v_mfma_f32_16x16x32_bf16 v[152:155], v[86:89], a[40:43], v[152:155]
    ds_read_b64_tr_b16 v[70:71], v45 offset:0
    v_mfma_f32_16x16x32_bf16 v[156:159], v[86:89], a[44:47], v[156:159]
    s_waitcnt vmcnt(14) lgkmcnt(3)
    ds_read_b64_tr_b16 v[72:73], v45 offset:512
    v_mfma_f32_16x16x32_bf16 v[128:131], v[58:61], a[48:51], v[128:131]
    ds_read_b64_tr_b16 v[74:75], v42 offset:4096
    v_mfma_f32_16x16x32_bf16 v[132:135], v[58:61], a[52:55], v[132:135]
    ds_read_b64_tr_b16 v[76:77], v42 offset:4608
    buffer_load_dwordx4 a[104:107], v21, s[28:31], s75 offen offset:2048 sc1
    v_mfma_f32_16x16x32_bf16 v[136:139], v[62:65], a[48:51], v[136:139]
    ds_read_b64_tr_b16 v[78:79], v43 offset:4096
    v_mfma_f32_16x16x32_bf16 v[140:143], v[62:65], a[52:55], v[140:143]
    s_waitcnt lgkmcnt(3)
    ds_read_b64_tr_b16 v[80:81], v43 offset:4608
    v_mfma_f32_16x16x32_bf16 v[144:147], v[66:69], a[48:51], v[144:147]
    ds_read_b64_tr_b16 v[82:83], v44 offset:4096
    v_mfma_f32_16x16x32_bf16 v[148:151], v[66:69], a[52:55], v[148:151]
    ds_read_b64_tr_b16 v[84:85], v44 offset:4608
    buffer_load_dwordx4 a[108:111], v21, s[28:31], s75 offen offset:2304 sc1
    v_mfma_f32_16x16x32_bf16 v[152:155], v[70:73], a[48:51], v[152:155]
    ds_read_b64_tr_b16 v[86:87], v45 offset:4096
    v_mfma_f32_16x16x32_bf16 v[156:159], v[70:73], a[52:55], v[156:159]
    s_waitcnt vmcnt(14) lgkmcnt(3)
    ds_read_b64_tr_b16 v[88:89], v45 offset:4608
    v_mfma_f32_16x16x32_bf16 v[128:131], v[74:77], a[56:59], v[128:131]
    ds_read_b64_tr_b16 v[58:59], v42 offset:8192
    s_add_u32 s75, s16, s9
    v_mfma_f32_16x16x32_bf16 v[132:135], v[74:77], a[60:63], v[132:135]
    ds_read_b64_tr_b16 v[60:61], v42 offset:8704
    buffer_load_dwordx4 a[112:115], v21, s[28:31], s75 offen offset:0 sc1
    v_mfma_f32_16x16x32_bf16 v[136:139], v[78:81], a[56:59], v[136:139]
    ds_read_b64_tr_b16 v[62:63], v43 offset:8192
    v_mfma_f32_16x16x32_bf16 v[140:143], v[78:81], a[60:63], v[140:143]
    s_waitcnt lgkmcnt(3)
    ds_read_b64_tr_b16 v[64:65], v43 offset:8704
    v_mfma_f32_16x16x32_bf16 v[144:147], v[82:85], a[56:59], v[144:147]
    ds_read_b64_tr_b16 v[66:67], v44 offset:8192
    v_mfma_f32_16x16x32_bf16 v[148:151], v[82:85], a[60:63], v[148:151]
    ds_read_b64_tr_b16 v[68:69], v44 offset:8704
    buffer_load_dwordx4 a[116:119], v21, s[28:31], s75 offen offset:256 sc1
    v_mfma_f32_16x16x32_bf16 v[152:155], v[86:89], a[56:59], v[152:155]
    ds_read_b64_tr_b16 v[70:71], v45 offset:8192
    v_mfma_f32_16x16x32_bf16 v[156:159], v[86:89], a[60:63], v[156:159]
    s_waitcnt vmcnt(13) lgkmcnt(3)
    ds_read_b64_tr_b16 v[72:73], v45 offset:8704
    v_mfma_f32_16x16x32_bf16 v[128:131], v[58:61], a[64:67], v[128:131]
    ds_read_b64_tr_b16 v[74:75], v42 offset:12288
    v_mfma_f32_16x16x32_bf16 v[132:135], v[58:61], a[68:71], v[132:135]
    ds_read_b64_tr_b16 v[76:77], v42 offset:12800
    buffer_load_dwordx4 a[120:123], v21, s[28:31], s75 offen offset:2048 sc1
    v_mfma_f32_16x16x32_bf16 v[136:139], v[62:65], a[64:67], v[136:139]
    ds_read_b64_tr_b16 v[78:79], v43 offset:12288
    v_mfma_f32_16x16x32_bf16 v[140:143], v[62:65], a[68:71], v[140:143]
    s_waitcnt lgkmcnt(3)
    ds_read_b64_tr_b16 v[80:81], v43 offset:12800
    v_mfma_f32_16x16x32_bf16 v[144:147], v[66:69], a[64:67], v[144:147]
    ds_read_b64_tr_b16 v[82:83], v44 offset:12288
    v_mfma_f32_16x16x32_bf16 v[148:151], v[66:69], a[68:71], v[148:151]
    ds_read_b64_tr_b16 v[84:85], v44 offset:12800
    buffer_load_dwordx4 a[124:127], v21, s[28:31], s75 offen offset:2304 sc1
    v_mfma_f32_16x16x32_bf16 v[152:155], v[70:73], a[64:67], v[152:155]
    ds_read_b64_tr_b16 v[86:87], v45 offset:12288
    v_mfma_f32_16x16x32_bf16 v[156:159], v[70:73], a[68:71], v[156:159]
    s_waitcnt vmcnt(13) lgkmcnt(3)
    ds_read_b64_tr_b16 v[88:89], v45 offset:12800
    v_mfma_f32_16x16x32_bf16 v[128:131], v[74:77], a[72:75], v[128:131]
    ds_read_b64_tr_b16 v[58:59], v42 offset:16384
    s_add_u32 s75, s17, s9
    v_mfma_f32_16x16x32_bf16 v[132:135], v[74:77], a[76:79], v[132:135]
    ds_read_b64_tr_b16 v[60:61], v42 offset:16896
    buffer_load_dwordx4 a[128:131], v21, s[28:31], s75 offen offset:0 sc1
    v_mfma_f32_16x16x32_bf16 v[136:139], v[78:81], a[72:75], v[136:139]
    ds_read_b64_tr_b16 v[62:63], v43 offset:16384
    v_mfma_f32_16x16x32_bf16 v[140:143], v[78:81], a[76:79], v[140:143]
    s_waitcnt lgkmcnt(3)
    ds_read_b64_tr_b16 v[64:65], v43 offset:16896
    s_barrier
    v_mfma_f32_16x16x32_bf16 v[144:147], v[82:85], a[72:75], v[144:147]
    ds_read_b64_tr_b16 v[66:67], v44 offset:16384
    s_add_u32 s74, s22, s0
    v_mfma_f32_16x16x32_bf16 v[148:151], v[82:85], a[76:79], v[148:151]
    ds_read_b64_tr_b16 v[68:69], v44 offset:16896
    buffer_load_dwordx4 a[132:135], v21, s[28:31], s75 offen offset:256 sc1
    v_mfma_f32_16x16x32_bf16 v[152:155], v[86:89], a[72:75], v[152:155]
    ds_read_b64_tr_b16 v[70:71], v45 offset:16384
    s_add_u32 m0, s64, 65536
    v_mfma_f32_16x16x32_bf16 v[156:159], v[86:89], a[76:79], v[156:159]
    s_waitcnt vmcnt(13) lgkmcnt(3)
    ds_read_b64_tr_b16 v[72:73], v45 offset:16896
    buffer_load_dwordx4 v12, s[40:43], s74 offen offset:0 lds
    v_mfma_f32_16x16x32_bf16 v[128:131], v[58:61], a[80:83], v[128:131]
    ds_read_b64_tr_b16 v[74:75], v42 offset:20480
    v_mfma_f32_16x16x32_bf16 v[132:135], v[58:61], a[84:87], v[132:135]
    ds_read_b64_tr_b16 v[76:77], v42 offset:20992
    buffer_load_dwordx4 a[136:139], v21, s[28:31], s75 offen offset:2048 sc1
    v_mfma_f32_16x16x32_bf16 v[136:139], v[62:65], a[80:83], v[136:139]
    ds_read_b64_tr_b16 v[78:79], v43 offset:20480
    v_mfma_f32_16x16x32_bf16 v[140:143], v[62:65], a[84:87], v[140:143]
    s_waitcnt lgkmcnt(3)
    ds_read_b64_tr_b16 v[80:81], v43 offset:20992
    buffer_load_dwordx4 v13, s[40:43], s74 offen offset:1024 lds
    v_mfma_f32_16x16x32_bf16 v[144:147], v[66:69], a[80:83], v[144:147]
    ds_read_b64_tr_b16 v[82:83], v44 offset:20480
    s_add_u32 s1, s22, s89
    v_mfma_f32_16x16x32_bf16 v[148:151], v[66:69], a[84:87], v[148:151]
    ds_read_b64_tr_b16 v[84:85], v44 offset:20992
    buffer_load_dwordx4 a[140:143], v21, s[28:31], s75 offen offset:2304 sc1
    v_mfma_f32_16x16x32_bf16 v[152:155], v[70:73], a[80:83], v[152:155]
    ds_read_b64_tr_b16 v[86:87], v45 offset:20480
    s_add_u32 m0, s64, 114688
    v_mfma_f32_16x16x32_bf16 v[156:159], v[70:73], a[84:87], v[156:159]
    s_waitcnt vmcnt(15) lgkmcnt(3)
    ds_read_b64_tr_b16 v[88:89], v45 offset:20992
    buffer_load_dwordx4 v12, s[40:43], s1 offen offset:0 lds
    s_waitcnt vmcnt(15)
    v_cmp_ne_u32 vcc, s54, v20
    s_nop 0
    s_cbranch_vccnz slow_18
back_19:
    s_xor_b32 s66, s66, 256
    v_mfma_f32_16x16x32_bf16 v[128:131], v[74:77], a[88:91], v[128:131]
    ds_read_b64_tr_b16 v[58:59], v42 offset:24576
    s_add_u32 s75, s12, s10
    v_mfma_f32_16x16x32_bf16 v[132:135], v[74:77], a[92:95], v[132:135]
    ds_read_b64_tr_b16 v[60:61], v42 offset:25088
    buffer_load_dwordx4 a[160:163], v21, s[28:31], s75 offen offset:0 sc1
    v_mfma_f32_16x16x32_bf16 v[136:139], v[78:81], a[88:91], v[136:139]
    ds_read_b64_tr_b16 v[62:63], v43 offset:24576
    v_mfma_f32_16x16x32_bf16 v[140:143], v[78:81], a[92:95], v[140:143]
    s_waitcnt lgkmcnt(3)
    ds_read_b64_tr_b16 v[64:65], v43 offset:25088
    buffer_load_dwordx4 v13, s[40:43], s1 offen offset:1024 lds
    v_mfma_f32_16x16x32_bf16 v[144:147], v[82:85], a[88:91], v[144:147]
    ds_read_b64_tr_b16 v[66:67], v44 offset:24576
    s_add_u32 s74, s23, s0
    v_mfma_f32_16x16x32_bf16 v[148:151], v[82:85], a[92:95], v[148:151]
    ds_read_b64_tr_b16 v[68:69], v44 offset:25088
    buffer_load_dwordx4 a[164:167], v21, s[28:31], s75 offen offset:256 sc1
    v_mfma_f32_16x16x32_bf16 v[152:155], v[86:89], a[88:91], v[152:155]
    ds_read_b64_tr_b16 v[70:71], v45 offset:24576
    s_add_u32 m0, s64, 73728
    v_mfma_f32_16x16x32_bf16 v[156:159], v[86:89], a[92:95], v[156:159]
    s_waitcnt vmcnt(16) lgkmcnt(3)
    ds_read_b64_tr_b16 v[72:73], v45 offset:25088
    buffer_load_dwordx4 v12, s[40:43], s74 offen offset:0 lds
    v_mfma_f32_16x16x32_bf16 v[128:131], v[58:61], a[96:99], v[128:131]
    ds_read_b64_tr_b16 v[74:75], v42 offset:28672
    v_mfma_f32_16x16x32_bf16 v[132:135], v[58:61], a[100:103], v[132:135]
    ds_read_b64_tr_b16 v[76:77], v42 offset:29184
    buffer_load_dwordx4 a[168:171], v21, s[28:31], s75 offen offset:2048 sc1
    v_mfma_f32_16x16x32_bf16 v[136:139], v[62:65], a[96:99], v[136:139]
    ds_read_b64_tr_b16 v[78:79], v43 offset:28672
    v_mfma_f32_16x16x32_bf16 v[140:143], v[62:65], a[100:103], v[140:143]
    s_waitcnt lgkmcnt(3)
    ds_read_b64_tr_b16 v[80:81], v43 offset:29184
    buffer_load_dwordx4 v13, s[40:43], s74 offen offset:1024 lds
    v_mfma_f32_16x16x32_bf16 v[144:147], v[66:69], a[96:99], v[144:147]
    ds_read_b64_tr_b16 v[82:83], v44 offset:28672
    s_add_u32 s1, s23, s89
    v_mfma_f32_16x16x32_bf16 v[148:151], v[66:69], a[100:103], v[148:151]
    ds_read_b64_tr_b16 v[84:85], v44 offset:29184
    buffer_load_dwordx4 a[172:175], v21, s[28:31], s75 offen offset:2304 sc1
    v_mfma_f32_16x16x32_bf16 v[152:155], v[70:73], a[96:99], v[152:155]
    ds_read_b64_tr_b16 v[86:87], v45 offset:28672
    s_add_u32 m0, s64, 122880
    v_mfma_f32_16x16x32_bf16 v[156:159], v[70:73], a[100:103], v[156:159]
    s_waitcnt vmcnt(18) lgkmcnt(3)
    ds_read_b64_tr_b16 v[88:89], v45 offset:29184
    buffer_load_dwordx4 v12, s[40:43], s1 offen offset:0 lds
    v_mfma_f32_16x16x32_bf16 v[128:131], v[74:77], a[104:107], v[128:131]
    ds_read_b64_tr_b16 v[58:59], v42 offset:32768
    s_add_u32 s75, s13, s10
    v_mfma_f32_16x16x32_bf16 v[132:135], v[74:77], a[108:111], v[132:135]
    ds_read_b64_tr_b16 v[60:61], v42 offset:33280
    buffer_load_dwordx4 a[176:179], v21, s[28:31], s75 offen offset:0 sc1
    v_mfma_f32_16x16x32_bf16 v[136:139], v[78:81], a[104:107], v[136:139]
    ds_read_b64_tr_b16 v[62:63], v43 offset:32768
    v_mfma_f32_16x16x32_bf16 v[140:143], v[78:81], a[108:111], v[140:143]
    s_waitcnt lgkmcnt(3)
    ds_read_b64_tr_b16 v[64:65], v43 offset:33280
    buffer_load_dwordx4 v13, s[40:43], s1 offen offset:1024 lds
    v_mfma_f32_16x16x32_bf16 v[144:147], v[82:85], a[104:107], v[144:147]
    ds_read_b64_tr_b16 v[66:67], v44 offset:32768
    v_mfma_f32_16x16x32_bf16 v[148:151], v[82:85], a[108:111], v[148:151]
    ds_read_b64_tr_b16 v[68:69], v44 offset:33280
    buffer_load_dwordx4 a[180:183], v21, s[28:31], s75 offen offset:256 sc1
    v_mfma_f32_16x16x32_bf16 v[152:155], v[86:89], a[104:107], v[152:155]
    ds_read_b64_tr_b16 v[70:71], v45 offset:32768
    v_mfma_f32_16x16x32_bf16 v[156:159], v[86:89], a[108:111], v[156:159]
    s_waitcnt vmcnt(20) lgkmcnt(3)
    ds_read_b64_tr_b16 v[72:73], v45 offset:33280
    v_mfma_f32_16x16x32_bf16 v[128:131], v[58:61], a[112:115], v[128:131]
    ds_read_b64_tr_b16 v[74:75], v42 offset:36864
    v_mfma_f32_16x16x32_bf16 v[132:135], v[58:61], a[116:119], v[132:135]
    ds_read_b64_tr_b16 v[76:77], v42 offset:37376
    buffer_load_dwordx4 a[184:187], v21, s[28:31], s75 offen offset:2048 sc1
    v_mfma_f32_16x16x32_bf16 v[136:139], v[62:65], a[112:115], v[136:139]
    ds_read_b64_tr_b16 v[78:79], v43 offset:36864
    v_mfma_f32_16x16x32_bf16 v[140:143], v[62:65], a[116:119], v[140:143]
    s_waitcnt lgkmcnt(3)
    ds_read_b64_tr_b16 v[80:81], v43 offset:37376
    v_mfma_f32_16x16x32_bf16 v[144:147], v[66:69], a[112:115], v[144:147]
    ds_read_b64_tr_b16 v[82:83], v44 offset:36864
    v_mfma_f32_16x16x32_bf16 v[148:151], v[66:69], a[116:119], v[148:151]
    ds_read_b64_tr_b16 v[84:85], v44 offset:37376
    buffer_load_dwordx4 a[188:191], v21, s[28:31], s75 offen offset:2304 sc1
    v_mfma_f32_16x16x32_bf16 v[152:155], v[70:73], a[112:115], v[152:155]
    ds_read_b64_tr_b16 v[86:87], v45 offset:36864
    v_mfma_f32_16x16x32_bf16 v[156:159], v[70:73], a[116:119], v[156:159]
    s_waitcnt vmcnt(20) lgkmcnt(3)
    ds_read_b64_tr_b16 v[88:89], v45 offset:37376
    v_mfma_f32_16x16x32_bf16 v[128:131], v[74:77], a[120:123], v[128:131]
    ds_read_b64_tr_b16 v[58:59], v42 offset:40960
    s_add_u32 s75, s14, s10
    v_mfma_f32_16x16x32_bf16 v[132:135], v[74:77], a[124:127], v[132:135]
    ds_read_b64_tr_b16 v[60:61], v42 offset:41472
    buffer_load_dwordx4 a[192:195], v21, s[28:31], s75 offen offset:0 sc1
    v_mfma_f32_16x16x32_bf16 v[136:139], v[78:81], a[120:123], v[136:139]
    ds_read_b64_tr_b16 v[62:63], v43 offset:40960
    v_mfma_f32_16x16x32_bf16 v[140:143], v[78:81], a[124:127], v[140:143]
    s_waitcnt lgkmcnt(3)
    ds_read_b64_tr_b16 v[64:65], v43 offset:41472
    v_mfma_f32_16x16x32_bf16 v[144:147], v[82:85], a[120:123], v[144:147]
    ds_read_b64_tr_b16 v[66:67], v44 offset:40960
    v_mfma_f32_16x16x32_bf16 v[148:151], v[82:85], a[124:127], v[148:151]
    ds_read_b64_tr_b16 v[68:69], v44 offset:41472
    buffer_load_dwordx4 a[196:199], v21, s[28:31], s75 offen offset:256 sc1
    v_mfma_f32_16x16x32_bf16 v[152:155], v[86:89], a[120:123], v[152:155]
    ds_read_b64_tr_b16 v[70:71], v45 offset:40960
    v_mfma_f32_16x16x32_bf16 v[156:159], v[86:89], a[124:127], v[156:159]
    s_waitcnt vmcnt(20) lgkmcnt(3)
    ds_read_b64_tr_b16 v[72:73], v45 offset:41472
    v_mfma_f32_16x16x32_bf16 v[128:131], v[58:61], a[128:131], v[128:131]
    ds_read_b64_tr_b16 v[74:75], v42 offset:45056
    v_mfma_f32_16x16x32_bf16 v[132:135], v[58:61], a[132:135], v[132:135]
    ds_read_b64_tr_b16 v[76:77], v42 offset:45568
    buffer_load_dwordx4 a[200:203], v21, s[28:31], s75 offen offset:2048 sc1
    v_mfma_f32_16x16x32_bf16 v[136:139], v[62:65], a[128:131], v[136:139]
    ds_read_b64_tr_b16 v[78:79], v43 offset:45056
    v_mfma_f32_16x16x32_bf16 v[140:143], v[62:65], a[132:135], v[140:143]
    s_waitcnt lgkmcnt(3)
    ds_read_b64_tr_b16 v[80:81], v43 offset:45568
    s_barrier
    v_mfma_f32_16x16x32_bf16 v[144:147], v[66:69], a[128:131], v[144:147]
    ds_read_b64_tr_b16 v[82:83], v44 offset:45056
    s_add_u32 m0, s62, 81920
    v_mfma_f32_16x16x32_bf16 v[148:151], v[66:69], a[132:135], v[148:151]
    ds_read_b64_tr_b16 v[84:85], v44 offset:45568
    buffer_load_dwordx4 a[204:207], v21, s[28:31], s75 offen offset:2304 sc1
    v_mfma_f32_16x16x32_bf16 v[152:155], v[70:73], a[128:131], v[152:155]
    ds_read_b64_tr_b16 v[86:87], v45 offset:45056
    v_mfma_f32_16x16x32_bf16 v[156:159], v[70:73], a[132:135], v[156:159]
    s_waitcnt vmcnt(18) lgkmcnt(3)
    ds_read_b64_tr_b16 v[88:89], v45 offset:45568
    buffer_load_dwordx4 v2, s[24:27], s69 offen offset:0 lds
    buffer_load_dword v20, v18, s[28:31], s66 offen sc1
    v_mfma_f32_16x16x32_bf16 v[128:131], v[74:77], a[136:139], v[128:131]
    ds_read_b64_tr_b16 v[58:59], v54 offset:0
    s_add_u32 s75, s15, s10
    v_mfma_f32_16x16x32_bf16 v[132:135], v[74:77], a[140:143], v[132:135]
    ds_read_b64_tr_b16 v[60:61], v54 offset:512
    buffer_load_dwordx4 a[0:3], v21, s[28:31], s75 offen offset:0 sc1
    v_mfma_f32_16x16x32_bf16 v[136:139], v[78:81], a[136:139], v[136:139]
    ds_read_b64_tr_b16 v[62:63], v55 offset:0
    v_mfma_f32_16x16x32_bf16 v[140:143], v[78:81], a[140:143], v[140:143]
    s_waitcnt lgkmcnt(3)
    ds_read_b64_tr_b16 v[64:65], v55 offset:512
    buffer_load_dwordx4 v3, s[24:27], s69 offen offset:1024 lds
    v_mfma_f32_16x16x32_bf16 v[144:147], v[82:85], a[136:139], v[144:147]
    ds_read_b64_tr_b16 v[66:67], v56 offset:0
    v_mfma_f32_16x16x32_bf16 v[148:151], v[82:85], a[140:143], v[148:151]
    ds_read_b64_tr_b16 v[68:69], v56 offset:512
    buffer_load_dwordx4 a[4:7], v21, s[28:31], s75 offen offset:256 sc1
    v_mfma_f32_16x16x32_bf16 v[152:155], v[86:89], a[136:139], v[152:155]
    ds_read_b64_tr_b16 v[70:71], v57 offset:0
    v_mfma_f32_16x16x32_bf16 v[156:159], v[86:89], a[140:143], v[156:159]
    s_waitcnt vmcnt(19) lgkmcnt(3)
    ds_read_b64_tr_b16 v[72:73], v57 offset:512
    buffer_load_dwordx4 v4, s[24:27], s69 offen offset:2048 lds
    v_mfma_f32_16x16x32_bf16 v[128:131], v[58:61], a[160:163], v[128:131]
    ds_read_b64_tr_b16 v[74:75], v54 offset:4096
    v_mfma_f32_16x16x32_bf16 v[132:135], v[58:61], a[164:167], v[132:135]
    ds_read_b64_tr_b16 v[76:77], v54 offset:4608
    buffer_load_dwordx4 a[8:11], v21, s[28:31], s75 offen offset:2048 sc1
    v_mfma_f32_16x16x32_bf16 v[136:139], v[62:65], a[160:163], v[136:139]
    ds_read_b64_tr_b16 v[78:79], v55 offset:4096
    v_mfma_f32_16x16x32_bf16 v[140:143], v[62:65], a[164:167], v[140:143]
    s_waitcnt lgkmcnt(3)
    ds_read_b64_tr_b16 v[80:81], v55 offset:4608
    buffer_load_dwordx4 v5, s[24:27], s69 offen offset:3072 lds
    v_mfma_f32_16x16x32_bf16 v[144:147], v[66:69], a[160:163], v[144:147]
    ds_read_b64_tr_b16 v[82:83], v56 offset:4096
    v_mfma_f32_16x16x32_bf16 v[148:151], v[66:69], a[164:167], v[148:151]
    ds_read_b64_tr_b16 v[84:85], v56 offset:4608
    buffer_load_dwordx4 a[12:15], v21, s[28:31], s75 offen offset:2304 sc1
    v_mfma_f32_16x16x32_bf16 v[152:155], v[70:73], a[160:163], v[152:155]
    ds_read_b64_tr_b16 v[86:87], v57 offset:4096
    v_mfma_f32_16x16x32_bf16 v[156:159], v[70:73], a[164:167], v[156:159]
    s_waitcnt vmcnt(19) lgkmcnt(3)
    ds_read_b64_tr_b16 v[88:89], v57 offset:4608
    v_mfma_f32_16x16x32_bf16 v[128:131], v[74:77], a[168:171], v[128:131]
    ds_read_b64_tr_b16 v[58:59], v54 offset:8192
    s_add_u32 s75, s16, s10
    v_mfma_f32_16x16x32_bf16 v[132:135], v[74:77], a[172:175], v[132:135]
    ds_read_b64_tr_b16 v[60:61], v54 offset:8704
    buffer_load_dwordx4 a[16:19], v21, s[28:31], s75 offen offset:0 sc1
    v_mfma_f32_16x16x32_bf16 v[136:139], v[78:81], a[168:171], v[136:139]
    ds_read_b64_tr_b16 v[62:63], v55 offset:8192
    v_mfma_f32_16x16x32_bf16 v[140:143], v[78:81], a[172:175], v[140:143]
    s_waitcnt lgkmcnt(3)
    ds_read_b64_tr_b16 v[64:65], v55 offset:8704
    v_mfma_f32_16x16x32_bf16 v[144:147], v[82:85], a[168:171], v[144:147]
    ds_read_b64_tr_b16 v[66:67], v56 offset:8192
    v_mfma_f32_16x16x32_bf16 v[148:151], v[82:85], a[172:175], v[148:151]
    ds_read_b64_tr_b16 v[68:69], v56 offset:8704
    buffer_load_dwordx4 a[20:23], v21, s[28:31], s75 offen offset:256 sc1
    v_mfma_f32_16x16x32_bf16 v[152:155], v[86:89], a[168:171], v[152:155]
    ds_read_b64_tr_b16 v[70:71], v57 offset:8192
    v_mfma_f32_16x16x32_bf16 v[156:159], v[86:89], a[172:175], v[156:159]
    s_waitcnt vmcnt(17) lgkmcnt(3)
    ds_read_b64_tr_b16 v[72:73], v57 offset:8704
    v_mfma_f32_16x16x32_bf16 v[128:131], v[58:61], a[176:179], v[128:131]
    ds_read_b64_tr_b16 v[74:75], v54 offset:12288
    v_mfma_f32_16x16x32_bf16 v[132:135], v[58:61], a[180:183], v[132:135]
    ds_read_b64_tr_b16 v[76:77], v54 offset:12800
    buffer_load_dwordx4 a[24:27], v21, s[28:31], s75 offen offset:2048 sc1
    v_mfma_f32_16x16x32_bf16 v[136:139], v[62:65], a[176:179], v[136:139]
    ds_read_b64_tr_b16 v[78:79], v55 offset:12288
    v_mfma_f32_16x16x32_bf16 v[140:143], v[62:65], a[180:183], v[140:143]
    s_waitcnt lgkmcnt(3)
    ds_read_b64_tr_b16 v[80:81], v55 offset:12800
    v_mfma_f32_16x16x32_bf16 v[144:147], v[66:69], a[176:179], v[144:147]
    ds_read_b64_tr_b16 v[82:83], v56 offset:12288
    v_mfma_f32_16x16x32_bf16 v[148:151], v[66:69], a[180:183], v[148:151]
    ds_read_b64_tr_b16 v[84:85], v56 offset:12800
    buffer_load_dwordx4 a[28:31], v21, s[28:31], s75 offen offset:2304 sc1
    v_mfma_f32_16x16x32_bf16 v[152:155], v[70:73], a[176:179], v[152:155]
    ds_read_b64_tr_b16 v[86:87], v57 offset:12288
    v_mfma_f32_16x16x32_bf16 v[156:159], v[70:73], a[180:183], v[156:159]
    s_waitcnt vmcnt(17) lgkmcnt(3)
    ds_read_b64_tr_b16 v[88:89], v57 offset:12800
    v_mfma_f32_16x16x32_bf16 v[128:131], v[74:77], a[184:187], v[128:131]
    ds_read_b64_tr_b16 v[58:59], v54 offset:16384
    s_add_u32 s75, s17, s10
    v_mfma_f32_16x16x32_bf16 v[132:135], v[74:77], a[188:191], v[132:135]
    ds_read_b64_tr_b16 v[60:61], v54 offset:16896
    buffer_load_dwordx4 a[32:35], v21, s[28:31], s75 offen offset:0 sc1
    v_mfma_f32_16x16x32_bf16 v[136:139], v[78:81], a[184:187], v[136:139]
    ds_read_b64_tr_b16 v[62:63], v55 offset:16384
    v_mfma_f32_16x16x32_bf16 v[140:143], v[78:81], a[188:191], v[140:143]
    s_waitcnt lgkmcnt(3)
    ds_read_b64_tr_b16 v[64:65], v55 offset:16896
    v_mfma_f32_16x16x32_bf16 v[144:147], v[82:85], a[184:187], v[144:147]
    ds_read_b64_tr_b16 v[66:67], v56 offset:16384
    v_mfma_f32_16x16x32_bf16 v[148:151], v[82:85], a[188:191], v[148:151]
    ds_read_b64_tr_b16 v[68:69], v56 offset:16896
    buffer_load_dwordx4 a[36:39], v21, s[28:31], s75 offen offset:256 sc1
    v_mfma_f32_16x16x32_bf16 v[152:155], v[86:89], a[184:187], v[152:155]
    ds_read_b64_tr_b16 v[70:71], v57 offset:16384
    v_mfma_f32_16x16x32_bf16 v[156:159], v[86:89], a[188:191], v[156:159]
    s_waitcnt vmcnt(17) lgkmcnt(3)
    ds_read_b64_tr_b16 v[72:73], v57 offset:16896
    v_mfma_f32_16x16x32_bf16 v[128:131], v[58:61], a[192:195], v[128:131]
    ds_read_b64_tr_b16 v[74:75], v54 offset:20480
    v_mfma_f32_16x16x32_bf16 v[132:135], v[58:61], a[196:199], v[132:135]
    ds_read_b64_tr_b16 v[76:77], v54 offset:20992
    buffer_load_dwordx4 a[40:43], v21, s[28:31], s75 offen offset:2048 sc1
    v_mfma_f32_16x16x32_bf16 v[136:139], v[62:65], a[192:195], v[136:139]
    ds_read_b64_tr_b16 v[78:79], v55 offset:20480
    v_mfma_f32_16x16x32_bf16 v[140:143], v[62:65], a[196:199], v[140:143]
    s_waitcnt lgkmcnt(3)
    ds_read_b64_tr_b16 v[80:81], v55 offset:20992
    v_mfma_f32_16x16x32_bf16 v[144:147], v[66:69], a[192:195], v[144:147]
    ds_read_b64_tr_b16 v[82:83], v56 offset:20480
    v_mfma_f32_16x16x32_bf16 v[148:151], v[66:69], a[196:199], v[148:151]
    ds_read_b64_tr_b16 v[84:85], v56 offset:20992
    buffer_load_dwordx4 a[44:47], v21, s[28:31], s75 offen offset:2304 sc1
    v_mfma_f32_16x16x32_bf16 v[152:155], v[70:73], a[192:195], v[152:155]
    ds_read_b64_tr_b16 v[86:87], v57 offset:20480
    v_mfma_f32_16x16x32_bf16 v[156:159], v[70:73], a[196:199], v[156:159]
    s_waitcnt vmcnt(17) lgkmcnt(3)
    ds_read_b64_tr_b16 v[88:89], v57 offset:20992
    s_waitcnt vmcnt(15)
    v_cmp_ne_u32 vcc, s54, v20
    s_nop 0
    s_cbranch_vccnz slow_21
back_22:
    v_mfma_f32_16x16x32_bf16 v[128:131], v[74:77], a[200:203], v[128:131]
    ds_read_b64_tr_b16 v[58:59], v54 offset:24576
    s_add_u32 s75, s12, s11
    v_mfma_f32_16x16x32_bf16 v[132:135], v[74:77], a[204:207], v[132:135]
    ds_read_b64_tr_b16 v[60:61], v54 offset:25088
    buffer_load_dwordx4 a[48:51], v21, s[28:31], s75 offen offset:0 sc1
    v_mfma_f32_16x16x32_bf16 v[136:139], v[78:81], a[200:203], v[136:139]
    ds_read_b64_tr_b16 v[62:63], v55 offset:24576
    v_mfma_f32_16x16x32_bf16 v[140:143], v[78:81], a[204:207], v[140:143]
    s_waitcnt lgkmcnt(3)
    ds_read_b64_tr_b16 v[64:65], v55 offset:25088
    v_mfma_f32_16x16x32_bf16 v[144:147], v[82:85], a[200:203], v[144:147]
    ds_read_b64_tr_b16 v[66:67], v56 offset:24576
    v_mfma_f32_16x16x32_bf16 v[148:151], v[82:85], a[204:207], v[148:151]
    ds_read_b64_tr_b16 v[68:69], v56 offset:25088
    buffer_load_dwordx4 a[52:55], v21, s[28:31], s75 offen offset:256 sc1
    v_mfma_f32_16x16x32_bf16 v[152:155], v[86:89], a[200:203], v[152:155]
    ds_read_b64_tr_b16 v[70:71], v57 offset:24576
    v_mfma_f32_16x16x32_bf16 v[156:159], v[86:89], a[204:207], v[156:159]
    s_waitcnt vmcnt(14) lgkmcnt(3)
    ds_read_b64_tr_b16 v[72:73], v57 offset:25088
    v_mfma_f32_16x16x32_bf16 v[128:131], v[58:61], a[0:3], v[128:131]
    ds_read_b64_tr_b16 v[74:75], v54 offset:28672
    v_mfma_f32_16x16x32_bf16 v[132:135], v[58:61], a[4:7], v[132:135]
    ds_read_b64_tr_b16 v[76:77], v54 offset:29184
    buffer_load_dwordx4 a[56:59], v21, s[28:31], s75 offen offset:2048 sc1
    v_mfma_f32_16x16x32_bf16 v[136:139], v[62:65], a[0:3], v[136:139]
    ds_read_b64_tr_b16 v[78:79], v55 offset:28672
    v_mfma_f32_16x16x32_bf16 v[140:143], v[62:65], a[4:7], v[140:143]
    s_waitcnt lgkmcnt(3)
    ds_read_b64_tr_b16 v[80:81], v55 offset:29184
    s_barrier
    v_mfma_f32_16x16x32_bf16 v[144:147], v[66:69], a[0:3], v[144:147]
    ds_read_b64_tr_b16 v[82:83], v56 offset:28672
    v_mfma_f32_16x16x32_bf16 v[148:151], v[66:69], a[4:7], v[148:151]
    ds_read_b64_tr_b16 v[84:85], v56 offset:29184
    buffer_load_dwordx4 a[60:63], v21, s[28:31], s75 offen offset:2304 sc1
    v_mfma_f32_16x16x32_bf16 v[152:155], v[70:73], a[0:3], v[152:155]
    ds_read_b64_tr_b16 v[86:87], v57 offset:28672
    v_mfma_f32_16x16x32_bf16 v[156:159], v[70:73], a[4:7], v[156:159]
    s_waitcnt vmcnt(12) lgkmcnt(3)
    ds_read_b64_tr_b16 v[88:89], v57 offset:29184
    v_mfma_f32_16x16x32_bf16 v[128:131], v[74:77], a[8:11], v[128:131]
    ds_read_b64_tr_b16 v[58:59], v26 offset:0
    s_add_u32 s75, s13, s11
    v_mfma_f32_16x16x32_bf16 v[132:135], v[74:77], a[12:15], v[132:135]
    ds_read_b64_tr_b16 v[60:61], v26 offset:512
    buffer_load_dwordx4 a[64:67], v21, s[28:31], s75 offen offset:0 sc1
    v_mfma_f32_16x16x32_bf16 v[136:139], v[78:81], a[8:11], v[136:139]
    ds_read_b64_tr_b16 v[62:63], v27 offset:0
    v_mfma_f32_16x16x32_bf16 v[140:143], v[78:81], a[12:15], v[140:143]
    s_waitcnt lgkmcnt(3)
    ds_read_b64_tr_b16 v[64:65], v27 offset:512
    v_mfma_f32_16x16x32_bf16 v[144:147], v[82:85], a[8:11], v[144:147]
    ds_read_b64_tr_b16 v[66:67], v28 offset:0
    v_mfma_f32_16x16x32_bf16 v[148:151], v[82:85], a[12:15], v[148:151]
    ds_read_b64_tr_b16 v[68:69], v28 offset:512
    buffer_load_dwordx4 a[68:71], v21, s[28:31], s75 offen offset:256 sc1
    v_mfma_f32_16x16x32_bf16 v[152:155], v[86:89], a[8:11], v[152:155]
    ds_read_b64_tr_b16 v[70:71], v29 offset:0
    v_mfma_f32_16x16x32_bf16 v[156:159], v[86:89], a[12:15], v[156:159]
    s_waitcnt vmcnt(12) lgkmcnt(3)
    ds_read_b64_tr_b16 v[72:73], v29 offset:512
    v_mfma_f32_16x16x32_bf16 v[128:131], v[58:61], a[16:19], v[128:131]
    ds_read_b64_tr_b16 v[74:75], v26 offset:4096
    v_mfma_f32_16x16x32_bf16 v[132:135], v[58:61], a[20:23], v[132:135]
    ds_read_b64_tr_b16 v[76:77], v26 offset:4608
    buffer_load_dwordx4 a[72:75], v21, s[28:31], s75 offen offset:2048 sc1
    v_mfma_f32_16x16x32_bf16 v[136:139], v[62:65], a[16:19], v[136:139]
    ds_read_b64_tr_b16 v[78:79], v27 offset:4096
    ds_read_b64 v[224:225], v34 offset:0
    v_mfma_f32_16x16x32_bf16 v[140:143], v[62:65], a[20:23], v[140:143]
    s_waitcnt lgkmcnt(4)
    ds_read_b64_tr_b16 v[80:81], v27 offset:4608
    v_mfma_f32_16x16x32_bf16 v[144:147], v[66:69], a[16:19], v[144:147]
    ds_read_b64_tr_b16 v[82:83], v28 offset:4096
    v_mfma_f32_16x16x32_bf16 v[148:151], v[66:69], a[20:23], v[148:151]
    ds_read_b64_tr_b16 v[84:85], v28 offset:4608
    buffer_load_dwordx4 a[76:79], v21, s[28:31], s75 offen offset:2304 sc1
    v_mfma_f32_16x16x32_bf16 v[152:155], v[70:73], a[16:19], v[152:155]
    ds_read_b64_tr_b16 v[86:87], v29 offset:4096
    ds_read_b64 v[226:227], v34 offset:2048
    v_mfma_f32_16x16x32_bf16 v[156:159], v[70:73], a[20:23], v[156:159]
    s_waitcnt vmcnt(12) lgkmcnt(4)
    ds_read_b64_tr_b16 v[88:89], v29 offset:4608
    v_mfma_f32_16x16x32_bf16 v[128:131], v[74:77], a[24:27], v[128:131]
    ds_read_b64_tr_b16 v[58:59], v26 offset:8192
    s_add_u32 s75, s14, s11
    v_mfma_f32_16x16x32_bf16 v[132:135], v[74:77], a[28:31], v[132:135]
ffn_pg5:
    s_cbranch_execz ffn_ret
    ds_read_b64_tr_b16 v[60:61], v26 offset:8704
    buffer_load_dwordx4 a[80:83], v21, s[28:31], s75 offen offset:0 sc1
    v_mfma_f32_16x16x32_bf16 v[136:139], v[78:81], a[24:27], v[136:139]
    ds_read_b64_tr_b16 v[62:63], v27 offset:8192
    ds_read_b64 v[228:229], v35 offset:0
    v_mfma_f32_16x16x32_bf16 v[140:143], v[78:81], a[28:31], v[140:143]
    s_waitcnt lgkmcnt(4)
    ds_read_b64_tr_b16 v[64:65], v27 offset:8704
    v_mfma_f32_16x16x32_bf16 v[144:147], v[82:85], a[24:27], v[144:147]
    ds_read_b64_tr_b16 v[66:67], v28 offset:8192
    v_mfma_f32_16x16x32_bf16 v[148:151], v[82:85], a[28:31], v[148:151]
    ds_read_b64_tr_b16 v[68:69], v28 offset:8704
    buffer_load_dwordx4 a[84:87], v21, s[28:31], s75 offen offset:256 sc1
    v_mfma_f32_16x16x32_bf16 v[152:155], v[86:89], a[24:27], v[152:155]
    ds_read_b64_tr_b16 v[70:71], v29 offset:8192
    ds_read_b64 v[230:231], v35 offset:2048
    v_mfma_f32_16x16x32_bf16 v[156:159], v[86:89], a[28:31], v[156:159]
    s_waitcnt vmcnt(12) lgkmcnt(4)
    ds_read_b64_tr_b16 v[72:73], v29 offset:8704
    v_mfma_f32_16x16x32_bf16 v[128:131], v[58:61], a[32:35], v[128:131]
    ds_read_b64_tr_b16 v[74:75], v26 offset:12288
    v_mfma_f32_16x16x32_bf16 v[132:135], v[58:61], a[36:39], v[132:135]
    ds_read_b64_tr_b16 v[76:77], v26 offset:12800
    buffer_load_dwordx4 a[88:91], v21, s[28:31], s75 offen offset:2048 sc1
    v_mfma_f32_16x16x32_bf16 v[136:139], v[62:65], a[32:35], v[136:139]
    ds_read_b64_tr_b16 v[78:79], v27 offset:12288
    ds_read_b64 v[232:233], v36 offset:0
    v_mfma_f32_16x16x32_bf16 v[140:143], v[62:65], a[36:39], v[140:143]
    s_waitcnt lgkmcnt(4)
    ds_read_b64_tr_b16 v[80:81], v27 offset:12800
    v_mfma_f32_16x16x32_bf16 v[144:147], v[66:69], a[32:35], v[144:147]
    ds_read_b64_tr_b16 v[82:83], v28 offset:12288
    v_mfma_f32_16x16x32_bf16 v[148:151], v[66:69], a[36:39], v[148:151]
    ds_read_b64_tr_b16 v[84:85], v28 offset:12800
    buffer_load_dwordx4 a[92:95], v21, s[28:31], s75 offen offset:2304 sc1
    v_mfma_f32_16x16x32_bf16 v[152:155], v[70:73], a[32:35], v[152:155]
    ds_read_b64_tr_b16 v[86:87], v29 offset:12288
    ds_read_b64 v[234:235], v36 offset:2048
    v_mfma_f32_16x16x32_bf16 v[156:159], v[70:73], a[36:39], v[156:159]
    s_waitcnt vmcnt(12) lgkmcnt(4)
    ds_read_b64_tr_b16 v[88:89], v29 offset:12800
    v_mfma_f32_16x16x32_bf16 v[128:131], v[74:77], a[40:43], v[128:131]
    ds_read_b64_tr_b16 v[58:59], v106 offset:0
    s_add_u32 s75, s15, s11
    v_mfma_f32_16x16x32_bf16 v[132:135], v[74:77], a[44:47], v[132:135]
    ds_read_b64_tr_b16 v[60:61], v106 offset:512
    buffer_load_dwordx4 a[96:99], v21, s[28:31], s75 offen offset:0 sc1
    v_mfma_f32_16x16x32_bf16 v[136:139], v[78:81], a[40:43], v[136:139]
    ds_read_b64_tr_b16 v[62:63], v107 offset:0
    ds_read_b64 v[236:237], v37 offset:0
    v_mfma_f32_16x16x32_bf16 v[140:143], v[78:81], a[44:47], v[140:143]
    s_waitcnt lgkmcnt(4)
    ds_read_b64_tr_b16 v[64:65], v107 offset:512
    v_mfma_f32_16x16x32_bf16 v[144:147], v[82:85], a[40:43], v[144:147]
    ds_read_b64_tr_b16 v[66:67], v108 offset:0
    v_mfma_f32_16x16x32_bf16 v[148:151], v[82:85], a[44:47], v[148:151]
    ds_read_b64_tr_b16 v[68:69], v108 offset:512
    buffer_load_dwordx4 a[100:103], v21, s[28:31], s75 offen offset:256 sc1
    v_mfma_f32_16x16x32_bf16 v[152:155], v[86:89], a[40:43], v[152:155]
    ds_read_b64_tr_b16 v[70:71], v109 offset:0
    ds_read_b64 v[238:239], v37 offset:2048
    v_mfma_f32_16x16x32_bf16 v[156:159], v[86:89], a[44:47], v[156:159]
    s_waitcnt vmcnt(12) lgkmcnt(4)
    ds_read_b64_tr_b16 v[72:73], v109 offset:512
    v_mfma_f32_16x16x32_bf16 v[128:131], v[58:61], a[48:51], v[128:131]
    ds_read_b64_tr_b16 v[74:75], v106 offset:4096
    v_mfma_f32_16x16x32_bf16 v[132:135], v[58:61], a[52:55], v[132:135]
    ds_read_b64_tr_b16 v[76:77], v106 offset:4608
    buffer_load_dwordx4 a[104:107], v21, s[28:31], s75 offen offset:2048 sc1
    v_mfma_f32_16x16x32_bf16 v[136:139], v[62:65], a[48:51], v[136:139]
    ds_read_b64_tr_b16 v[78:79], v107 offset:4096
    v_mfma_f32_16x16x32_bf16 v[140:143], v[62:65], a[52:55], v[140:143]
    s_waitcnt lgkmcnt(3)
    ds_read_b64_tr_b16 v[80:81], v107 offset:4608
    v_mfma_f32_16x16x32_bf16 v[144:147], v[66:69], a[48:51], v[144:147]
    ds_read_b64_tr_b16 v[82:83], v108 offset:4096
    v_mfma_f32_16x16x32_bf16 v[148:151], v[66:69], a[52:55], v[148:151]
    ds_read_b64_tr_b16 v[84:85], v108 offset:4608
    buffer_load_dwordx4 a[108:111], v21, s[28:31], s75 offen offset:2304 sc1
    v_mfma_f32_16x16x32_bf16 v[152:155], v[70:73], a[48:51], v[152:155]
    ds_read_b64_tr_b16 v[86:87], v109 offset:4096
    v_mfma_f32_16x16x32_bf16 v[156:159], v[70:73], a[52:55], v[156:159]
    s_waitcnt vmcnt(12) lgkmcnt(3)
    ds_read_b64_tr_b16 v[88:89], v109 offset:4608
    v_mfma_f32_16x16x32_bf16 v[128:131], v[74:77], a[56:59], v[128:131]
    ds_read_b64_tr_b16 v[58:59], v106 offset:8192
    s_add_u32 s75, s16, s11
    v_mfma_f32_16x16x32_bf16 v[132:135], v[74:77], a[60:63], v[132:135]
    ds_read_b64_tr_b16 v[60:61], v106 offset:8704
    buffer_load_dwordx4 a[112:115], v21, s[28:31], s75 offen offset:0 sc1
    v_mfma_f32_16x16x32_bf16 v[136:139], v[78:81], a[56:59], v[136:139]
    ds_read_b64_tr_b16 v[62:63], v107 offset:8192
    v_lshlrev_b32 v192, 16, v224
    v_mfma_f32_16x16x32_bf16 v[140:143], v[78:81], a[60:63], v[140:143]
    s_waitcnt lgkmcnt(3)
    ds_read_b64_tr_b16 v[64:65], v107 offset:8704
    v_mfma_f32_16x16x32_bf16 v[144:147], v[82:85], a[56:59], v[144:147]
    ds_read_b64_tr_b16 v[66:67], v108 offset:8192
    v_and_b32 v193, 0xffff0000, v224
    v_mfma_f32_16x16x32_bf16 v[148:151], v[82:85], a[60:63], v[148:151]
    ds_read_b64_tr_b16 v[68:69], v108 offset:8704
    buffer_load_dwordx4 a[116:119], v21, s[28:31], s75 offen offset:256 sc1
    v_mfma_f32_16x16x32_bf16 v[152:155], v[86:89], a[56:59], v[152:155]
    ds_read_b64_tr_b16 v[70:71], v109 offset:8192
    v_lshlrev_b32 v194, 16, v225
    v_mfma_f32_16x16x32_bf16 v[156:159], v[86:89], a[60:63], v[156:159]
    s_waitcnt vmcnt(12) lgkmcnt(3)
    ds_read_b64_tr_b16 v[72:73], v109 offset:8704
    buffer_load_dword v20, v19, s[28:31], s67 offen sc1
    v_mfma_f32_16x16x32_bf16 v[128:131], v[58:61], a[64:67], v[128:131]
    ds_read_b64_tr_b16 v[74:75], v106 offset:12288
    v_and_b32 v195, 0xffff0000, v225
    v_mfma_f32_16x16x32_bf16 v[132:135], v[58:61], a[68:71], v[132:135]
    ds_read_b64_tr_b16 v[76:77], v106 offset:12800
    buffer_load_dwordx4 a[120:123], v21, s[28:31], s75 offen offset:2048 sc1
    v_mfma_f32_16x16x32_bf16 v[136:139], v[62:65], a[64:67], v[136:139]
    ds_read_b64_tr_b16 v[78:79], v107 offset:12288
    v_lshlrev_b32 v196, 16, v226
    v_mfma_f32_16x16x32_bf16 v[140:143], v[62:65], a[68:71], v[140:143]
    s_waitcnt lgkmcnt(3)
    ds_read_b64_tr_b16 v[80:81], v107 offset:12800
    v_mfma_f32_16x16x32_bf16 v[144:147], v[66:69], a[64:67], v[144:147]
    ds_read_b64_tr_b16 v[82:83], v108 offset:12288
    v_and_b32 v197, 0xffff0000, v226
    v_mfma_f32_16x16x32_bf16 v[148:151], v[66:69], a[68:71], v[148:151]
    ds_read_b64_tr_b16 v[84:85], v108 offset:12800
    buffer_load_dwordx4 a[124:127], v21, s[28:31], s75 offen offset:2304 sc1
    v_mfma_f32_16x16x32_bf16 v[152:155], v[70:73], a[64:67], v[152:155]
    ds_read_b64_tr_b16 v[86:87], v109 offset:12288
    v_lshlrev_b32 v198, 16, v227
    v_mfma_f32_16x16x32_bf16 v[156:159], v[70:73], a[68:71], v[156:159]
    s_waitcnt vmcnt(13) lgkmcnt(3)
    ds_read_b64_tr_b16 v[88:89], v109 offset:12800
    v_mfma_f32_16x16x32_bf16 v[128:131], v[74:77], a[72:75], v[128:131]
    ds_read_b64_tr_b16 v[58:59], v106 offset:16384
    s_add_u32 s75, s17, s11
    v_mfma_f32_16x16x32_bf16 v[132:135], v[74:77], a[76:79], v[132:135]
    ds_read_b64_tr_b16 v[60:61], v106 offset:16896
    buffer_load_dwordx4 a[128:131], v21, s[28:31], s75 offen offset:0 sc1
    v_mfma_f32_16x16x32_bf16 v[136:139], v[78:81], a[72:75], v[136:139]
    ds_read_b64_tr_b16 v[62:63], v107 offset:16384
    v_and_b32 v199, 0xffff0000, v227
    v_mfma_f32_16x16x32_bf16 v[140:143], v[78:81], a[76:79], v[140:143]
    s_waitcnt lgkmcnt(3)
    ds_read_b64_tr_b16 v[64:65], v107 offset:16896
    v_mfma_f32_16x16x32_bf16 v[144:147], v[82:85], a[72:75], v[144:147]
    ds_read_b64_tr_b16 v[66:67], v108 offset:16384
    v_lshlrev_b32 v200, 16, v228
    v_mfma_f32_16x16x32_bf16 v[148:151], v[82:85], a[76:79], v[148:151]
    ds_read_b64_tr_b16 v[68:69], v108 offset:16896
    buffer_load_dwordx4 a[132:135], v21, s[28:31], s75 offen offset:256 sc1
    v_mfma_f32_16x16x32_bf16 v[152:155], v[86:89], a[72:75], v[152:155]
    ds_read_b64_tr_b16 v[70:71], v109 offset:16384
    v_and_b32 v201, 0xffff0000, v228
    v_mfma_f32_16x16x32_bf16 v[156:159], v[86:89], a[76:79], v[156:159]
    s_waitcnt vmcnt(13) lgkmcnt(3)
    ds_read_b64_tr_b16 v[72:73], v109 offset:16896
    v_mfma_f32_16x16x32_bf16 v[128:131], v[58:61], a[80:83], v[128:131]
    ds_read_b64_tr_b16 v[74:75], v106 offset:20480
    v_lshlrev_b32 v202, 16, v229
    v_mfma_f32_16x16x32_bf16 v[132:135], v[58:61], a[84:87], v[132:135]
    ds_read_b64_tr_b16 v[76:77], v106 offset:20992
    buffer_load_dwordx4 a[136:139], v21, s[28:31], s75 offen offset:2048 sc1
    v_mfma_f32_16x16x32_bf16 v[136:139], v[62:65], a[80:83], v[136:139]
    ds_read_b64_tr_b16 v[78:79], v107 offset:20480
    v_and_b32 v203, 0xffff0000, v229
    v_mfma_f32_16x16x32_bf16 v[140:143], v[62:65], a[84:87], v[140:143]
    s_waitcnt lgkmcnt(3)
    ds_read_b64_tr_b16 v[80:81], v107 offset:20992
    v_mfma_f32_16x16x32_bf16 v[144:147], v[66:69], a[80:83], v[144:147]
    ds_read_b64_tr_b16 v[82:83], v108 offset:20480
    v_lshlrev_b32 v204, 16, v230
    v_mfma_f32_16x16x32_bf16 v[148:151], v[66:69], a[84:87], v[148:151]
    ds_read_b64_tr_b16 v[84:85], v108 offset:20992
    buffer_load_dwordx4 a[140:143], v21, s[28:31], s75 offen offset:2304 sc1
    v_mfma_f32_16x16x32_bf16 v[152:155], v[70:73], a[80:83], v[152:155]
    ds_read_b64_tr_b16 v[86:87], v109 offset:20480
    v_and_b32 v205, 0xffff0000, v230
    v_mfma_f32_16x16x32_bf16 v[156:159], v[70:73], a[84:87], v[156:159]
    s_waitcnt vmcnt(13) lgkmcnt(3)
    ds_read_b64_tr_b16 v[88:89], v109 offset:20992
    v_mfma_f32_16x16x32_bf16 v[128:131], v[74:77], a[88:91], v[128:131]
    ds_read_b64_tr_b16 v[58:59], v106 offset:24576
    v_lshlrev_b32 v206, 16, v231
    v_mfma_f32_16x16x32_bf16 v[132:135], v[74:77], a[92:95], v[132:135]
    ds_read_b64_tr_b16 v[60:61], v106 offset:25088
    v_and_b32 v207, 0xffff0000, v231
    v_mfma_f32_16x16x32_bf16 v[136:139], v[78:81], a[88:91], v[136:139]
    ds_read_b64_tr_b16 v[62:63], v107 offset:24576
    v_lshlrev_b32 v208, 16, v232
    v_mfma_f32_16x16x32_bf16 v[140:143], v[78:81], a[92:95], v[140:143]
    s_waitcnt lgkmcnt(3)
    ds_read_b64_tr_b16 v[64:65], v107 offset:25088
    v_mfma_f32_16x16x32_bf16 v[144:147], v[82:85], a[88:91], v[144:147]
    ds_read_b64_tr_b16 v[66:67], v108 offset:24576
    v_and_b32 v209, 0xffff0000, v232
    v_mfma_f32_16x16x32_bf16 v[148:151], v[82:85], a[92:95], v[148:151]
    ds_read_b64_tr_b16 v[68:69], v108 offset:25088
    v_lshlrev_b32 v210, 16, v233
    v_mfma_f32_16x16x32_bf16 v[152:155], v[86:89], a[88:91], v[152:155]
    ds_read_b64_tr_b16 v[70:71], v109 offset:24576
    v_and_b32 v211, 0xffff0000, v233
    v_mfma_f32_16x16x32_bf16 v[156:159], v[86:89], a[92:95], v[156:159]
    s_waitcnt vmcnt(11) lgkmcnt(3)
    ds_read_b64_tr_b16 v[72:73], v109 offset:25088
    v_mfma_f32_16x16x32_bf16 v[128:131], v[58:61], a[96:99], v[128:131]
    ds_read_b64_tr_b16 v[74:75], v106 offset:28672
    v_lshlrev_b32 v212, 16, v234
    v_mfma_f32_16x16x32_bf16 v[132:135], v[58:61], a[100:103], v[132:135]
    ds_read_b64_tr_b16 v[76:77], v106 offset:29184
    v_and_b32 v213, 0xffff0000, v234
    v_mfma_f32_16x16x32_bf16 v[136:139], v[62:65], a[96:99], v[136:139]
    ds_read_b64_tr_b16 v[78:79], v107 offset:28672
    v_lshlrev_b32 v214, 16, v235
    v_mfma_f32_16x16x32_bf16 v[140:143], v[62:65], a[100:103], v[140:143]
    s_waitcnt lgkmcnt(3)
    ds_read_b64_tr_b16 v[80:81], v107 offset:29184
    v_mfma_f32_16x16x32_bf16 v[144:147], v[66:69], a[96:99], v[144:147]
    ds_read_b64_tr_b16 v[82:83], v108 offset:28672
    v_and_b32 v215, 0xffff0000, v235
    v_mfma_f32_16x16x32_bf16 v[148:151], v[66:69], a[100:103], v[148:151]
    ds_read_b64_tr_b16 v[84:85], v108 offset:29184
    v_lshlrev_b32 v216, 16, v236
    v_mfma_f32_16x16x32_bf16 v[152:155], v[70:73], a[96:99], v[152:155]
    ds_read_b64_tr_b16 v[86:87], v109 offset:28672
    v_and_b32 v217, 0xffff0000, v236
    v_mfma_f32_16x16x32_bf16 v[156:159], v[70:73], a[100:103], v[156:159]
    s_waitcnt vmcnt(9) lgkmcnt(3)
    ds_read_b64_tr_b16 v[88:89], v109 offset:29184
    s_waitcnt vmcnt(6)
    v_cmp_ne_u32 vcc, s54, v20
    s_nop 0
    s_cbranch_vccz ok_24
    s_mov_b32 s55, 0
rt_25:
    buffer_load_dword v20, v19, s[28:31], s67 offen sc1
    s_waitcnt vmcnt(0)
    v_cmp_ne_u32 vcc, s54, v20
    s_nop 0
    s_cbranch_vccz ok_24
    s_add_u32 s55, s55, 1
    s_cmp_lt_u32 s55, 262144
    s_cbranch_scc1 rt_25
ok_24:
    v_mfma_f32_16x16x32_bf16 v[128:131], v[74:77], a[104:107], v[128:131]
    ds_read_b64_tr_b16 v[58:59], v42 offset:0
    s_add_u32 m0, s63, 131072
    v_mfma_f32_16x16x32_bf16 v[132:135], v[74:77], a[108:111], v[132:135]
    ds_read_b64_tr_b16 v[60:61], v42 offset:512
    buffer_load_dwordx4 v14, s[28:31], s68 offen offset:0 sc1 lds
    v_mfma_f32_16x16x32_bf16 v[136:139], v[78:81], a[104:107], v[136:139]
    ds_read_b64_tr_b16 v[62:63], v43 offset:0
    v_lshlrev_b32 v218, 16, v237
    v_mfma_f32_16x16x32_bf16 v[140:143], v[78:81], a[108:111], v[140:143]
    s_waitcnt lgkmcnt(3)
    ds_read_b64_tr_b16 v[64:65], v43 offset:512
    buffer_load_dwordx4 v15, s[28:31], s68 offen offset:1024 sc1 lds
    v_mfma_f32_16x16x32_bf16 v[144:147], v[82:85], a[104:107], v[144:147]
    ds_read_b64_tr_b16 v[66:67], v44 offset:0
    v_and_b32 v219, 0xffff0000, v237
    v_mfma_f32_16x16x32_bf16 v[148:151], v[82:85], a[108:111], v[148:151]
    ds_read_b64_tr_b16 v[68:69], v44 offset:512
    buffer_load_dwordx4 v16, s[28:31], s68 offen offset:2048 sc1 lds
    v_mfma_f32_16x16x32_bf16 v[152:155], v[86:89], a[104:107], v[152:155]
    ds_read_b64_tr_b16 v[70:71], v45 offset:0
    v_lshlrev_b32 v220, 16, v238
    v_mfma_f32_16x16x32_bf16 v[156:159], v[86:89], a[108:111], v[156:159]
    s_waitcnt lgkmcnt(3)
    ds_read_b64_tr_b16 v[72:73], v45 offset:512
    buffer_load_dwordx4 v17, s[28:31], s68 offen offset:3072 sc1 lds
    v_mfma_f32_16x16x32_bf16 v[128:131], v[58:61], a[112:115], v[128:131]
    ds_read_b64_tr_b16 v[74:75], v42 offset:4096
    s_add_u32 s68, s68, 20480
    v_mfma_f32_16x16x32_bf16 v[132:135], v[58:61], a[116:119], v[132:135]
    ds_read_b64_tr_b16 v[76:77], v42 offset:4608
    s_add_u32 m0, s63, 135168
    s_nop 0
    buffer_load_dwordx4 v14, s[28:31], s68 offen offset:0 sc1 lds
    v_mfma_f32_16x16x32_bf16 v[136:139], v[62:65], a[112:115], v[136:139]
    ds_read_b64_tr_b16 v[78:79], v43 offset:4096
    v_and_b32 v221, 0xffff0000, v238
    v_mfma_f32_16x16x32_bf16 v[140:143], v[62:65], a[116:119], v[140:143]
    s_waitcnt lgkmcnt(3)
    ds_read_b64_tr_b16 v[80:81], v43 offset:4608
    buffer_load_dwordx4 v15, s[28:31], s68 offen offset:1024 sc1 lds
    v_mfma_f32_16x16x32_bf16 v[144:147], v[66:69], a[112:115], v[144:147]
    ds_read_b64_tr_b16 v[82:83], v44 offset:4096
    v_lshlrev_b32 v222, 16, v239
    v_mfma_f32_16x16x32_bf16 v[148:151], v[66:69], a[116:119], v[148:151]
    ds_read_b64_tr_b16 v[84:85], v44 offset:4608
    buffer_load_dwordx4 v16, s[28:31], s68 offen offset:2048 sc1 lds
    v_mfma_f32_16x16x32_bf16 v[152:155], v[70:73], a[112:115], v[152:155]
    ds_read_b64_tr_b16 v[86:87], v45 offset:4096
    v_and_b32 v223, 0xffff0000, v239
    v_mfma_f32_16x16x32_bf16 v[156:159], v[70:73], a[116:119], v[156:159]
    s_waitcnt vmcnt(11) lgkmcnt(3)
    ds_read_b64_tr_b16 v[88:89], v45 offset:4608
    buffer_load_dwordx4 v17, s[28:31], s68 offen offset:3072 sc1 lds
    v_mfma_f32_16x16x32_bf16 v[128:131], v[74:77], a[120:123], v[128:131]
    ds_read_b64_tr_b16 v[58:59], v42 offset:8192
    v_mfma_f32_16x16x32_bf16 v[132:135], v[74:77], a[124:127], v[132:135]
    ds_read_b64_tr_b16 v[60:61], v42 offset:8704
    v_mfma_f32_16x16x32_bf16 v[136:139], v[78:81], a[120:123], v[136:139]
    ds_read_b64_tr_b16 v[62:63], v43 offset:8192
    v_mfma_f32_16x16x32_bf16 v[140:143], v[78:81], a[124:127], v[140:143]
    s_waitcnt lgkmcnt(3)
    ds_read_b64_tr_b16 v[64:65], v43 offset:8704
    v_mfma_f32_16x16x32_bf16 v[144:147], v[82:85], a[120:123], v[144:147]
    ds_read_b64_tr_b16 v[66:67], v44 offset:8192
    v_mfma_f32_16x16x32_bf16 v[148:151], v[82:85], a[124:127], v[148:151]
    ds_read_b64_tr_b16 v[68:69], v44 offset:8704
    v_mfma_f32_16x16x32_bf16 v[152:155], v[86:89], a[120:123], v[152:155]
    ds_read_b64_tr_b16 v[70:71], v45 offset:8192
    v_mfma_f32_16x16x32_bf16 v[156:159], v[86:89], a[124:127], v[156:159]
    s_waitcnt vmcnt(10) lgkmcnt(3)
    ds_read_b64_tr_b16 v[72:73], v45 offset:8704
    v_mfma_f32_16x16x32_bf16 v[128:131], v[58:61], a[128:131], v[128:131]
    ds_read_b64_tr_b16 v[74:75], v42 offset:12288
    v_mfma_f32_16x16x32_bf16 v[132:135], v[58:61], a[132:135], v[132:135]
    ds_read_b64_tr_b16 v[76:77], v42 offset:12800
    v_mfma_f32_16x16x32_bf16 v[136:139], v[62:65], a[128:131], v[136:139]
    ds_read_b64_tr_b16 v[78:79], v43 offset:12288
    v_mfma_f32_16x16x32_bf16 v[140:143], v[62:65], a[132:135], v[140:143]
    s_waitcnt lgkmcnt(3)
    ds_read_b64_tr_b16 v[80:81], v43 offset:12800
    v_mfma_f32_16x16x32_bf16 v[144:147], v[66:69], a[128:131], v[144:147]
    ds_read_b64_tr_b16 v[82:83], v44 offset:12288
    v_mfma_f32_16x16x32_bf16 v[148:151], v[66:69], a[132:135], v[148:151]
    ds_read_b64_tr_b16 v[84:85], v44 offset:12800
    v_mfma_f32_16x16x32_bf16 v[152:155], v[70:73], a[128:131], v[152:155]
    ds_read_b64_tr_b16 v[86:87], v45 offset:12288
    v_mfma_f32_16x16x32_bf16 v[156:159], v[70:73], a[132:135], v[156:159]
    s_waitcnt vmcnt(8) lgkmcnt(3)
    ds_read_b64_tr_b16 v[88:89], v45 offset:12800
    v_mfma_f32_16x16x32_bf16 v[128:131], v[74:77], a[136:139], v[128:131]
    v_mfma_f32_16x16x32_bf16 v[132:135], v[74:77], a[140:143], v[132:135]
    v_mfma_f32_16x16x32_bf16 v[136:139], v[78:81], a[136:139], v[136:139]
    v_mfma_f32_16x16x32_bf16 v[140:143], v[78:81], a[140:143], v[140:143]
    s_waitcnt lgkmcnt(0)
    v_mfma_f32_16x16x32_bf16 v[144:147], v[82:85], a[136:139], v[144:147]
    v_mfma_f32_16x16x32_bf16 v[148:151], v[82:85], a[140:143], v[148:151]
    v_mfma_f32_16x16x32_bf16 v[152:155], v[86:89], a[136:139], v[152:155]
    v_mfma_f32_16x16x32_bf16 v[156:159], v[86:89], a[140:143], v[156:159]
    v_pk_mul_f32 v[224:225], v[128:129], v[46:47] op_sel:[0,0] op_sel_hi:[1,0]
    v_pk_mul_f32 v[226:227], v[130:131], v[46:47] op_sel:[0,0] op_sel_hi:[1,0]
    v_pk_mul_f32 v[228:229], v[132:133], v[46:47] op_sel:[0,0] op_sel_hi:[1,0]
    v_pk_mul_f32 v[230:231], v[134:135], v[46:47] op_sel:[0,0] op_sel_hi:[1,0]
    v_pk_mul_f32 v[232:233], v[136:137], v[46:47] op_sel:[0,0] op_sel_hi:[1,0]
    v_pk_mul_f32 v[234:235], v[138:139], v[46:47] op_sel:[0,0] op_sel_hi:[1,0]
    v_pk_mul_f32 v[236:237], v[140:141], v[46:47] op_sel:[0,0] op_sel_hi:[1,0]
    v_pk_mul_f32 v[238:239], v[142:143], v[46:47] op_sel:[0,0] op_sel_hi:[1,0]
    v_pk_mul_f32 v[240:241], v[144:145], v[46:47] op_sel:[0,0] op_sel_hi:[1,0]
    v_pk_mul_f32 v[242:243], v[146:147], v[46:47] op_sel:[0,0] op_sel_hi:[1,0]
    v_pk_mul_f32 v[244:245], v[148:149], v[46:47] op_sel:[0,0] op_sel_hi:[1,0]
    v_pk_mul_f32 v[246:247], v[150:151], v[46:47] op_sel:[0,0] op_sel_hi:[1,0]
    v_pk_mul_f32 v[248:249], v[152:153], v[46:47] op_sel:[0,0] op_sel_hi:[1,0]
    v_pk_mul_f32 v[250:251], v[154:155], v[46:47] op_sel:[0,0] op_sel_hi:[1,0]
    v_pk_mul_f32 v[252:253], v[156:157], v[46:47] op_sel:[0,0] op_sel_hi:[1,0]
    v_pk_mul_f32 v[254:255], v[158:159], v[46:47] op_sel:[0,0] op_sel_hi:[1,0]
    v_exp_f32 v224, v224
    v_exp_f32 v225, v225
    v_exp_f32 v226, v226
    v_exp_f32 v227, v227
    v_exp_f32 v228, v228
    v_exp_f32 v229, v229
    v_exp_f32 v230, v230
    v_exp_f32 v231, v231
    v_exp_f32 v232, v232
    v_exp_f32 v233, v233
    v_exp_f32 v234, v234
    v_exp_f32 v235, v235
    v_exp_f32 v236, v236
    v_exp_f32 v237, v237
    v_exp_f32 v238, v238
    v_exp_f32 v239, v239
    v_exp_f32 v240, v240
    v_exp_f32 v241, v241
    v_exp_f32 v242, v242
    v_exp_f32 v243, v243
    v_exp_f32 v244, v244
    v_exp_f32 v245, v245
    v_exp_f32 v246, v246
    v_exp_f32 v247, v247
    v_exp_f32 v248, v248
    v_exp_f32 v249, v249
    v_exp_f32 v250, v250
    v_exp_f32 v251, v251
    v_exp_f32 v252, v252
    v_exp_f32 v253, v253
    v_exp_f32 v254, v254
    v_exp_f32 v255, v255
    v_pk_fma_f32 v[224:225], v[224:225], v[46:47], v[46:47] op_sel:[0,1,1] op_sel_hi:[1,1,1]
    v_pk_fma_f32 v[226:227], v[226:227], v[46:47], v[46:47] op_sel:[0,1,1] op_sel_hi:[1,1,1]
    v_pk_fma_f32 v[228:229], v[228:229], v[46:47], v[46:47] op_sel:[0,1,1] op_sel_hi:[1,1,1]
    v_pk_fma_f32 v[230:231], v[230:231], v[46:47], v[46:47] op_sel:[0,1,1] op_sel_hi:[1,1,1]
    v_pk_fma_f32 v[232:233], v[232:233], v[46:47], v[46:47] op_sel:[0,1,1] op_sel_hi:[1,1,1]
    v_pk_fma_f32 v[234:235], v[234:235], v[46:47], v[46:47] op_sel:[0,1,1] op_sel_hi:[1,1,1]
    v_pk_fma_f32 v[236:237], v[236:237], v[46:47], v[46:47] op_sel:[0,1,1] op_sel_hi:[1,1,1]
    v_pk_fma_f32 v[238:239], v[238:239], v[46:47], v[46:47] op_sel:[0,1,1] op_sel_hi:[1,1,1]
    v_pk_fma_f32 v[240:241], v[240:241], v[46:47], v[46:47] op_sel:[0,1,1] op_sel_hi:[1,1,1]
    v_pk_fma_f32 v[242:243], v[242:243], v[46:47], v[46:47] op_sel:[0,1,1] op_sel_hi:[1,1,1]
    v_pk_fma_f32 v[244:245], v[244:245], v[46:47], v[46:47] op_sel:[0,1,1] op_sel_hi:[1,1,1]
    v_pk_fma_f32 v[246:247], v[246:247], v[46:47], v[46:47] op_sel:[0,1,1] op_sel_hi:[1,1,1]
    v_pk_fma_f32 v[248:249], v[248:249], v[46:47], v[46:47] op_sel:[0,1,1] op_sel_hi:[1,1,1]
    v_pk_fma_f32 v[250:251], v[250:251], v[46:47], v[46:47] op_sel:[0,1,1] op_sel_hi:[1,1,1]
    v_pk_fma_f32 v[252:253], v[252:253], v[46:47], v[46:47] op_sel:[0,1,1] op_sel_hi:[1,1,1]
    v_pk_fma_f32 v[254:255], v[254:255], v[46:47], v[46:47] op_sel:[0,1,1] op_sel_hi:[1,1,1]
    v_rcp_f32 v224, v224
    v_rcp_f32 v225, v225
    v_rcp_f32 v226, v226
    v_rcp_f32 v227, v227
    v_rcp_f32 v232, v232
    v_rcp_f32 v233, v233
    v_rcp_f32 v234, v234
    v_rcp_f32 v235, v235
    v_rcp_f32 v240, v240
    v_rcp_f32 v241, v241
    v_rcp_f32 v242, v242
    v_rcp_f32 v243, v243
    v_rcp_f32 v248, v248
    v_rcp_f32 v249, v249
    v_rcp_f32 v250, v250
    v_rcp_f32 v251, v251
    s_waitcnt vmcnt(0)
    s_barrier
    ds_read_b64_tr_b16 a[0:1], v110 offset:0
    v_rcp_f32 v228, v228
    ds_read_b64_tr_b16 a[2:3], v110 offset:512
    v_rcp_f32 v229, v229
    ds_read_b64_tr_b16 a[4:5], v111 offset:0
    v_rcp_f32 v230, v230
    ds_read_b64_tr_b16 a[6:7], v111 offset:512
    v_rcp_f32 v231, v231
    ds_read_b64_tr_b16 a[8:9], v112 offset:0
    v_rcp_f32 v236, v236
    ds_read_b64_tr_b16 a[10:11], v112 offset:512
    v_rcp_f32 v237, v237
    ds_read_b64_tr_b16 a[12:13], v113 offset:0
    v_rcp_f32 v238, v238
    ds_read_b64_tr_b16 a[14:15], v113 offset:512
    v_rcp_f32 v239, v239
    ds_read_b64_tr_b16 a[16:17], v110 offset:4096
    v_rcp_f32 v244, v244
    ds_read_b64_tr_b16 a[18:19], v110 offset:4608
    v_rcp_f32 v245, v245
    ds_read_b64_tr_b16 a[20:21], v111 offset:4096
    v_rcp_f32 v246, v246
    ds_read_b64_tr_b16 a[22:23], v111 offset:4608
    v_rcp_f32 v247, v247
    ds_read_b64_tr_b16 a[24:25], v112 offset:4096
    v_rcp_f32 v252, v252
    ds_read_b64_tr_b16 a[26:27], v112 offset:4608
    v_rcp_f32 v253, v253
    ds_read_b64_tr_b16 a[28:29], v113 offset:4096
    v_rcp_f32 v254, v254
    ds_read_b64_tr_b16 a[30:31], v113 offset:4608
    v_rcp_f32 v255, v255
    v_pk_mul_f32 v[224:225], v[224:225], v[128:129]
    v_pk_mul_f32 v[226:227], v[226:227], v[130:131]
    v_pk_mul_f32 v[232:233], v[232:233], v[136:137]
    v_pk_mul_f32 v[234:235], v[234:235], v[138:139]
    v_pk_mul_f32 v[240:241], v[240:241], v[144:145]
    v_pk_mul_f32 v[242:243], v[242:243], v[146:147]
    v_pk_mul_f32 v[248:249], v[248:249], v[152:153]
    v_pk_mul_f32 v[250:251], v[250:251], v[154:155]
    v_pk_mul_f32 v[228:229], v[228:229], v[132:133]
    v_pk_mul_f32 v[230:231], v[230:231], v[134:135]
    v_pk_mul_f32 v[236:237], v[236:237], v[140:141]
    v_pk_mul_f32 v[238:239], v[238:239], v[142:143]
    v_pk_mul_f32 v[244:245], v[244:245], v[148:149]
    v_pk_mul_f32 v[246:247], v[246:247], v[150:151]
    v_pk_mul_f32 v[252:253], v[252:253], v[156:157]
    v_pk_mul_f32 v[254:255], v[254:255], v[158:159]
    s_waitcnt lgkmcnt(0)
    v_mfma_f32_16x16x32_bf16 v[160:163], a[0:3], a[208:211], 0
    ds_read_b64_tr_b16 a[32:33], v110 offset:8192
    v_mfma_f32_16x16x32_bf16 v[168:171], a[4:7], a[208:211], 0
    ds_read_b64_tr_b16 a[34:35], v110 offset:8704
    ds_read_b64_tr_b16 a[36:37], v111 offset:8192
    v_mfma_f32_16x16x32_bf16 v[176:179], a[8:11], a[208:211], 0
    ds_read_b64_tr_b16 a[38:39], v111 offset:8704
    v_mfma_f32_16x16x32_bf16 v[184:187], a[12:15], a[208:211], 0
    ds_read_b64_tr_b16 a[40:41], v112 offset:8192
    ds_read_b64_tr_b16 a[42:43], v112 offset:8704
    v_mfma_f32_16x16x32_bf16 v[160:163], a[16:19], a[212:215], v[160:163]
    ds_read_b64_tr_b16 a[44:45], v113 offset:8192
    v_mfma_f32_16x16x32_bf16 v[168:171], a[20:23], a[212:215], v[168:171]
    ds_read_b64_tr_b16 a[46:47], v113 offset:8704
    ds_read_b64_tr_b16 a[48:49], v110 offset:12288
    v_mfma_f32_16x16x32_bf16 v[176:179], a[24:27], a[212:215], v[176:179]
    ds_read_b64_tr_b16 a[50:51], v110 offset:12800
    v_mfma_f32_16x16x32_bf16 v[184:187], a[28:31], a[212:215], v[184:187]
    ds_read_b64_tr_b16 a[52:53], v111 offset:12288
    ds_read_b64_tr_b16 a[54:55], v111 offset:12800
    s_waitcnt lgkmcnt(10)
    v_mfma_f32_16x16x32_bf16 v[160:163], a[32:35], a[224:227], v[160:163]
    ds_read_b64_tr_b16 a[56:57], v112 offset:12288
    s_waitcnt lgkmcnt(9)
    v_mfma_f32_16x16x32_bf16 v[168:171], a[36:39], a[224:227], v[168:171]
    ds_read_b64_tr_b16 a[58:59], v112 offset:12800
    ds_read_b64_tr_b16 a[60:61], v113 offset:12288
    s_waitcnt lgkmcnt(9)
    v_mfma_f32_16x16x32_bf16 v[176:179], a[40:43], a[240:243], v[176:179]
    ds_read_b64_tr_b16 a[62:63], v113 offset:12800
    s_waitcnt lgkmcnt(8)
    v_mfma_f32_16x16x32_bf16 v[184:187], a[44:47], a[240:243], v[184:187]
    s_waitcnt lgkmcnt(6)
    v_mfma_f32_16x16x32_bf16 v[160:163], a[48:51], a[228:231], v[160:163]
    s_waitcnt lgkmcnt(4)
    v_mfma_f32_16x16x32_bf16 v[168:171], a[52:55], a[228:231], v[168:171]
    s_waitcnt lgkmcnt(2)
    v_mfma_f32_16x16x32_bf16 v[176:179], a[56:59], a[244:247], v[176:179]
    s_waitcnt lgkmcnt(0)
    v_mfma_f32_16x16x32_bf16 v[184:187], a[60:63], a[244:247], v[184:187]
    v_mfma_f32_16x16x32_bf16 v[164:167], a[0:3], a[216:219], 0
    v_mfma_f32_16x16x32_bf16 v[172:175], a[4:7], a[216:219], 0
    v_fma_f32 v192, v224, v160, v192
    v_fma_f32 v193, v225, v161, v193
    v_fma_f32 v194, v226, v162, v194
    v_mfma_f32_16x16x32_bf16 v[180:183], a[8:11], a[216:219], 0
    v_fma_f32 v195, v227, v163, v195
    v_cvt_pk_bf16_f32 v58, v192, v193
    v_cvt_pk_bf16_f32 v59, v194, v195
    v_mfma_f32_16x16x32_bf16 v[188:191], a[12:15], a[216:219], 0
    ds_write_b64 v34, v[58:59] offset:0
    v_fma_f32 v200, v232, v168, v200
    v_mfma_f32_16x16x32_bf16 v[164:167], a[16:19], a[220:223], v[164:167]
    v_fma_f32 v201, v233, v169, v201
    v_fma_f32 v202, v234, v170, v202
    v_fma_f32 v203, v235, v171, v203
    v_mfma_f32_16x16x32_bf16 v[172:175], a[20:23], a[220:223], v[172:175]
    v_cvt_pk_bf16_f32 v60, v200, v201
    v_cvt_pk_bf16_f32 v61, v202, v203
    v_mfma_f32_16x16x32_bf16 v[180:183], a[24:27], a[220:223], v[180:183]
    ds_write_b64 v35, v[60:61] offset:0
    v_fma_f32 v208, v240, v176, v208
    v_mfma_f32_16x16x32_bf16 v[188:191], a[28:31], a[220:223], v[188:191]
    v_fma_f32 v209, v241, v177, v209
    v_fma_f32 v210, v242, v178, v210
    v_fma_f32 v211, v243, v179, v211
    v_mfma_f32_16x16x32_bf16 v[164:167], a[32:35], a[232:235], v[164:167]
    v_cvt_pk_bf16_f32 v62, v208, v209
    v_cvt_pk_bf16_f32 v63, v210, v211
    v_mfma_f32_16x16x32_bf16 v[172:175], a[36:39], a[232:235], v[172:175]
    ds_write_b64 v36, v[62:63] offset:0
    v_fma_f32 v216, v248, v184, v216
    v_mfma_f32_16x16x32_bf16 v[180:183], a[40:43], a[248:251], v[180:183]
    v_fma_f32 v217, v249, v185, v217
    v_fma_f32 v218, v250, v186, v218
    v_fma_f32 v219, v251, v187, v219
    v_mfma_f32_16x16x32_bf16 v[188:191], a[44:47], a[248:251], v[188:191]
    v_cvt_pk_bf16_f32 v64, v216, v217
    v_cvt_pk_bf16_f32 v65, v218, v219
    v_mfma_f32_16x16x32_bf16 v[164:167], a[48:51], a[236:239], v[164:167]
    ds_write_b64 v37, v[64:65] offset:0
    v_mfma_f32_16x16x32_bf16 v[172:175], a[52:55], a[236:239], v[172:175]
    ds_read_b128 v[90:93], v38 offset:0
    ds_read_b128 v[94:97], v38 offset:1024
    v_mfma_f32_16x16x32_bf16 v[180:183], a[56:59], a[252:255], v[180:183]
    v_mfma_f32_16x16x32_bf16 v[188:191], a[60:63], a[252:255], v[188:191]
    s_nop 1
    v_pk_fma_f32 v[196:197], v[228:229], v[164:165], v[196:197]
    v_pk_fma_f32 v[198:199], v[230:231], v[166:167], v[198:199]
    v_cvt_pk_bf16_f32 v66, v196, v197
    v_cvt_pk_bf16_f32 v67, v198, v199
    ds_write_b64 v34, v[66:67] offset:2048
    v_pk_fma_f32 v[204:205], v[236:237], v[172:173], v[204:205]
    v_pk_fma_f32 v[206:207], v[238:239], v[174:175], v[206:207]
    v_cvt_pk_bf16_f32 v68, v204, v205
    v_cvt_pk_bf16_f32 v69, v206, v207
    ds_write_b64 v35, v[68:69] offset:2048
    s_waitcnt lgkmcnt(3)
    buffer_store_dwordx4 v[90:93], v2, s[44:47], s69 offen offset:0
    v_pk_fma_f32 v[212:213], v[244:245], v[180:181], v[212:213]
    v_pk_fma_f32 v[214:215], v[246:247], v[182:183], v[214:215]
    v_cvt_pk_bf16_f32 v70, v212, v213
    v_cvt_pk_bf16_f32 v71, v214, v215
    ds_write_b64 v36, v[70:71] offset:2048
    v_pk_fma_f32 v[220:221], v[252:253], v[188:189], v[220:221]
    v_pk_fma_f32 v[222:223], v[254:255], v[190:191], v[222:223]
    v_cvt_pk_bf16_f32 v72, v220, v221
    v_cvt_pk_bf16_f32 v73, v222, v223
ffn_pg6:
    s_cbranch_execz ffn_ret
    ds_write_b64 v37, v[72:73] offset:2048
    ds_read_b128 v[98:101], v38 offset:2048
    ds_read_b128 v[102:105], v38 offset:3072
    s_waitcnt lgkmcnt(6)
    buffer_store_dwordx4 v[94:97], v3, s[44:47], s69 offen offset:1024
    s_waitcnt lgkmcnt(1)
    buffer_store_dwordx4 v[98:101], v4, s[44:47], s69 offen offset:2048
    s_waitcnt lgkmcnt(0)
    buffer_store_dwordx4 v[102:105], v5, s[44:47], s69 offen offset:3072
    s_endpgm
k_help:
    s_waitcnt vmcnt(17)
    v_mov_b32 v8, s54
    s_mov_b64 exec, 1
    buffer_store_dword v8, off, s[28:31], s65 sc1
    s_mov_b64 exec, -1
    s_xor_b32 s65, s65, 512
    s_mul_i32 s51, s73, 12288
    v_lshl_add_u32 v106, v0, 7, s51
    v_and_b32 v9, 31, v0
    s_add_u32 s51, s51, 8192
    v_lshl_add_u32 v107, v9, 7, s51
    s_waitcnt vmcnt(15)
    v_cmp_ne_u32 vcc, s54, v20
    s_nop 0
    s_cbranch_vccnz slow_26
back_27:
    s_xor_b32 s66, s66, 384
    buffer_load_dword v108, v106, s[28:31], s9 offen sc1
    buffer_load_dword v108, v107, s[28:31], s9 offen sc1
    s_waitcnt vmcnt(3)
    v_mov_b32 v8, s54
    s_mov_b64 exec, 1
    buffer_store_dword v8, off, s[28:31], s65 sc1
    s_mov_b64 exec, -1
    v_and_b32 v9, 7, v0
    v_min_u32 v9, 4, v9
    v_lshrrev_b32 v10, 3, v0
    v_mul_u32_u24 v10, 40960, v10
    v_lshl_add_u32 v9, v9, 7, v10
    s_lshl_b32 s51, s73, 9
    s_add_u32 s51, s51, s69
    buffer_load_dword v108, v9, s[24:27], s51 offen
    s_add_u32 s51, s51, 327680
    buffer_load_dword v108, v9, s[24:27], s51 offen
    s_add_u32 s51, s51, 327680
    buffer_load_dword v108, v9, s[24:27], s51 offen
    s_add_u32 s51, s51, 327680
    buffer_load_dword v108, v9, s[24:27], s51 offen
    s_add_u32 s51, s51, 327680
    buffer_load_dword v20, v18, s[28:31], s66 offen sc1
    s_waitcnt vmcnt(0)
    v_cmp_ne_u32 vcc, s54, v20
    s_nop 0
    s_cbranch_vccnz slow_29
back_30:
    s_xor_b32 s66, s66, 256
    buffer_load_dword v108, v106, s[28:31], s10 offen sc1
    buffer_load_dword v108, v107, s[28:31], s10 offen sc1
    buffer_load_dword v20, v18, s[28:31], s66 offen sc1
    s_waitcnt vmcnt(0)
    v_cmp_ne_u32 vcc, s54, v20
    s_nop 0
    s_cbranch_vccnz slow_32
back_33:
    buffer_load_dword v108, v106, s[28:31], s11 offen sc1
    buffer_load_dword v108, v107, s[28:31], s11 offen sc1
    s_lshl_b32 s50, s2, 2
    s_add_u32 s50, s50, s3
    s_cmp_eq_u32 s50, 640
    s_cbranch_scc1 k_bump
    s_endpgm
k_bump:
    v_lshrrev_b32 v8, 3, v0
    v_lshlrev_b32 v8, 11, v8
    v_and_b32 v9, 7, v0
    v_min_u32 v9, 5, v9
    v_lshl_add_u32 v8, v9, 4, v8
    v_lshrrev_b32 v9, 4, v0
    v_lshlrev_b32 v9, 7, v9
    v_and_b32 v10, 15, v0
    v_lshl_add_u32 v9, v10, 2, v9
    s_mov_b32 s60, 262144
    s_mov_b32 s61, 131072
    buffer_load_dword v90, v8, s[28:31], s60 offen offset:0 sc1
    buffer_load_dword v91, v8, s[28:31], s60 offen offset:128 sc1
    buffer_load_dword v92, v8, s[28:31], s60 offen offset:256 sc1
    buffer_load_dword v93, v8, s[28:31], s60 offen offset:384 sc1
    buffer_load_dword v94, v9, s[28:31], s61 offen sc1
    s_waitcnt vmcnt(0)
    v_xor_b32 v94, s54, v94
    v_bitop3_b32 v94, v90, s54, v94 bitop3:0xbe
    v_bitop3_b32 v94, v91, s54, v94 bitop3:0xbe
    v_bitop3_b32 v94, v92, s54, v94 bitop3:0xbe
    v_bitop3_b32 v94, v93, s54, v94 bitop3:0xbe
    v_cmp_ne_u32 vcc, 0, v94
    s_nop 0
    s_cbranch_vccnz slow_35
back_36:
    s_mov_b32 s60, 0
    v_mov_b32 v8, s54
    s_mov_b64 exec, 1
    buffer_store_dword v8, off, s[28:31], s60 sc1
    s_mov_b64 exec, -1
    s_endpgm
slow_3:
    s_mov_b32 s55, 0
rt_5:
    buffer_load_dwordx4 v[90:93], v31, s[28:31], s78 offen offset:0 sc1
    buffer_load_dwordx4 v[94:97], v31, s[28:31], s78 offen offset:512 sc1
    buffer_load_dwordx4 v[98:101], v31, s[28:31], s79 offen offset:0 sc1
    buffer_load_dwordx4 v[102:105], v31, s[28:31], s79 offen offset:512 sc1
    s_waitcnt vmcnt(0)
    v_xor_b32 v105, s54, v105
    v_bitop3_b32 v105, v93, s54, v105 bitop3:0xbe
    v_bitop3_b32 v105, v97, s54, v105 bitop3:0xbe
    v_bitop3_b32 v105, v101, s54, v105 bitop3:0xbe
    v_cmp_ne_u32 vcc, 0, v105
    s_nop 0
    s_cbranch_vccz back_4
    s_add_u32 s55, s55, 1
    s_cmp_lt_u32 s55, 262144
    s_cbranch_scc1 rt_5
    s_nop 4
    s_branch back_4
slow_6:
    s_mov_b32 s55, 0
rt_8:
    buffer_load_dwordx4 v[34:37], v31, s[28:31], s78 offen offset:0 sc1
    buffer_load_dwordx4 v[38:41], v31, s[28:31], s78 offen offset:512 sc1
    s_waitcnt vmcnt(0)
    v_xor_b32 v41, s54, v41
    v_bitop3_b32 v41, v37, s54, v41 bitop3:0xbe
    v_cmp_ne_u32 vcc, 0, v41
    s_nop 0
    s_cbranch_vccz back_7
    s_add_u32 s55, s55, 1
    s_cmp_lt_u32 s55, 262144
    s_cbranch_scc1 rt_8
    s_nop 4
    s_branch back_7
slow_9:
    s_mov_b32 s55, 0
rt_11:
    buffer_load_dwordx4 v[90:93], v31, s[28:31], s79 offen offset:0 sc1
    buffer_load_dwordx4 v[94:97], v31, s[28:31], s79 offen offset:512 sc1
    s_waitcnt vmcnt(0)
    v_xor_b32 v97, s54, v97
    v_bitop3_b32 v97, v93, s54, v97 bitop3:0xbe
    v_cmp_ne_u32 vcc, 0, v97
    s_nop 0
    s_cbranch_vccz back_10
    s_add_u32 s55, s55, 1
    s_cmp_lt_u32 s55, 262144
    s_cbranch_scc1 rt_11
    s_nop 4
    s_branch back_10
slow_12:
    s_mov_b32 s55, 0
rt_14:
    buffer_load_dword v20, v18, s[28:31], s66 offen sc1
    s_waitcnt vmcnt(0)
    v_cmp_ne_u32 vcc, s54, v20
    s_nop 0
    s_cbranch_vccz back_13
    s_add_u32 s55, s55, 1
    s_cmp_lt_u32 s55, 262144
    s_cbranch_scc1 rt_14
    s_nop 4
    s_branch back_13
slow_15:
    s_mov_b32 s55, 0
rt_17:
    buffer_load_dword v20, v18, s[28:31], s66 offen sc1
    s_waitcnt vmcnt(0)
    v_cmp_ne_u32 vcc, s54, v20
    s_nop 0
    s_cbranch_vccz back_16
    s_add_u32 s55, s55, 1
    s_cmp_lt_u32 s55, 262144
    s_cbranch_scc1 rt_17
    s_nop 4
    s_branch back_16
slow_18:
    s_mov_b32 s55, 0
rt_20:
    buffer_load_dword v20, v18, s[28:31], s66 offen sc1
    s_waitcnt vmcnt(0)
    v_cmp_ne_u32 vcc, s54, v20
    s_nop 0
    s_cbranch_vccz back_19
    s_add_u32 s55, s55, 1
    s_cmp_lt_u32 s55, 262144
    s_cbranch_scc1 rt_20
    s_nop 4
    s_branch back_19
slow_21:
    s_mov_b32 s55, 0
rt_23:
    buffer_load_dword v20, v18, s[28:31], s66 offen sc1
    s_waitcnt vmcnt(0)
    v_cmp_ne_u32 vcc, s54, v20
    s_nop 0
    s_cbranch_vccz back_22
    s_add_u32 s55, s55, 1
    s_cmp_lt_u32 s55, 262144
    s_cbranch_scc1 rt_23
    s_nop 4
    s_branch back_22
slow_26:
    s_mov_b32 s55, 0
rt_28:
    buffer_load_dword v20, v18, s[28:31], s66 offen sc1
    s_waitcnt vmcnt(0)
    v_cmp_ne_u32 vcc, s54, v20
    s_nop 0
    s_cbranch_vccz back_27
    s_add_u32 s55, s55, 1
    s_cmp_lt_u32 s55, 262144
    s_cbranch_scc1 rt_28
    s_nop 4
    s_branch back_27
slow_29:
    s_mov_b32 s55, 0
rt_31:
    buffer_load_dword v20, v18, s[28:31], s66 offen sc1
    s_waitcnt vmcnt(0)
    v_cmp_ne_u32 vcc, s54, v20
    s_nop 0
    s_cbranch_vccz back_30
    s_add_u32 s55, s55, 1
    s_cmp_lt_u32 s55, 262144
    s_cbranch_scc1 rt_31
    s_nop 4
    s_branch back_30
slow_32:
    s_mov_b32 s55, 0
rt_34:
    buffer_load_dword v20, v18, s[28:31], s66 offen sc1
    s_waitcnt vmcnt(0)
    v_cmp_ne_u32 vcc, s54, v20
    s_nop 0
    s_cbranch_vccz back_33
    s_add_u32 s55, s55, 1
    s_cmp_lt_u32 s55, 262144
    s_cbranch_scc1 rt_34
    s_nop 4
    s_branch back_33
slow_35:
    s_mov_b32 s55, 0
rt_37:
    buffer_load_dword v90, v8, s[28:31], s60 offen offset:0 sc1
    buffer_load_dword v91, v8, s[28:31], s60 offen offset:128 sc1
    buffer_load_dword v92, v8, s[28:31], s60 offen offset:256 sc1
    buffer_load_dword v93, v8, s[28:31], s60 offen offset:384 sc1
    buffer_load_dword v94, v9, s[28:31], s61 offen sc1
    s_waitcnt vmcnt(0)
    v_xor_b32 v94, s54, v94
    v_bitop3_b32 v94, v90, s54, v94 bitop3:0xbe
    v_bitop3_b32 v94, v91, s54, v94 bitop3:0xbe
    v_bitop3_b32 v94, v92, s54, v94 bitop3:0xbe
    v_bitop3_b32 v94, v93, s54, v94 bitop3:0xbe
    v_cmp_ne_u32 vcc, 0, v94
    s_nop 0
    s_cbranch_vccz back_36
    s_add_u32 s55, s55, 1
    s_cmp_lt_u32 s55, 262144
    s_cbranch_scc1 rt_37
    s_nop 4
    s_branch back_36
ffn_end:
.p2align 12
k_spec:
    v_lshrrev_b32 v6, 4, v0
    v_and_b32 v7, 15, v0
    v_lshlrev_b32 v8, 4, v0
    v_and_b32 v2, 6, v0
    v_xor_b32 v2, v2, v6
    v_lshlrev_b32 v2, 4, v2
    v_lshl_add_u32 v2, v3, 7, v2
    v_bfe_u32 v4, v0, 3, 1
    v_mul_u32_u24 v4, 10240, v4
    s_mul_i32 s50, s3, 20480
    v_add3_u32 v12, v2, v4, s50
    v_xor_b32 v13, 64, v12
    v_cvt_f32_u32 v9, v6
    v_mul_f32 v9, 4.0, v9
    s_mul_i32 s58, s57, 0x80008000
    s_mul_i32 s59, s3, 5
    s_add_u32 s59, s59, 1
    s_lshr_b32 s59, s59, 1
    s_sub_u32 s62, 2, s57
    s_cmp_eq_u32 s56, 0
    s_cselect_b32 s63, 32, 64
    s_cselect_b32 s74, 0xffff, 0
    s_mov_b32 s75, 0
    s_bitcmp1_b32 s3, 0
    s_cselect_b64 s[32:33], s[8:9], s[6:7]
    s_mov_b32 s34, 1314816
    s_mov_b32 s35, 0x20000
    v_lshrrev_b32 v2, 1, v6
    v_and_b32 v3, 1, v6
    v_lshlrev_b32 v2, 2, v2
    v_add_lshl_u32 v2, v2, v3, 2
    v_cvt_f32_u32 v5, v2
    s_and_b32 s50, s3, 1
    s_lshl_b32 s50, s50, 5
    v_add_u32 v2, s50, v7
    v_cmp_eq_u32 vcc, 1, v2
    s_nop 1
    v_cndmask_b32 v2, v2, 64, vcc
    v_and_b32 v3, 1, v2
    v_lshrrev_b32 v2, 1, v2
    v_cvt_f32_u32 v3, v3
    v_cvt_f32_u32 v2, v2
    v_mul_f32 v2, 0x3c800000, v2
    v_mul_f32 v3, 0xbe800000, v3
    v_fmac_f32 v3, v2, v5
    v_fmamk_f32 v224, v2, 0x0, v3
    v_fmamk_f32 v225, v2, 0x3f800000, v3
    v_fmamk_f32 v226, v2, 0x40000000, v3
    v_fmamk_f32 v227, v2, 0x40400000, v3
    v_fmamk_f32 v228, v2, 0x41000000, v3
    v_fmamk_f32 v229, v2, 0x41100000, v3
    v_fmamk_f32 v230, v2, 0x41200000, v3
    v_fmamk_f32 v231, v2, 0x41300000, v3
    v_fmamk_f32 v232, v2, 0x42000000, v3
    v_fmamk_f32 v233, v2, 0x42040000, v3
    v_fmamk_f32 v234, v2, 0x42080000, v3
    v_fmamk_f32 v235, v2, 0x420c0000, v3
    v_fmamk_f32 v236, v2, 0x42200000, v3
    v_fmamk_f32 v237, v2, 0x42240000, v3
    v_fmamk_f32 v238, v2, 0x42280000, v3
    v_fmamk_f32 v239, v2, 0x422c0000, v3
    v_cos_f32 v224, v224
    v_cos_f32 v225, v225
    v_cos_f32 v226, v226
    v_cos_f32 v227, v227
    v_cos_f32 v228, v228
    v_cos_f32 v229, v229
    v_cos_f32 v230, v230
    v_cos_f32 v231, v231
    v_cos_f32 v232, v232
    v_cos_f32 v233, v233
    v_cos_f32 v234, v234
    v_cos_f32 v235, v235
    v_cos_f32 v236, v236
    v_cos_f32 v237, v237
    v_cos_f32 v238, v238
    v_cos_f32 v239, v239
    v_add_u32 v2, s50, v7
    v_add_u32 v2, 16, v2
    v_and_b32 v3, 1, v2
    v_lshrrev_b32 v2, 1, v2
    v_cvt_f32_u32 v3, v3
    v_cvt_f32_u32 v2, v2
    v_mul_f32 v2, 0x3c800000, v2
    v_mul_f32 v3, 0xbe800000, v3
    v_fmac_f32 v3, v2, v5
    v_fmamk_f32 v240, v2, 0x0, v3
    v_fmamk_f32 v241, v2, 0x3f800000, v3
    v_fmamk_f32 v242, v2, 0x40000000, v3
    v_fmamk_f32 v243, v2, 0x40400000, v3
    v_fmamk_f32 v244, v2, 0x41000000, v3
    v_fmamk_f32 v245, v2, 0x41100000, v3
    v_fmamk_f32 v246, v2, 0x41200000, v3
    v_fmamk_f32 v247, v2, 0x41300000, v3
    v_fmamk_f32 v248, v2, 0x42000000, v3
    v_fmamk_f32 v249, v2, 0x42040000, v3
    v_fmamk_f32 v250, v2, 0x42080000, v3
    v_fmamk_f32 v251, v2, 0x420c0000, v3
    v_fmamk_f32 v252, v2, 0x42200000, v3
    v_fmamk_f32 v253, v2, 0x42240000, v3
    v_fmamk_f32 v254, v2, 0x42280000, v3
    v_fmamk_f32 v255, v2, 0x422c0000, v3
    v_cos_f32 v240, v240
    v_cos_f32 v241, v241
    v_cos_f32 v242, v242
    v_cos_f32 v243, v243
    v_cos_f32 v244, v244
    v_cos_f32 v245, v245
    v_cos_f32 v246, v246
    v_cos_f32 v247, v247
    v_cos_f32 v248, v248
    v_cos_f32 v249, v249
    v_cos_f32 v250, v250
    v_cos_f32 v251, v251
    v_cos_f32 v252, v252
    v_cos_f32 v253, v253
    v_cos_f32 v254, v254
    v_cos_f32 v255, v255
    s_waitcnt lgkmcnt(0)
    s_mul_i32 s54, s54, 0x9E3779B1
    s_add_u32 s54, s54, 0x7F4A7C15
    s_lshl_b32 s50, s56, 2
    s_add_u32 s50, s50, s3
    s_mul_i32 s51, s57, 100
    s_add_u32 s51, s51, s50
    s_lshl_b32 s51, s51, 10
    s_add_u32 s51, s51, 524288
    s_cmp_lt_u32 s50, 100
    s_cselect_b32 s83, s51, 14680064
    s_mul_i32 s51, s50, 205
    s_lshr_b32 s51, s51, 10
    s_mul_i32 s52, s51, 5
    s_sub_u32 s50, s50, s52
    s_and_b32 s52, s51, 1
    s_mul_i32 s52, s52, 0x3e800000
    s_lshr_b32 s51, s51, 1
    s_lshl_b32 s51, s51, 4
    v_add_u32 v2, s51, v7
    v_cvt_f32_u32 v2, v2
    v_add_f32 v2, 0.5, v2
    v_mul_f32 v2, 0x3b4ccccd, v2
    v_cvt_f32_u32 v3, s62
    v_fma_f32 v3, v3, 0.5, v9
    v_fma_f32 v3, v2, v3, s52
    s_mul_i32 s51, s50, 5
    s_add_u32 s51, s51, 1
    s_lshr_b32 s51, s51, 1
    s_add_u32 s52, s51, 1
    s_cmp_eq_u32 s50, 4
    s_cselect_b32 s51, 2, s51
    s_cselect_b32 s52, 7, s52
    s_lshl_b32 s51, s51, 4
    s_lshl_b32 s52, s52, 4
    v_cvt_f32_u32 v4, s51
    v_cvt_f32_u32 v5, s52
    v_fma_f32 v52, v2, v4, v3
    v_fma_f32 v56, v2, v5, v3
    v_fmamk_f32 v53, v2, 0x3f800000, v52
    v_fmamk_f32 v54, v2, 0x40000000, v52
    v_fmamk_f32 v55, v2, 0x40400000, v52
    v_fmamk_f32 v57, v2, 0x3f800000, v56
    v_fmamk_f32 v58, v2, 0x40000000, v56
    v_fmamk_f32 v59, v2, 0x40400000, v56
    v_cos_f32 v52, v52
    v_cos_f32 v53, v53
    v_cos_f32 v54, v54
    v_cos_f32 v55, v55
    v_cos_f32 v56, v56
    v_cos_f32 v57, v57
    v_cos_f32 v58, v58
    v_cos_f32 v59, v59
    s_lshl_b32 s51, s57, 3
    s_add_u32 s51, s51, s50
    s_cmp_eq_u32 s51, 3
    s_cselect_b32 s51, 3, 4
    v_mul_f32 v2, 0.5, v59
    v_cmp_eq_u32 vcc, s51, v6
    s_nop 1
    v_cndmask_b32 v59, v59, v2, vcc
    v_cvt_pk_bf16_f32 v60, v52, v53
    v_cvt_pk_bf16_f32 v61, v54, v55
    v_cvt_pk_bf16_f32 v62, v56, v57
    v_cvt_pk_bf16_f32 v63, v58, v59
    v_lshrrev_b32 v2, 3, v0
    v_and_b32 v3, 7, v0
    v_mul_u32_u24 v14, 656, v2
    v_lshl_add_u32 v14, v3, 4, v14
    s_mul_i32 s50, s3, 10496
    s_add_u32 s50, s50, 81920
    v_add_u32 v14, s50, v14
    v_lshlrev_b32 v17, 2, v0
    s_mul_i32 s50, s63, 642
    v_and_b32 v4, 3, v2
    v_lshrrev_b32 v5, 5, v0
    v_lshl_add_u32 v4, v4, 2, v5
    v_sub_u32 v5, 13, v4
    s_cmp_ge_u32 s3, 2
    s_cselect_b64 vcc, -1, 0
    v_cndmask_b32 v4, v4, v5, vcc
    v_mul_u32_u24 v15, s50, v4
    s_mul_i32 s51, s56, 640
    s_lshl_b32 s68, s56, 1
    s_sub_u32 s69, 0, s68
    s_and_b32 s69, s69, 127
    s_mul_i32 s52, s56, 642
    s_sub_u32 s52, 1314816, s52
    s_sub_u32 s52, s52, s69
    s_mul_i32 s53, s50, 13
    s_sub_u32 s52, s52, s53
    s_sub_u32 s53, 0, s50
    s_cmp_ge_u32 s3, 2
    s_cselect_b32 s64, s52, s51
    s_cselect_b32 s50, s53, s50
    s_cselect_b32 s51, 657408, 0
    s_mul_i32 s65, s50, 2
    s_add_u32 s65, s65, s64
    s_mul_i32 s66, s50, 16
    s_add_u32 s66, s66, s64
    s_mul_i32 s67, s50, 18
    s_add_u32 s67, s67, s64
    s_cmp_eq_u32 s56, 0
    s_cselect_b32 s51, s51, 0
    s_sub_u32 s64, s64, s51
    v_add_u32 v16, s51, v15
    v_cmp_gt_u32 vcc, 8, v0
    s_nop 1
    v_cndmask_b32 v16, v16, v15, vcc
    v_and_b32 v4, 1, v2
    v_lshlrev_b32 v4, 2, v4
    v_xor_b32 v4, v4, v3
    v_lshl_add_u32 v15, v4, 4, v15
    v_lshl_add_u32 v16, v4, 4, v16
    s_mul_i32 s76, s3, 655360
    s_mul_i32 s50, s57, 40960
    s_mul_i32 s51, s56, 640
    s_add_u32 s76, s76, s50
    s_add_u32 s76, s76, s51
    s_add_u32 s76, s76, 1048576
    s_mul_i32 s78, s3, 655360
    s_add_u32 s78, s78, s50
    s_mul_i32 s50, s56, 1280
    s_add_u32 s78, s78, s50
    s_add_u32 s78, s78, 4194304
    s_lshl_b32 s51, s56, 1
    s_add_u32 s51, s51, s57
    s_lshl_b32 s51, s51, 2
    s_add_u32 s51, s51, s3
    s_mul_i32 s77, s51, 10240
    s_add_u32 s77, s77, 1048576
    s_lshl_b32 s51, s57, 2
    s_add_u32 s50, s51, s3
    s_lshl_b32 s50, s50, 5
    s_add_u32 s50, s50, s56
    s_lshl_b32 s50, s50, 7
    s_add_u32 s81, s50, 196608
    s_and_b32 s52, s3, 1
    s_lshl_b32 s50, s3, 4
    s_add_u32 s50, s50, s57
    s_lshl_b32 s50, s50, 1
    s_lshr_b32 s51, s56, 4
    s_add_u32 s50, s50, s51
    s_lshl_b32 s50, s50, 5
    s_and_b32 s51, s56, 15
    s_add_u32 s50, s50, s51
    s_lshl_b32 s50, s50, 2
    s_add_u32 s80, s50, 131072
    s_lshl_b32 s50, s56, 1
    s_add_u32 s50, s50, s57
    s_lshl_b32 s50, s50, 1
    s_add_u32 s50, s50, s52
    s_lshl_b32 s50, s50, 7
    s_add_u32 s79, s50, 131072
    v_bfe_u32 v2, v0, 2, 3
    v_lshlrev_b32 v2, 7, v2
    v_lshrrev_b32 v3, 5, v0
    v_mul_u32_u24 v3, 20480, v3
    v_add_u32 v2, v2, v3
    v_and_b32 v3, 3, v0
    v_lshl_add_u32 v2, v3, 3, v2
    v_bfe_u32 v3, v0, 3, 2
    v_lshl_add_u32 v2, v3, 5, v2
    s_lshr_b32 s50, s3, 1
    s_mul_i32 s50, s50, 5
    s_add_u32 s51, s50, 0
    s_and_b32 s52, s51, 3
    s_lshl_b32 s52, s52, 5
    s_lshr_b32 s51, s51, 2
    s_lshl_b32 s51, s51, 10
    v_xor_b32 v18, s52, v2
    v_add_u32 v18, s51, v18
    s_sub_u32 s51, 19, s50
    s_and_b32 s52, s51, 3
    s_lshl_b32 s52, s52, 5
    s_or_b32 s52, s52, 24
    s_lshr_b32 s51, s51, 2
    s_lshl_b32 s51, s51, 10
    v_xor_b32 v19, s52, v2
    v_add_u32 v19, s51, v19
    s_add_u32 s51, s50, 1
    s_and_b32 s52, s51, 3
    s_lshl_b32 s52, s52, 5
    s_lshr_b32 s51, s51, 2
    s_lshl_b32 s51, s51, 10
    v_xor_b32 v20, s52, v2
    v_add_u32 v20, s51, v20
    s_sub_u32 s51, 18, s50
    s_and_b32 s52, s51, 3
    s_lshl_b32 s52, s52, 5
    s_or_b32 s52, s52, 24
    s_lshr_b32 s51, s51, 2
    s_lshl_b32 s51, s51, 10
    v_xor_b32 v21, s52, v2
    v_add_u32 v21, s51, v21
    s_add_u32 s51, s50, 2
    s_and_b32 s52, s51, 3
    s_lshl_b32 s52, s52, 5
    s_lshr_b32 s51, s51, 2
    s_lshl_b32 s51, s51, 10
    v_xor_b32 v22, s52, v2
    v_add_u32 v22, s51, v22
    s_sub_u32 s51, 17, s50
    s_and_b32 s52, s51, 3
    s_lshl_b32 s52, s52, 5
    s_or_b32 s52, s52, 24
    s_lshr_b32 s51, s51, 2
    s_lshl_b32 s51, s51, 10
    v_xor_b32 v23, s52, v2
    v_add_u32 v23, s51, v23
    s_add_u32 s51, s50, 3
    s_and_b32 s52, s51, 3
    s_lshl_b32 s52, s52, 5
    s_lshr_b32 s51, s51, 2
    s_lshl_b32 s51, s51, 10
    v_xor_b32 v24, s52, v2
    v_add_u32 v24, s51, v24
    s_sub_u32 s51, 16, s50
    s_and_b32 s52, s51, 3
    s_lshl_b32 s52, s52, 5
    s_or_b32 s52, s52, 24
    s_lshr_b32 s51, s51, 2
    s_lshl_b32 s51, s51, 10
    v_xor_b32 v25, s52, v2
    v_add_u32 v25, s51, v25
    s_add_u32 s51, s50, 4
    s_and_b32 s52, s51, 3
    s_lshl_b32 s52, s52, 5
    s_lshr_b32 s51, s51, 2
    s_lshl_b32 s51, s51, 10
    v_xor_b32 v26, s52, v2
    v_add_u32 v26, s51, v26
    s_sub_u32 s51, 15, s50
    s_and_b32 s52, s51, 3
    s_lshl_b32 s52, s52, 5
    s_or_b32 s52, s52, 24
    s_lshr_b32 s51, s51, 2
    s_lshl_b32 s51, s51, 10
    v_xor_b32 v27, s52, v2
    v_add_u32 v27, s51, v27
    s_and_b32 s51, s3, 1
    s_mul_i32 s51, s51, 20992
    s_add_u32 s51, s51, 81920
    v_mul_u32_u24 v28, 656, v7
    v_lshl_add_u32 v28, v6, 4, v28
    v_add_u32 v28, s51, v28
    s_lshr_b32 s50, s3, 1
    s_lshl_b32 s50, s50, 3
    v_add_u32 v28, s50, v28
    v_mul_u32_u24 v2, 81920, v6
    v_bfe_u32 v3, v0, 3, 1
    v_mul_u32_u24 v3, 20480, v3
    v_and_b32 v4, 7, v0
    v_add_u32 v2, v2, v3
    v_lshl_add_u32 v29, v4, 4, v2
    s_lshl_b32 s50, s3, 4
    v_add_u32 v3, s50, v7
    v_lshlrev_b32 v30, 2, v3
    v_add_u32 v30, 155648, v30
    v_lshlrev_b32 v31, 1, v3
    v_add_u32 v31, 155904, v31
    s_lshl_b32 s50, s56, 10
    s_add_u32 s50, s50, 65536
    v_lshl_add_u32 v32, v3, 4, s50
    v_lshrrev_b32 v2, 1, v6
    v_and_b32 v3, 1, v6
    v_lshlrev_b32 v2, 2, v2
    v_add_lshl_u32 v2, v2, v3, 3
    v_lshlrev_b32 v3, 1, v2
    v_add_u32 v34, 155648, v3
    v_add_u32 v35, 155904, v2
    v_mov_b32 v36, 0x3f803f80
    v_mov_b32 v37, 0x3f803f80
    v_mov_b32 v38, 0x3f803f80
    v_mov_b32 v39, 0x3f803f80
    v_mov_b32 v43, s54
    s_mov_b32 s40, s16
    s_mov_b32 s41, s17
    s_mov_b32 s42, 1966080
    s_mov_b32 s43, 0x20000
    s_add_u32 s50, s59, 0
    s_lshl_b32 s50, s50, 4
    v_add_u32 v2, s50, v7
    v_lshl_add_u32 v2, v2, 1, s62
    v_cvt_f32_u32 v2, v2
    v_mul_f32 v84, 0x3acccccd, v2
    v_add_f32 v3, 0.5, v9
    v_mul_f32 v85, v84, v3
    v_mul_f32 v4, 0x41800000, v84
    v_cos_f32 v4, v4
    v_fmamk_f32 v92, v84, 0x0, v85
    v_fmamk_f32 v93, v84, 0x3f800000, v85
    v_fmamk_f32 v94, v84, 0x40000000, v85
    v_fmamk_f32 v95, v84, 0x40400000, v85
    v_cos_f32 v88, v92
    v_cos_f32 v89, v93
    v_cos_f32 v90, v94
    v_cos_f32 v91, v95
    v_sin_f32_e64 v92, -v92
    v_sin_f32_e64 v93, -v93
    v_sin_f32_e64 v94, -v94
    v_sin_f32_e64 v95, -v95
    v_add_f32 v86, v4, v4
    v_add_f32 v87, v4, v4
    v_cvt_pk_bf16_f32 v112, v88, v89
    v_cvt_pk_bf16_f32 v113, v90, v91
    v_cvt_pk_bf16_f32 v114, v92, v93
    v_cvt_pk_bf16_f32 v115, v94, v95
    v_accvgpr_write_b32 a0, v112
    v_accvgpr_write_b32 a1, v113
    v_accvgpr_write_b32 a60, v114
    v_accvgpr_write_b32 a61, v115
    s_add_u32 m0, s73, 7168
    s_nop 0
    buffer_load_dwordx4 v10, s[24:27], s60 offen offset:1024 lds
    v_fmamk_f32 v100, v84, 0x41800000, v85
    v_fmamk_f32 v101, v84, 0x41880000, v85
    v_fmamk_f32 v102, v84, 0x41900000, v85
    v_fmamk_f32 v103, v84, 0x41980000, v85
    v_cos_f32 v96, v100
    v_cos_f32 v97, v101
    v_cos_f32 v98, v102
    v_cos_f32 v99, v103
    v_sin_f32_e64 v100, -v100
    v_sin_f32_e64 v101, -v101
    v_sin_f32_e64 v102, -v102
    v_sin_f32_e64 v103, -v103
    v_cvt_pk_bf16_f32 v116, v96, v97
    v_cvt_pk_bf16_f32 v117, v98, v99
    v_cvt_pk_bf16_f32 v118, v100, v101
    v_cvt_pk_bf16_f32 v119, v102, v103
    v_accvgpr_write_b32 a4, v116
    v_accvgpr_write_b32 a5, v117
    v_accvgpr_write_b32 a64, v118
    v_accvgpr_write_b32 a65, v119
    s_add_u32 m0, s73, 8064
    s_nop 0
    buffer_load_dwordx4 v10, s[24:27], s60 offen offset:1152 lds
    v_pk_fma_f32 v[104:105], v[86:87], v[96:97], v[88:89] neg_lo:[0,0,1] neg_hi:[0,0,1]
    v_pk_fma_f32 v[106:107], v[86:87], v[98:99], v[90:91] neg_lo:[0,0,1] neg_hi:[0,0,1]
    v_pk_fma_f32 v[108:109], v[86:87], v[100:101], v[92:93] neg_lo:[0,0,1] neg_hi:[0,0,1]
    v_pk_fma_f32 v[110:111], v[86:87], v[102:103], v[94:95] neg_lo:[0,0,1] neg_hi:[0,0,1]
    v_cvt_pk_bf16_f32 v112, v104, v105
    v_cvt_pk_bf16_f32 v113, v106, v107
    v_cvt_pk_bf16_f32 v114, v108, v109
    v_cvt_pk_bf16_f32 v115, v110, v111
    v_accvgpr_write_b32 a8, v112
    v_accvgpr_write_b32 a9, v113
    v_accvgpr_write_b32 a68, v114
    v_accvgpr_write_b32 a69, v115
    s_add_u32 m0, s72, 0
    s_nop 0
    buffer_load_dwordx4 v10, s[24:27], s61 offen offset:0 lds
    v_pk_fma_f32 v[88:89], v[86:87], v[104:105], v[96:97] neg_lo:[0,0,1] neg_hi:[0,0,1]
    v_pk_fma_f32 v[90:91], v[86:87], v[106:107], v[98:99] neg_lo:[0,0,1] neg_hi:[0,0,1]
    v_pk_fma_f32 v[92:93], v[86:87], v[108:109], v[100:101] neg_lo:[0,0,1] neg_hi:[0,0,1]
    v_pk_fma_f32 v[94:95], v[86:87], v[110:111], v[102:103] neg_lo:[0,0,1] neg_hi:[0,0,1]
    v_cvt_pk_bf16_f32 v116, v88, v89
    v_cvt_pk_bf16_f32 v117, v90, v91
    v_cvt_pk_bf16_f32 v118, v92, v93
    v_cvt_pk_bf16_f32 v119, v94, v95
    v_accvgpr_write_b32 a12, v116
    v_accvgpr_write_b32 a13, v117
    v_accvgpr_write_b32 a72, v118
    v_accvgpr_write_b32 a73, v119
    s_add_u32 m0, s72, 896
    s_nop 0
    buffer_load_dwordx4 v10, s[24:27], s61 offen offset:128 lds
    v_pk_fma_f32 v[96:97], v[86:87], v[88:89], v[104:105] neg_lo:[0,0,1] neg_hi:[0,0,1]
    v_pk_fma_f32 v[98:99], v[86:87], v[90:91], v[106:107] neg_lo:[0,0,1] neg_hi:[0,0,1]
    v_pk_fma_f32 v[100:101], v[86:87], v[92:93], v[108:109] neg_lo:[0,0,1] neg_hi:[0,0,1]
    v_pk_fma_f32 v[102:103], v[86:87], v[94:95], v[110:111] neg_lo:[0,0,1] neg_hi:[0,0,1]
    v_cvt_pk_bf16_f32 v112, v96, v97
    v_cvt_pk_bf16_f32 v113, v98, v99
    v_cvt_pk_bf16_f32 v114, v100, v101
    v_cvt_pk_bf16_f32 v115, v102, v103
    v_accvgpr_write_b32 a16, v112
    v_accvgpr_write_b32 a17, v113
    v_accvgpr_write_b32 a76, v114
    v_accvgpr_write_b32 a77, v115
    s_add_u32 m0, s72, 1792
    s_nop 0
    buffer_load_dwordx4 v10, s[24:27], s61 offen offset:256 lds
    v_pk_fma_f32 v[104:105], v[86:87], v[96:97], v[88:89] neg_lo:[0,0,1] neg_hi:[0,0,1]
    v_pk_fma_f32 v[106:107], v[86:87], v[98:99], v[90:91] neg_lo:[0,0,1] neg_hi:[0,0,1]
    v_pk_fma_f32 v[108:109], v[86:87], v[100:101], v[92:93] neg_lo:[0,0,1] neg_hi:[0,0,1]
    v_pk_fma_f32 v[110:111], v[86:87], v[102:103], v[94:95] neg_lo:[0,0,1] neg_hi:[0,0,1]
    v_cvt_pk_bf16_f32 v116, v104, v105
    v_cvt_pk_bf16_f32 v117, v106, v107
    v_cvt_pk_bf16_f32 v118, v108, v109
    v_cvt_pk_bf16_f32 v119, v110, v111
    v_accvgpr_write_b32 a2, v116
    v_accvgpr_write_b32 a3, v117
    v_accvgpr_write_b32 a62, v118
    v_accvgpr_write_b32 a63, v119
    s_add_u32 m0, s72, 2688
    s_nop 0
    buffer_load_dwordx4 v10, s[24:27], s61 offen offset:384 lds
    v_pk_fma_f32 v[88:89], v[86:87], v[104:105], v[96:97] neg_lo:[0,0,1] neg_hi:[0,0,1]
    v_pk_fma_f32 v[90:91], v[86:87], v[106:107], v[98:99] neg_lo:[0,0,1] neg_hi:[0,0,1]
    v_pk_fma_f32 v[92:93], v[86:87], v[108:109], v[100:101] neg_lo:[0,0,1] neg_hi:[0,0,1]
    v_pk_fma_f32 v[94:95], v[86:87], v[110:111], v[102:103] neg_lo:[0,0,1] neg_hi:[0,0,1]
    v_cvt_pk_bf16_f32 v112, v88, v89
    v_cvt_pk_bf16_f32 v113, v90, v91
    v_cvt_pk_bf16_f32 v114, v92, v93
    v_cvt_pk_bf16_f32 v115, v94, v95
    v_accvgpr_write_b32 a6, v112
    v_accvgpr_write_b32 a7, v113
    v_accvgpr_write_b32 a66, v114
    v_accvgpr_write_b32 a67, v115
    s_add_u32 m0, s72, 3584
    s_nop 0
    buffer_load_dwordx4 v10, s[24:27], s61 offen offset:512 lds
    v_pk_fma_f32 v[96:97], v[86:87], v[88:89], v[104:105] neg_lo:[0,0,1] neg_hi:[0,0,1]
    v_pk_fma_f32 v[98:99], v[86:87], v[90:91], v[106:107] neg_lo:[0,0,1] neg_hi:[0,0,1]
    v_pk_fma_f32 v[100:101], v[86:87], v[92:93], v[108:109] neg_lo:[0,0,1] neg_hi:[0,0,1]
    v_pk_fma_f32 v[102:103], v[86:87], v[94:95], v[110:111] neg_lo:[0,0,1] neg_hi:[0,0,1]
    v_cvt_pk_bf16_f32 v116, v96, v97
    v_cvt_pk_bf16_f32 v117, v98, v99
    v_cvt_pk_bf16_f32 v118, v100, v101
    v_cvt_pk_bf16_f32 v119, v102, v103
    v_accvgpr_write_b32 a10, v116
    v_accvgpr_write_b32 a11, v117
    v_accvgpr_write_b32 a70, v118
    v_accvgpr_write_b32 a71, v119
    s_add_u32 m0, s72, 4480
    s_nop 0
    buffer_load_dwordx4 v10, s[24:27], s61 offen offset:640 lds
    v_pk_fma_f32 v[104:105], v[86:87], v[96:97], v[88:89] neg_lo:[0,0,1] neg_hi:[0,0,1]
    v_pk_fma_f32 v[106:107], v[86:87], v[98:99], v[90:91] neg_lo:[0,0,1] neg_hi:[0,0,1]
    v_pk_fma_f32 v[108:109], v[86:87], v[100:101], v[92:93] neg_lo:[0,0,1] neg_hi:[0,0,1]
    v_pk_fma_f32 v[110:111], v[86:87], v[102:103], v[94:95] neg_lo:[0,0,1] neg_hi:[0,0,1]
    v_cvt_pk_bf16_f32 v112, v104, v105
    v_cvt_pk_bf16_f32 v113, v106, v107
    v_cvt_pk_bf16_f32 v114, v108, v109
    v_cvt_pk_bf16_f32 v115, v110, v111
    v_accvgpr_write_b32 a14, v112
    v_accvgpr_write_b32 a15, v113
    v_accvgpr_write_b32 a74, v114
    v_accvgpr_write_b32 a75, v115
    s_add_u32 m0, s72, 5376
    s_nop 0
    buffer_load_dwordx4 v10, s[24:27], s61 offen offset:768 lds
    v_pk_fma_f32 v[88:89], v[86:87], v[104:105], v[96:97] neg_lo:[0,0,1] neg_hi:[0,0,1]
    v_pk_fma_f32 v[90:91], v[86:87], v[106:107], v[98:99] neg_lo:[0,0,1] neg_hi:[0,0,1]
    v_pk_fma_f32 v[92:93], v[86:87], v[108:109], v[100:101] neg_lo:[0,0,1] neg_hi:[0,0,1]
    v_pk_fma_f32 v[94:95], v[86:87], v[110:111], v[102:103] neg_lo:[0,0,1] neg_hi:[0,0,1]
    v_cvt_pk_bf16_f32 v116, v88, v89
    v_cvt_pk_bf16_f32 v117, v90, v91
    v_cvt_pk_bf16_f32 v118, v92, v93
    v_cvt_pk_bf16_f32 v119, v94, v95
    v_accvgpr_write_b32 a18, v116
    v_accvgpr_write_b32 a19, v117
    v_accvgpr_write_b32 a78, v118
    v_accvgpr_write_b32 a79, v119
    s_add_u32 m0, s72, 6272
    s_nop 0
    buffer_load_dwordx4 v10, s[24:27], s61 offen offset:896 lds
    s_add_u32 s50, s59, 1
    s_lshl_b32 s50, s50, 4
    v_add_u32 v2, s50, v7
    v_lshl_add_u32 v2, v2, 1, s62
    v_cvt_f32_u32 v2, v2
    v_mul_f32 v84, 0x3acccccd, v2
    v_add_f32 v3, 0.5, v9
    v_mul_f32 v85, v84, v3
    v_mul_f32 v4, 0x41800000, v84
    v_cos_f32 v4, v4
    v_fmamk_f32 v92, v84, 0x0, v85
    v_fmamk_f32 v93, v84, 0x3f800000, v85
    v_fmamk_f32 v94, v84, 0x40000000, v85
    v_fmamk_f32 v95, v84, 0x40400000, v85
    v_cos_f32 v88, v92
    v_cos_f32 v89, v93
    v_cos_f32 v90, v94
    v_cos_f32 v91, v95
    v_sin_f32_e64 v92, -v92
    v_sin_f32_e64 v93, -v93
    v_sin_f32_e64 v94, -v94
    v_sin_f32_e64 v95, -v95
    v_add_f32 v86, v4, v4
    v_add_f32 v87, v4, v4
    v_cvt_pk_bf16_f32 v112, v88, v89
    v_cvt_pk_bf16_f32 v113, v90, v91
    v_cvt_pk_bf16_f32 v114, v92, v93
    v_cvt_pk_bf16_f32 v115, v94, v95
    v_accvgpr_write_b32 a20, v112
    v_accvgpr_write_b32 a21, v113
    v_accvgpr_write_b32 a80, v114
    v_accvgpr_write_b32 a81, v115
    s_add_u32 m0, s72, 7168
    s_nop 0
    buffer_load_dwordx4 v10, s[24:27], s61 offen offset:1024 lds
    v_fmamk_f32 v100, v84, 0x41800000, v85
    v_fmamk_f32 v101, v84, 0x41880000, v85
    v_fmamk_f32 v102, v84, 0x41900000, v85
    v_fmamk_f32 v103, v84, 0x41980000, v85
    v_cos_f32 v96, v100
    v_cos_f32 v97, v101
    v_cos_f32 v98, v102
    v_cos_f32 v99, v103
    v_sin_f32_e64 v100, -v100
    v_sin_f32_e64 v101, -v101
    v_sin_f32_e64 v102, -v102
    v_sin_f32_e64 v103, -v103
    v_cvt_pk_bf16_f32 v116, v96, v97
    v_cvt_pk_bf16_f32 v117, v98, v99
    v_cvt_pk_bf16_f32 v118, v100, v101
    v_cvt_pk_bf16_f32 v119, v102, v103
    v_accvgpr_write_b32 a24, v116
    v_accvgpr_write_b32 a25, v117
    v_accvgpr_write_b32 a84, v118
    v_accvgpr_write_b32 a85, v119
    s_add_u32 m0, s72, 8064
    s_nop 0
    buffer_load_dwordx4 v10, s[24:27], s61 offen offset:1152 lds
    v_pk_fma_f32 v[104:105], v[86:87], v[96:97], v[88:89] neg_lo:[0,0,1] neg_hi:[0,0,1]
    v_pk_fma_f32 v[106:107], v[86:87], v[98:99], v[90:91] neg_lo:[0,0,1] neg_hi:[0,0,1]
    v_pk_fma_f32 v[108:109], v[86:87], v[100:101], v[92:93] neg_lo:[0,0,1] neg_hi:[0,0,1]
    v_pk_fma_f32 v[110:111], v[86:87], v[102:103], v[94:95] neg_lo:[0,0,1] neg_hi:[0,0,1]
    v_cvt_pk_bf16_f32 v112, v104, v105
    v_cvt_pk_bf16_f32 v113, v106, v107
    v_cvt_pk_bf16_f32 v114, v108, v109
    v_cvt_pk_bf16_f32 v115, v110, v111
    v_accvgpr_write_b32 a28, v112
    v_accvgpr_write_b32 a29, v113
    v_accvgpr_write_b32 a88, v114
    v_accvgpr_write_b32 a89, v115
    v_pk_fma_f32 v[88:89], v[86:87], v[104:105], v[96:97] neg_lo:[0,0,1] neg_hi:[0,0,1]
    v_pk_fma_f32 v[90:91], v[86:87], v[106:107], v[98:99] neg_lo:[0,0,1] neg_hi:[0,0,1]
    v_pk_fma_f32 v[92:93], v[86:87], v[108:109], v[100:101] neg_lo:[0,0,1] neg_hi:[0,0,1]
    v_pk_fma_f32 v[94:95], v[86:87], v[110:111], v[102:103] neg_lo:[0,0,1] neg_hi:[0,0,1]
    v_cvt_pk_bf16_f32 v116, v88, v89
    v_cvt_pk_bf16_f32 v117, v90, v91
    v_cvt_pk_bf16_f32 v118, v92, v93
    v_cvt_pk_bf16_f32 v119, v94, v95
    v_accvgpr_write_b32 a32, v116
    v_accvgpr_write_b32 a33, v117
    v_accvgpr_write_b32 a92, v118
    v_accvgpr_write_b32 a93, v119
    v_pk_fma_f32 v[96:97], v[86:87], v[88:89], v[104:105] neg_lo:[0,0,1] neg_hi:[0,0,1]
    v_pk_fma_f32 v[98:99], v[86:87], v[90:91], v[106:107] neg_lo:[0,0,1] neg_hi:[0,0,1]
    v_pk_fma_f32 v[100:101], v[86:87], v[92:93], v[108:109] neg_lo:[0,0,1] neg_hi:[0,0,1]
    v_pk_fma_f32 v[102:103], v[86:87], v[94:95], v[110:111] neg_lo:[0,0,1] neg_hi:[0,0,1]
    v_cvt_pk_bf16_f32 v112, v96, v97
    v_cvt_pk_bf16_f32 v113, v98, v99
    v_cvt_pk_bf16_f32 v114, v100, v101
    v_cvt_pk_bf16_f32 v115, v102, v103
    v_accvgpr_write_b32 a36, v112
    v_accvgpr_write_b32 a37, v113
    v_accvgpr_write_b32 a96, v114
    v_accvgpr_write_b32 a97, v115
    v_pk_fma_f32 v[104:105], v[86:87], v[96:97], v[88:89] neg_lo:[0,0,1] neg_hi:[0,0,1]
    v_pk_fma_f32 v[106:107], v[86:87], v[98:99], v[90:91] neg_lo:[0,0,1] neg_hi:[0,0,1]
    v_pk_fma_f32 v[108:109], v[86:87], v[100:101], v[92:93] neg_lo:[0,0,1] neg_hi:[0,0,1]
    v_pk_fma_f32 v[110:111], v[86:87], v[102:103], v[94:95] neg_lo:[0,0,1] neg_hi:[0,0,1]
    v_cvt_pk_bf16_f32 v116, v104, v105
    v_cvt_pk_bf16_f32 v117, v106, v107
    v_cvt_pk_bf16_f32 v118, v108, v109
    v_cvt_pk_bf16_f32 v119, v110, v111
    v_accvgpr_write_b32 a22, v116
    v_accvgpr_write_b32 a23, v117
    v_accvgpr_write_b32 a82, v118
    v_accvgpr_write_b32 a83, v119
    v_pk_fma_f32 v[88:89], v[86:87], v[104:105], v[96:97] neg_lo:[0,0,1] neg_hi:[0,0,1]
    v_pk_fma_f32 v[90:91], v[86:87], v[106:107], v[98:99] neg_lo:[0,0,1] neg_hi:[0,0,1]
    v_pk_fma_f32 v[92:93], v[86:87], v[108:109], v[100:101] neg_lo:[0,0,1] neg_hi:[0,0,1]
    v_pk_fma_f32 v[94:95], v[86:87], v[110:111], v[102:103] neg_lo:[0,0,1] neg_hi:[0,0,1]
    v_cvt_pk_bf16_f32 v112, v88, v89
    v_cvt_pk_bf16_f32 v113, v90, v91
    v_cvt_pk_bf16_f32 v114, v92, v93
    v_cvt_pk_bf16_f32 v115, v94, v95
    v_accvgpr_write_b32 a26, v112
    v_accvgpr_write_b32 a27, v113
    v_accvgpr_write_b32 a86, v114
    v_accvgpr_write_b32 a87, v115
    v_pk_fma_f32 v[96:97], v[86:87], v[88:89], v[104:105] neg_lo:[0,0,1] neg_hi:[0,0,1]
    v_pk_fma_f32 v[98:99], v[86:87], v[90:91], v[106:107] neg_lo:[0,0,1] neg_hi:[0,0,1]
    v_pk_fma_f32 v[100:101], v[86:87], v[92:93], v[108:109] neg_lo:[0,0,1] neg_hi:[0,0,1]
    v_pk_fma_f32 v[102:103], v[86:87], v[94:95], v[110:111] neg_lo:[0,0,1] neg_hi:[0,0,1]
    v_cvt_pk_bf16_f32 v116, v96, v97
    v_cvt_pk_bf16_f32 v117, v98, v99
    v_cvt_pk_bf16_f32 v118, v100, v101
    v_cvt_pk_bf16_f32 v119, v102, v103
    v_accvgpr_write_b32 a30, v116
    v_accvgpr_write_b32 a31, v117
    v_accvgpr_write_b32 a90, v118
    v_accvgpr_write_b32 a91, v119
    v_pk_fma_f32 v[104:105], v[86:87], v[96:97], v[88:89] neg_lo:[0,0,1] neg_hi:[0,0,1]
    v_pk_fma_f32 v[106:107], v[86:87], v[98:99], v[90:91] neg_lo:[0,0,1] neg_hi:[0,0,1]
    v_pk_fma_f32 v[108:109], v[86:87], v[100:101], v[92:93] neg_lo:[0,0,1] neg_hi:[0,0,1]
    v_pk_fma_f32 v[110:111], v[86:87], v[102:103], v[94:95] neg_lo:[0,0,1] neg_hi:[0,0,1]
    v_cvt_pk_bf16_f32 v112, v104, v105
    v_cvt_pk_bf16_f32 v113, v106, v107
    v_cvt_pk_bf16_f32 v114, v108, v109
    v_cvt_pk_bf16_f32 v115, v110, v111
    v_accvgpr_write_b32 a34, v112
    v_accvgpr_write_b32 a35, v113
    v_accvgpr_write_b32 a94, v114
    v_accvgpr_write_b32 a95, v115
    v_pk_fma_f32 v[88:89], v[86:87], v[104:105], v[96:97] neg_lo:[0,0,1] neg_hi:[0,0,1]
    v_pk_fma_f32 v[90:91], v[86:87], v[106:107], v[98:99] neg_lo:[0,0,1] neg_hi:[0,0,1]
    v_pk_fma_f32 v[92:93], v[86:87], v[108:109], v[100:101] neg_lo:[0,0,1] neg_hi:[0,0,1]
    v_pk_fma_f32 v[94:95], v[86:87], v[110:111], v[102:103] neg_lo:[0,0,1] neg_hi:[0,0,1]
    v_cvt_pk_bf16_f32 v116, v88, v89
    v_cvt_pk_bf16_f32 v117, v90, v91
    v_cvt_pk_bf16_f32 v118, v92, v93
    v_cvt_pk_bf16_f32 v119, v94, v95
    v_accvgpr_write_b32 a38, v116
    v_accvgpr_write_b32 a39, v117
    v_accvgpr_write_b32 a98, v118
    v_accvgpr_write_b32 a99, v119
    s_add_u32 s50, s59, 2
    s_lshl_b32 s50, s50, 4
    v_add_u32 v2, s50, v7
    v_lshl_add_u32 v2, v2, 1, s62
    v_cvt_f32_u32 v2, v2
    v_mul_f32 v84, 0x3acccccd, v2
    v_add_f32 v3, 0.5, v9
    v_mul_f32 v85, v84, v3
    v_mul_f32 v4, 0x41800000, v84
    v_cos_f32 v4, v4
    v_fmamk_f32 v92, v84, 0x0, v85
    v_fmamk_f32 v93, v84, 0x3f800000, v85
    v_fmamk_f32 v94, v84, 0x40000000, v85
    v_fmamk_f32 v95, v84, 0x40400000, v85
    v_cos_f32 v88, v92
    v_cos_f32 v89, v93
    v_cos_f32 v90, v94
    v_cos_f32 v91, v95
    v_sin_f32_e64 v92, -v92
    v_sin_f32_e64 v93, -v93
    v_sin_f32_e64 v94, -v94
    v_sin_f32_e64 v95, -v95
    v_add_f32 v86, v4, v4
    v_add_f32 v87, v4, v4
    v_cvt_pk_bf16_f32 v112, v88, v89
    v_cvt_pk_bf16_f32 v113, v90, v91
    v_cvt_pk_bf16_f32 v114, v92, v93
    v_cvt_pk_bf16_f32 v115, v94, v95
    v_accvgpr_write_b32 a40, v112
    v_accvgpr_write_b32 a41, v113
    v_accvgpr_write_b32 a100, v114
    v_accvgpr_write_b32 a101, v115
    v_fmamk_f32 v100, v84, 0x41800000, v85
    v_fmamk_f32 v101, v84, 0x41880000, v85
    v_fmamk_f32 v102, v84, 0x41900000, v85
    v_fmamk_f32 v103, v84, 0x41980000, v85
    v_cos_f32 v96, v100
    v_cos_f32 v97, v101
    v_cos_f32 v98, v102
    v_cos_f32 v99, v103
    v_sin_f32_e64 v100, -v100
    v_sin_f32_e64 v101, -v101
    v_sin_f32_e64 v102, -v102
    v_sin_f32_e64 v103, -v103
    v_cvt_pk_bf16_f32 v116, v96, v97
    v_cvt_pk_bf16_f32 v117, v98, v99
    v_cvt_pk_bf16_f32 v118, v100, v101
    v_cvt_pk_bf16_f32 v119, v102, v103
    v_accvgpr_write_b32 a44, v116
    v_accvgpr_write_b32 a45, v117
    v_accvgpr_write_b32 a104, v118
    v_accvgpr_write_b32 a105, v119
    v_pk_fma_f32 v[104:105], v[86:87], v[96:97], v[88:89] neg_lo:[0,0,1] neg_hi:[0,0,1]
    v_pk_fma_f32 v[106:107], v[86:87], v[98:99], v[90:91] neg_lo:[0,0,1] neg_hi:[0,0,1]
    v_pk_fma_f32 v[108:109], v[86:87], v[100:101], v[92:93] neg_lo:[0,0,1] neg_hi:[0,0,1]
    v_pk_fma_f32 v[110:111], v[86:87], v[102:103], v[94:95] neg_lo:[0,0,1] neg_hi:[0,0,1]
    v_cvt_pk_bf16_f32 v112, v104, v105
    v_cvt_pk_bf16_f32 v113, v106, v107
    v_cvt_pk_bf16_f32 v114, v108, v109
    v_cvt_pk_bf16_f32 v115, v110, v111
    v_accvgpr_write_b32 a48, v112
    v_accvgpr_write_b32 a49, v113
    v_accvgpr_write_b32 a108, v114
    v_accvgpr_write_b32 a109, v115
    v_pk_fma_f32 v[88:89], v[86:87], v[104:105], v[96:97] neg_lo:[0,0,1] neg_hi:[0,0,1]
    v_pk_fma_f32 v[90:91], v[86:87], v[106:107], v[98:99] neg_lo:[0,0,1] neg_hi:[0,0,1]
    v_pk_fma_f32 v[92:93], v[86:87], v[108:109], v[100:101] neg_lo:[0,0,1] neg_hi:[0,0,1]
    v_pk_fma_f32 v[94:95], v[86:87], v[110:111], v[102:103] neg_lo:[0,0,1] neg_hi:[0,0,1]
    v_cvt_pk_bf16_f32 v116, v88, v89
    v_cvt_pk_bf16_f32 v117, v90, v91
    v_cvt_pk_bf16_f32 v118, v92, v93
    v_cvt_pk_bf16_f32 v119, v94, v95
    v_accvgpr_write_b32 a52, v116
    v_accvgpr_write_b32 a53, v117
    v_accvgpr_write_b32 a112, v118
    v_accvgpr_write_b32 a113, v119
    v_pk_fma_f32 v[96:97], v[86:87], v[88:89], v[104:105] neg_lo:[0,0,1] neg_hi:[0,0,1]
    v_pk_fma_f32 v[98:99], v[86:87], v[90:91], v[106:107] neg_lo:[0,0,1] neg_hi:[0,0,1]
    v_pk_fma_f32 v[100:101], v[86:87], v[92:93], v[108:109] neg_lo:[0,0,1] neg_hi:[0,0,1]
    v_pk_fma_f32 v[102:103], v[86:87], v[94:95], v[110:111] neg_lo:[0,0,1] neg_hi:[0,0,1]
    v_cvt_pk_bf16_f32 v112, v96, v97
    v_cvt_pk_bf16_f32 v113, v98, v99
    v_cvt_pk_bf16_f32 v114, v100, v101
    v_cvt_pk_bf16_f32 v115, v102, v103
    v_accvgpr_write_b32 a56, v112
    v_accvgpr_write_b32 a57, v113
    v_accvgpr_write_b32 a116, v114
    v_accvgpr_write_b32 a117, v115
    v_pk_fma_f32 v[104:105], v[86:87], v[96:97], v[88:89] neg_lo:[0,0,1] neg_hi:[0,0,1]
    v_pk_fma_f32 v[106:107], v[86:87], v[98:99], v[90:91] neg_lo:[0,0,1] neg_hi:[0,0,1]
    v_pk_fma_f32 v[108:109], v[86:87], v[100:101], v[92:93] neg_lo:[0,0,1] neg_hi:[0,0,1]
    v_pk_fma_f32 v[110:111], v[86:87], v[102:103], v[94:95] neg_lo:[0,0,1] neg_hi:[0,0,1]
    v_cvt_pk_bf16_f32 v116, v104, v105
    v_cvt_pk_bf16_f32 v117, v106, v107
    v_cvt_pk_bf16_f32 v118, v108, v109
    v_cvt_pk_bf16_f32 v119, v110, v111
    v_accvgpr_write_b32 a42, v116
    v_accvgpr_write_b32 a43, v117
    v_accvgpr_write_b32 a102, v118
    v_accvgpr_write_b32 a103, v119
    v_pk_fma_f32 v[88:89], v[86:87], v[104:105], v[96:97] neg_lo:[0,0,1] neg_hi:[0,0,1]
    v_pk_fma_f32 v[90:91], v[86:87], v[106:107], v[98:99] neg_lo:[0,0,1] neg_hi:[0,0,1]
    v_pk_fma_f32 v[92:93], v[86:87], v[108:109], v[100:101] neg_lo:[0,0,1] neg_hi:[0,0,1]
    v_pk_fma_f32 v[94:95], v[86:87], v[110:111], v[102:103] neg_lo:[0,0,1] neg_hi:[0,0,1]
    v_cvt_pk_bf16_f32 v112, v88, v89
    v_cvt_pk_bf16_f32 v113, v90, v91
    v_cvt_pk_bf16_f32 v114, v92, v93
    v_cvt_pk_bf16_f32 v115, v94, v95
    v_accvgpr_write_b32 a46, v112
    v_accvgpr_write_b32 a47, v113
    v_accvgpr_write_b32 a106, v114
    v_accvgpr_write_b32 a107, v115
    v_pk_fma_f32 v[96:97], v[86:87], v[88:89], v[104:105] neg_lo:[0,0,1] neg_hi:[0,0,1]
    v_pk_fma_f32 v[98:99], v[86:87], v[90:91], v[106:107] neg_lo:[0,0,1] neg_hi:[0,0,1]
    v_pk_fma_f32 v[100:101], v[86:87], v[92:93], v[108:109] neg_lo:[0,0,1] neg_hi:[0,0,1]
    v_pk_fma_f32 v[102:103], v[86:87], v[94:95], v[110:111] neg_lo:[0,0,1] neg_hi:[0,0,1]
    v_cvt_pk_bf16_f32 v116, v96, v97
    v_cvt_pk_bf16_f32 v117, v98, v99
    v_cvt_pk_bf16_f32 v118, v100, v101
    v_cvt_pk_bf16_f32 v119, v102, v103
    v_accvgpr_write_b32 a50, v116
    v_accvgpr_write_b32 a51, v117
    v_accvgpr_write_b32 a110, v118
    v_accvgpr_write_b32 a111, v119
    v_pk_fma_f32 v[104:105], v[86:87], v[96:97], v[88:89] neg_lo:[0,0,1] neg_hi:[0,0,1]
    v_pk_fma_f32 v[106:107], v[86:87], v[98:99], v[90:91] neg_lo:[0,0,1] neg_hi:[0,0,1]
    v_pk_fma_f32 v[108:109], v[86:87], v[100:101], v[92:93] neg_lo:[0,0,1] neg_hi:[0,0,1]
    v_pk_fma_f32 v[110:111], v[86:87], v[102:103], v[94:95] neg_lo:[0,0,1] neg_hi:[0,0,1]
    v_cvt_pk_bf16_f32 v112, v104, v105
    v_cvt_pk_bf16_f32 v113, v106, v107
    v_cvt_pk_bf16_f32 v114, v108, v109
    v_cvt_pk_bf16_f32 v115, v110, v111
    v_accvgpr_write_b32 a54, v112
    v_accvgpr_write_b32 a55, v113
    v_accvgpr_write_b32 a114, v114
    v_accvgpr_write_b32 a115, v115
    v_pk_fma_f32 v[88:89], v[86:87], v[104:105], v[96:97] neg_lo:[0,0,1] neg_hi:[0,0,1]
    v_pk_fma_f32 v[90:91], v[86:87], v[106:107], v[98:99] neg_lo:[0,0,1] neg_hi:[0,0,1]
    v_pk_fma_f32 v[92:93], v[86:87], v[108:109], v[100:101] neg_lo:[0,0,1] neg_hi:[0,0,1]
    v_pk_fma_f32 v[94:95], v[86:87], v[110:111], v[102:103] neg_lo:[0,0,1] neg_hi:[0,0,1]
    v_cvt_pk_bf16_f32 v116, v88, v89
    v_cvt_pk_bf16_f32 v117, v90, v91
    v_cvt_pk_bf16_f32 v118, v92, v93
    v_cvt_pk_bf16_f32 v119, v94, v95
    v_accvgpr_write_b32 a58, v116
    v_accvgpr_write_b32 a59, v117
    v_accvgpr_write_b32 a118, v118
    v_accvgpr_write_b32 a119, v119
    buffer_store_dwordx4 v[60:63], v8, s[28:31], s83 offen sc1
    buffer_load_dword v124, off, s[28:31], s79
    s_mov_b64 exec, 0
    s_cmp_eq_u32 s3, 1
    s_cbranch_scc1 spec_pg1
    s_cmp_eq_u32 s3, 2
    s_cbranch_scc1 spec_pg2
    s_cmp_eq_u32 s3, 3
    s_cbranch_scc1 spec_pg3
    s_branch spec_pg0
spec_ret:
    s_mov_b64 exec, -1
spec_main:
    s_waitcnt vmcnt(11)
    ds_read_b128 a[120:123], v12 offset:0
    ds_read_b128 a[124:127], v13 offset:0
    s_waitcnt vmcnt(10)
    ds_read_b128 a[128:131], v12 offset:1024
    ds_read_b128 a[132:135], v13 offset:1024
    s_mov_b32 s50, 0xaaaaaaaa
    s_mov_b32 s51, 0xaaaaaaaa
    s_mov_b32 s52, 0xcccccccc
    s_mov_b32 s53, 0xcccccccc
    s_waitcnt lgkmcnt(3)
    v_mfma_f32_16x16x32_bf16 v[84:87], a[120:123], a[120:123], 0
    s_waitcnt vmcnt(9)
    ds_read_b128 a[136:139], v12 offset:2048
    v_mfma_f32_16x16x32_bf16 v[88:91], v[36:39], a[120:123], 0
    s_waitcnt lgkmcnt(3)
    v_mfma_f32_16x16x32_bf16 v[84:87], a[124:127], a[124:127], v[84:87]
    ds_read_b128 a[140:143], v13 offset:2048
    v_mfma_f32_16x16x32_bf16 v[88:91], v[36:39], a[124:127], v[88:91]
    s_waitcnt lgkmcnt(3)
    v_mfma_f32_16x16x32_bf16 v[84:87], a[128:131], a[128:131], v[84:87]
    s_waitcnt vmcnt(8)
    ds_read_b128 a[144:147], v12 offset:3072
    v_mfma_f32_16x16x32_bf16 v[88:91], v[36:39], a[128:131], v[88:91]
    s_waitcnt lgkmcnt(3)
    v_mfma_f32_16x16x32_bf16 v[84:87], a[132:135], a[132:135], v[84:87]
    ds_read_b128 a[148:151], v13 offset:3072
    v_mfma_f32_16x16x32_bf16 v[88:91], v[36:39], a[132:135], v[88:91]
    s_waitcnt lgkmcnt(3)
    v_mfma_f32_16x16x32_bf16 v[84:87], a[136:139], a[136:139], v[84:87]
    s_waitcnt vmcnt(7)
    ds_read_b128 a[120:123], v12 offset:4096
    v_mfma_f32_16x16x32_bf16 v[88:91], v[36:39], a[136:139], v[88:91]
    s_waitcnt lgkmcnt(3)
    v_mfma_f32_16x16x32_bf16 v[84:87], a[140:143], a[140:143], v[84:87]
    ds_read_b128 a[124:127], v13 offset:4096
    v_mfma_f32_16x16x32_bf16 v[88:91], v[36:39], a[140:143], v[88:91]
    s_waitcnt lgkmcnt(3)
    v_mfma_f32_16x16x32_bf16 v[84:87], a[144:147], a[144:147], v[84:87]
    s_waitcnt vmcnt(6)
    ds_read_b128 a[128:131], v12 offset:5120
    v_mfma_f32_16x16x32_bf16 v[88:91], v[36:39], a[144:147], v[88:91]
    s_waitcnt lgkmcnt(3)
    v_mfma_f32_16x16x32_bf16 v[84:87], a[148:151], a[148:151], v[84:87]
    ds_read_b128 a[132:135], v13 offset:5120
    v_mfma_f32_16x16x32_bf16 v[88:91], v[36:39], a[148:151], v[88:91]
    s_waitcnt lgkmcnt(3)
    v_mfma_f32_16x16x32_bf16 v[84:87], a[120:123], a[120:123], v[84:87]
    s_waitcnt vmcnt(5)
    ds_read_b128 a[136:139], v12 offset:6144
    v_mfma_f32_16x16x32_bf16 v[88:91], v[36:39], a[120:123], v[88:91]
    s_waitcnt lgkmcnt(3)
    v_mfma_f32_16x16x32_bf16 v[84:87], a[124:127], a[124:127], v[84:87]
    ds_read_b128 a[140:143], v13 offset:6144
    v_mfma_f32_16x16x32_bf16 v[88:91], v[36:39], a[124:127], v[88:91]
    s_waitcnt lgkmcnt(3)
    v_mfma_f32_16x16x32_bf16 v[84:87], a[128:131], a[128:131], v[84:87]
    s_waitcnt vmcnt(4)
    ds_read_b128 a[144:147], v12 offset:7168
    v_mfma_f32_16x16x32_bf16 v[88:91], v[36:39], a[128:131], v[88:91]
    s_waitcnt lgkmcnt(3)
    v_mfma_f32_16x16x32_bf16 v[84:87], a[132:135], a[132:135], v[84:87]
    ds_read_b128 a[148:151], v13 offset:7168
    v_mfma_f32_16x16x32_bf16 v[88:91], v[36:39], a[132:135], v[88:91]
    s_waitcnt lgkmcnt(3)
    v_mfma_f32_16x16x32_bf16 v[84:87], a[136:139], a[136:139], v[84:87]
    s_waitcnt vmcnt(3)
    ds_read_b128 a[120:123], v12 offset:8192
    v_mfma_f32_16x16x32_bf16 v[88:91], v[36:39], a[136:139], v[88:91]
    s_waitcnt lgkmcnt(3)
    v_mfma_f32_16x16x32_bf16 v[84:87], a[140:143], a[140:143], v[84:87]
    ds_read_b128 a[124:127], v13 offset:8192
    v_mfma_f32_16x16x32_bf16 v[88:91], v[36:39], a[140:143], v[88:91]
    s_waitcnt lgkmcnt(3)
    v_mfma_f32_16x16x32_bf16 v[84:87], a[144:147], a[144:147], v[84:87]
    s_waitcnt vmcnt(2)
    ds_read_b128 a[128:131], v12 offset:9216
    v_mfma_f32_16x16x32_bf16 v[88:91], v[36:39], a[144:147], v[88:91]
    s_waitcnt lgkmcnt(3)
    v_mfma_f32_16x16x32_bf16 v[84:87], a[148:151], a[148:151], v[84:87]
    ds_read_b128 a[132:135], v13 offset:9216
    v_mfma_f32_16x16x32_bf16 v[88:91], v[36:39], a[148:151], v[88:91]
    s_waitcnt lgkmcnt(3)
    v_mfma_f32_16x16x32_bf16 v[84:87], a[120:123], a[120:123], v[84:87]
    v_mfma_f32_16x16x32_bf16 v[88:91], v[36:39], a[120:123], v[88:91]
    s_waitcnt lgkmcnt(2)
    v_mfma_f32_16x16x32_bf16 v[84:87], a[124:127], a[124:127], v[84:87]
    v_mfma_f32_16x16x32_bf16 v[88:91], v[36:39], a[124:127], v[88:91]
    s_waitcnt lgkmcnt(1)
    v_mfma_f32_16x16x32_bf16 v[84:87], a[128:131], a[128:131], v[84:87]
    v_mfma_f32_16x16x32_bf16 v[88:91], v[36:39], a[128:131], v[88:91]
    s_waitcnt lgkmcnt(0)
    v_mfma_f32_16x16x32_bf16 v[84:87], a[132:135], a[132:135], v[84:87]
    v_mfma_f32_16x16x32_bf16 v[88:91], v[36:39], a[132:135], v[88:91]
    s_cmp_eq_u32 s57, 0
    s_cselect_b32 s73, 0x00f0000f, 0
    s_cselect_b32 s72, 0, 0xf0000f00
    s_mov_b32 exec_lo, 0x00f0000f
    s_mov_b32 exec_hi, 0xf0000f00
    s_nop 1
    v_cndmask_b32 v2, v84, v85, s[50:51]
    v_cndmask_b32 v4, v86, v87, s[50:51]
    v_cndmask_b32 v4, v2, v4, s[52:53]
    v_mul_f32 v3, 0x3acccccd, v88
    v_mul_f32 v4, 0x3acccccd, v4
    v_fma_f32 v4, -v3, v3, v4
    v_cvt_pk_bf16_f32 v40, -v3, -v3
    v_max_f32 v4, 0, v4
    ds_write_b16 v31, v40
    v_cvt_pk_bf16_f32 v4, 0, v4
    v_add_f32 v4, 0x3727c5ac, v4
    v_cvt_pk_bf16_f32 v4, 0, v4
    v_sqrt_f32 v4, v4
    s_nop 0
    v_cvt_pk_bf16_f32 v4, 0, v4
    v_rcp_f32 v5, v4
    v_mul_f32 v42, v4, v4
    ds_write_b32 v30, v5
    v_mul_f32 v41, 0xbfb8aa3b, v5
    s_mov_b32 exec_lo, s73
    s_mov_b32 exec_hi, s72
    buffer_store_dwordx4 v[40:43], v32, s[28:31], 0 offen sc1
    s_mov_b64 exec, -1
    s_waitcnt lgkmcnt(0)
    s_barrier
    ds_read_b128 v[108:111], v34 offset:0
    ds_read_b128 v[112:115], v34 offset:32
    ds_read_b128 v[116:119], v34 offset:128
    ds_read_b128 v[120:123], v34 offset:160
    ds_read_b64 v[100:101], v35 offset:0
    ds_read_b64 v[102:103], v35 offset:16
    ds_read_b64 v[104:105], v35 offset:64
    ds_read_b64 v[106:107], v35 offset:80
    ds_read_b64_tr_b16 a[120:121], v18 offset:0
    ds_read_b64_tr_b16 a[122:123], v18 offset:10240
    ds_read_b64_tr_b16 a[124:125], v18 offset:40960
    ds_read_b64_tr_b16 a[126:127], v18 offset:51200
    ds_read_b64_tr_b16 a[128:129], v18 offset:5120
    ds_read_b64_tr_b16 a[130:131], v18 offset:15360
    s_waitcnt lgkmcnt(13)
    v_pk_mul_f32 v[224:225], v[224:225], v[108:109]
    v_pk_mul_f32 v[240:241], v[240:241], v[108:109]
    v_pk_mul_f32 v[226:227], v[226:227], v[110:111]
    v_pk_mul_f32 v[242:243], v[242:243], v[110:111]
    s_waitcnt lgkmcnt(12)
    v_pk_mul_f32 v[228:229], v[228:229], v[112:113]
    v_pk_mul_f32 v[244:245], v[244:245], v[112:113]
    v_pk_mul_f32 v[230:231], v[230:231], v[114:115]
    v_pk_mul_f32 v[246:247], v[246:247], v[114:115]
    s_waitcnt lgkmcnt(11)
    v_pk_mul_f32 v[232:233], v[232:233], v[116:117]
    v_pk_mul_f32 v[248:249], v[248:249], v[116:117]
    v_pk_mul_f32 v[234:235], v[234:235], v[118:119]
    v_pk_mul_f32 v[250:251], v[250:251], v[118:119]
    s_waitcnt lgkmcnt(10)
    v_pk_mul_f32 v[236:237], v[236:237], v[120:121]
    v_pk_mul_f32 v[252:253], v[252:253], v[120:121]
    v_pk_mul_f32 v[238:239], v[238:239], v[122:123]
    v_pk_mul_f32 v[254:255], v[254:255], v[122:123]
    v_cvt_pk_bf16_f32 v52, v224, v225
    v_cvt_pk_bf16_f32 v53, v226, v227
    v_cvt_pk_bf16_f32 v54, v228, v229
    v_cvt_pk_bf16_f32 v55, v230, v231
    v_cvt_pk_bf16_f32 v56, v232, v233
    v_cvt_pk_bf16_f32 v57, v234, v235
    v_cvt_pk_bf16_f32 v58, v236, v237
    v_cvt_pk_bf16_f32 v59, v238, v239
    v_cvt_pk_bf16_f32 v60, v240, v241
    v_cvt_pk_bf16_f32 v61, v242, v243
    v_cvt_pk_bf16_f32 v62, v244, v245
    v_cvt_pk_bf16_f32 v63, v246, v247
    v_cvt_pk_bf16_f32 v64, v248, v249
    v_cvt_pk_bf16_f32 v65, v250, v251
    v_cvt_pk_bf16_f32 v66, v252, v253
    v_cvt_pk_bf16_f32 v67, v254, v255
    s_waitcnt lgkmcnt(8)
    v_mfma_f32_16x16x32_bf16 v[84:87], v[100:103], v[52:55], 0
    ds_read_b64_tr_b16 a[132:133], v18 offset:46080
    v_xor_b32 v68, s58, v52
    v_xor_b32 v69, s58, v53
    v_xor_b32 v70, s58, v54
    v_xor_b32 v71, s58, v55
    v_mfma_f32_16x16x32_bf16 v[88:91], v[100:103], v[60:63], 0
    ds_read_b64_tr_b16 a[134:135], v18 offset:56320
    v_xor_b32 v76, s58, v60
    v_xor_b32 v77, s58, v61
    v_xor_b32 v78, s58, v62
    v_xor_b32 v79, s58, v63
    v_xor_b32 v72, s58, v56
    s_waitcnt lgkmcnt(8)
    v_mfma_f32_16x16x32_bf16 v[84:87], v[104:107], v[56:59], v[84:87]
    ds_read_b64_tr_b16 a[136:137], v19 offset:5120
    v_xor_b32 v73, s58, v57
    v_xor_b32 v74, s58, v58
    v_xor_b32 v75, s58, v59
    v_xor_b32 v80, s58, v64
    v_mfma_f32_16x16x32_bf16 v[88:91], v[104:107], v[64:67], v[88:91]
    ds_read_b64_tr_b16 a[138:139], v19 offset:15360
    v_xor_b32 v81, s58, v65
    v_xor_b32 v82, s58, v66
    v_xor_b32 v83, s58, v67
    v_mfma_f32_16x16x32_bf16 v[84:87], v[100:103], v[68:71], v[84:87]
    ds_read_b64_tr_b16 a[140:141], v19 offset:46080
    v_mfma_f32_16x16x32_bf16 v[88:91], v[100:103], v[76:79], v[88:91]
    ds_read_b64_tr_b16 a[142:143], v19 offset:56320
    v_mfma_f32_16x16x32_bf16 v[84:87], v[104:107], v[72:75], v[84:87]
    v_mfma_f32_16x16x32_bf16 v[88:91], v[104:107], v[80:83], v[88:91]
    s_add_u32 s60, s76, 327680
    s_waitcnt lgkmcnt(8)
    v_mfma_f32_16x16x32_bf16 v[108:111], a[120:123], v[52:55], v[84:87]
    ds_read_b64_tr_b16 a[144:145], v19 offset:0
    v_mfma_f32_16x16x32_bf16 v[112:115], a[120:123], v[60:63], v[88:91]
    ds_read_b64_tr_b16 a[146:147], v19 offset:10240
    v_mfma_f32_16x16x32_bf16 v[108:111], a[124:127], v[56:59], v[108:111]
    ds_read_b64_tr_b16 a[148:149], v19 offset:40960
    v_mfma_f32_16x16x32_bf16 v[112:115], a[124:127], v[64:67], v[112:115]
    ds_read_b64_tr_b16 a[150:151], v19 offset:51200
    s_waitcnt lgkmcnt(8)
    v_mfma_f32_16x16x32_bf16 v[108:111], a[128:131], v[68:71], v[108:111]
    ds_read_b64_tr_b16 a[120:121], v20 offset:0
    v_mfma_f32_16x16x32_bf16 v[112:115], a[128:131], v[76:79], v[112:115]
    ds_read_b64_tr_b16 a[122:123], v20 offset:10240
    v_mfma_f32_16x16x32_bf16 v[108:111], a[132:135], v[72:75], v[108:111]
    ds_read_b64_tr_b16 a[124:125], v20 offset:40960
    v_mfma_f32_16x16x32_bf16 v[112:115], a[132:135], v[80:83], v[112:115]
    ds_read_b64_tr_b16 a[126:127], v20 offset:51200
    s_waitcnt lgkmcnt(8)
    v_mfma_f32_16x16x32_bf16 v[116:119], a[136:139], v[52:55], v[84:87]
    ds_read_b64_tr_b16 a[128:129], v20 offset:5120
    v_mfma_f32_16x16x32_bf16 v[120:123], a[136:139], v[60:63], v[88:91]
    ds_read_b64_tr_b16 a[130:131], v20 offset:15360
    v_mfma_f32_16x16x32_bf16 v[116:119], a[140:143], v[56:59], v[116:119]
    ds_read_b64_tr_b16 a[132:133], v20 offset:46080
    v_mfma_f32_16x16x32_bf16 v[120:123], a[140:143], v[64:67], v[120:123]
    ds_read_b64_tr_b16 a[134:135], v20 offset:56320
    s_waitcnt lgkmcnt(8)
    v_mfma_f32_16x16x32_bf16 v[116:119], a[144:147], v[68:71], v[116:119]
    ds_read_b64_tr_b16 a[136:137], v21 offset:5120
    v_mfma_f32_16x16x32_bf16 v[120:123], a[144:147], v[76:79], v[120:123]
    ds_read_b64_tr_b16 a[138:139], v21 offset:15360
    v_mfma_f32_16x16x32_bf16 v[116:119], a[148:151], v[72:75], v[116:119]
    ds_read_b64_tr_b16 a[140:141], v21 offset:46080
    v_mfma_f32_16x16x32_bf16 v[120:123], a[148:151], v[80:83], v[120:123]
    ds_read_b64_tr_b16 a[142:143], v21 offset:56320
    s_waitcnt lgkmcnt(8)
    v_mfma_f32_16x16x32_bf16 v[224:227], a[120:123], v[52:55], v[84:87]
    ds_read_b64_tr_b16 a[144:145], v21 offset:0
    v_mfma_f32_16x16x32_bf16 v[228:231], a[120:123], v[60:63], v[88:91]
    ds_read_b64_tr_b16 a[146:147], v21 offset:10240
    v_mfma_f32_16x16x32_bf16 v[224:227], a[124:127], v[56:59], v[224:227]
    ds_read_b64_tr_b16 a[148:149], v21 offset:40960
    v_add_f32 v240, v108, v119
    v_add_f32 v241, v109, v118
    v_mfma_f32_16x16x32_bf16 v[228:231], a[124:127], v[64:67], v[228:231]
    ds_read_b64_tr_b16 a[150:151], v21 offset:51200
    v_add_f32 v242, v110, v117
    v_add_f32 v243, v111, v116
    s_waitcnt lgkmcnt(8)
    v_mfma_f32_16x16x32_bf16 v[224:227], a[128:131], v[68:71], v[224:227]
    ds_read_b64_tr_b16 a[120:121], v22 offset:0
    v_sub_f32 v244, v108, v119
    v_sub_f32 v245, v109, v118
    v_mfma_f32_16x16x32_bf16 v[228:231], a[128:131], v[76:79], v[228:231]
    ds_read_b64_tr_b16 a[122:123], v22 offset:10240
    v_sub_f32 v246, v110, v117
    v_sub_f32 v247, v111, v116
    v_mfma_f32_16x16x32_bf16 v[224:227], a[132:135], v[72:75], v[224:227]
    ds_read_b64_tr_b16 a[124:125], v22 offset:40960
    v_cvt_pk_bf16_f32 v240, v240, v241
    v_cvt_pk_bf16_f32 v241, v242, v243
    v_mfma_f32_16x16x32_bf16 v[228:231], a[132:135], v[80:83], v[228:231]
    ds_read_b64_tr_b16 a[126:127], v22 offset:51200
    v_cvt_pk_bf16_f32 v242, v244, v245
    v_cvt_pk_bf16_f32 v243, v246, v247
    s_waitcnt lgkmcnt(8)
    v_mfma_f32_16x16x32_bf16 v[232:235], a[136:139], v[52:55], v[84:87]
    ds_read_b64_tr_b16 a[128:129], v22 offset:5120
    ds_write_b64 v28, v[240:241] offset:0
    v_mfma_f32_16x16x32_bf16 v[236:239], a[136:139], v[60:63], v[88:91]
    ds_read_b64_tr_b16 a[130:131], v22 offset:15360
    ds_write_b64 v28, v[242:243] offset:64
    v_mfma_f32_16x16x32_bf16 v[232:235], a[140:143], v[56:59], v[232:235]
    ds_read_b64_tr_b16 a[132:133], v22 offset:46080
    v_add_f32 v248, v112, v123
    v_add_f32 v249, v113, v122
    v_mfma_f32_16x16x32_bf16 v[236:239], a[140:143], v[64:67], v[236:239]
    ds_read_b64_tr_b16 a[134:135], v22 offset:56320
    v_add_f32 v250, v114, v121
    v_add_f32 v251, v115, v120
    s_waitcnt lgkmcnt(10)
    v_mfma_f32_16x16x32_bf16 v[232:235], a[144:147], v[68:71], v[232:235]
    ds_read_b64_tr_b16 a[136:137], v23 offset:5120
    v_sub_f32 v252, v112, v123
    v_sub_f32 v253, v113, v122
    v_mfma_f32_16x16x32_bf16 v[236:239], a[144:147], v[76:79], v[236:239]
    ds_read_b64_tr_b16 a[138:139], v23 offset:15360
    v_sub_f32 v254, v114, v121
    v_sub_f32 v255, v115, v120
    v_mfma_f32_16x16x32_bf16 v[232:235], a[148:151], v[72:75], v[232:235]
    ds_read_b64_tr_b16 a[140:141], v23 offset:46080
    v_cvt_pk_bf16_f32 v248, v248, v249
    v_cvt_pk_bf16_f32 v249, v250, v251
    v_mfma_f32_16x16x32_bf16 v[236:239], a[148:151], v[80:83], v[236:239]
    ds_read_b64_tr_b16 a[142:143], v23 offset:56320
    v_cvt_pk_bf16_f32 v250, v252, v253
    v_cvt_pk_bf16_f32 v251, v254, v255
    ds_write_b64 v28, v[248:249] offset:10496
    ds_write_b64 v28, v[250:251] offset:10560
    s_waitcnt lgkmcnt(12)
    v_mfma_f32_16x16x32_bf16 v[108:111], a[120:123], v[52:55], v[84:87]
    ds_read_b64_tr_b16 a[144:145], v23 offset:0
    v_mfma_f32_16x16x32_bf16 v[112:115], a[120:123], v[60:63], v[88:91]
    ds_read_b64_tr_b16 a[146:147], v23 offset:10240
    v_mfma_f32_16x16x32_bf16 v[108:111], a[124:127], v[56:59], v[108:111]
    ds_read_b64_tr_b16 a[148:149], v23 offset:40960
    v_add_f32 v240, v224, v235
    v_add_f32 v241, v225, v234
    v_mfma_f32_16x16x32_bf16 v[112:115], a[124:127], v[64:67], v[112:115]
    ds_read_b64_tr_b16 a[150:151], v23 offset:51200
    v_add_f32 v242, v226, v233
    v_add_f32 v243, v227, v232
    s_waitcnt lgkmcnt(10)
    v_mfma_f32_16x16x32_bf16 v[108:111], a[128:131], v[68:71], v[108:111]
    ds_read_b64_tr_b16 a[120:121], v24 offset:0
    v_sub_f32 v244, v224, v235
    v_sub_f32 v245, v225, v234
    v_mfma_f32_16x16x32_bf16 v[112:115], a[128:131], v[76:79], v[112:115]
    ds_read_b64_tr_b16 a[122:123], v24 offset:10240
    v_sub_f32 v246, v226, v233
    v_sub_f32 v247, v227, v232
    v_mfma_f32_16x16x32_bf16 v[108:111], a[132:135], v[72:75], v[108:111]
    ds_read_b64_tr_b16 a[124:125], v24 offset:40960
    v_cvt_pk_bf16_f32 v240, v240, v241
    v_cvt_pk_bf16_f32 v241, v242, v243
    v_mfma_f32_16x16x32_bf16 v[112:115], a[132:135], v[80:83], v[112:115]
    ds_read_b64_tr_b16 a[126:127], v24 offset:51200
    v_cvt_pk_bf16_f32 v242, v244, v245
    v_cvt_pk_bf16_f32 v243, v246, v247
    s_waitcnt lgkmcnt(10)
    v_mfma_f32_16x16x32_bf16 v[116:119], a[136:139], v[52:55], v[84:87]
    ds_read_b64_tr_b16 a[128:129], v24 offset:5120
    ds_write_b64 v28, v[240:241] offset:128
    v_mfma_f32_16x16x32_bf16 v[120:123], a[136:139], v[60:63], v[88:91]
    ds_read_b64_tr_b16 a[130:131], v24 offset:15360
    ds_write_b64 v28, v[242:243] offset:192
    v_mfma_f32_16x16x32_bf16 v[116:119], a[140:143], v[56:59], v[116:119]
    ds_read_b64_tr_b16 a[132:133], v24 offset:46080
    v_add_f32 v248, v228, v239
    v_add_f32 v249, v229, v238
    v_mfma_f32_16x16x32_bf16 v[120:123], a[140:143], v[64:67], v[120:123]
    ds_read_b64_tr_b16 a[134:135], v24 offset:56320
    v_add_f32 v250, v230, v237
    v_add_f32 v251, v231, v236
    s_waitcnt lgkmcnt(10)
    v_mfma_f32_16x16x32_bf16 v[116:119], a[144:147], v[68:71], v[116:119]
    ds_read_b64_tr_b16 a[136:137], v25 offset:5120
    v_sub_f32 v252, v228, v239
    v_sub_f32 v253, v229, v238
    v_mfma_f32_16x16x32_bf16 v[120:123], a[144:147], v[76:79], v[120:123]
    ds_read_b64_tr_b16 a[138:139], v25 offset:15360
    v_sub_f32 v254, v230, v237
    v_sub_f32 v255, v231, v236
    v_mfma_f32_16x16x32_bf16 v[116:119], a[148:151], v[72:75], v[116:119]
    ds_read_b64_tr_b16 a[140:141], v25 offset:46080
spec_pg0:
    s_cbranch_execz spec_ret
    v_cvt_pk_bf16_f32 v248, v248, v249
    v_cvt_pk_bf16_f32 v249, v250, v251
    v_mfma_f32_16x16x32_bf16 v[120:123], a[148:151], v[80:83], v[120:123]
    ds_read_b64_tr_b16 a[142:143], v25 offset:56320
    v_cvt_pk_bf16_f32 v250, v252, v253
    v_cvt_pk_bf16_f32 v251, v254, v255
    ds_write_b64 v28, v[248:249] offset:10624
    ds_write_b64 v28, v[250:251] offset:10688
    s_waitcnt lgkmcnt(12)
    v_mfma_f32_16x16x32_bf16 v[224:227], a[120:123], v[52:55], v[84:87]
    ds_read_b64_tr_b16 a[144:145], v25 offset:0
    v_mfma_f32_16x16x32_bf16 v[228:231], a[120:123], v[60:63], v[88:91]
    ds_read_b64_tr_b16 a[146:147], v25 offset:10240
    v_mfma_f32_16x16x32_bf16 v[224:227], a[124:127], v[56:59], v[224:227]
    s_waitcnt lgkmcnt(2)
    s_barrier
    ds_read_b64_tr_b16 a[148:149], v25 offset:40960
    v_mfma_f32_16x16x32_bf16 v[228:231], a[124:127], v[64:67], v[228:231]
    ds_read_b64_tr_b16 a[150:151], v25 offset:51200
    ds_read_b128 v[92:95], v14 offset:0
    v_mfma_f32_16x16x32_bf16 v[224:227], a[128:131], v[68:71], v[224:227]
    ds_read_b64_tr_b16 a[120:121], v26 offset:0
    v_add_f32 v240, v108, v119
    v_add_f32 v241, v109, v118
    v_mfma_f32_16x16x32_bf16 v[228:231], a[128:131], v[76:79], v[228:231]
    ds_read_b64_tr_b16 a[122:123], v26 offset:10240
    ds_read_b128 v[96:99], v14 offset:5248
    v_mfma_f32_16x16x32_bf16 v[224:227], a[132:135], v[72:75], v[224:227]
    ds_read_b64_tr_b16 a[124:125], v26 offset:40960
    v_add_f32 v242, v110, v117
    v_add_f32 v243, v111, v116
    v_mfma_f32_16x16x32_bf16 v[228:231], a[132:135], v[80:83], v[228:231]
    ds_read_b64_tr_b16 a[126:127], v26 offset:51200
    ds_read_b128 v[100:103], v14 offset:128
    v_mfma_f32_16x16x32_bf16 v[232:235], a[136:139], v[52:55], v[84:87]
    ds_read_b64_tr_b16 a[128:129], v26 offset:5120
    v_sub_f32 v244, v108, v119
    v_sub_f32 v245, v109, v118
    v_mfma_f32_16x16x32_bf16 v[236:239], a[136:139], v[60:63], v[88:91]
    ds_read_b64_tr_b16 a[130:131], v26 offset:15360
    ds_read_b128 v[104:107], v14 offset:5376
    v_mfma_f32_16x16x32_bf16 v[232:235], a[140:143], v[56:59], v[232:235]
    ds_read_b64_tr_b16 a[132:133], v26 offset:46080
    v_sub_f32 v246, v110, v117
    v_sub_f32 v247, v111, v116
    v_mfma_f32_16x16x32_bf16 v[236:239], a[140:143], v[64:67], v[236:239]
    ds_read_b64_tr_b16 a[134:135], v26 offset:56320
    s_waitcnt lgkmcnt(11)
    buffer_store_dwordx4 v[92:95], v29, s[28:31], s76 offen offset:0 sc1
    v_mfma_f32_16x16x32_bf16 v[232:235], a[144:147], v[68:71], v[232:235]
    ds_read_b64_tr_b16 a[136:137], v27 offset:5120
    v_cvt_pk_bf16_f32 v240, v240, v241
    v_cvt_pk_bf16_f32 v241, v242, v243
    v_mfma_f32_16x16x32_bf16 v[236:239], a[144:147], v[76:79], v[236:239]
    ds_read_b64_tr_b16 a[138:139], v27 offset:15360
    s_waitcnt lgkmcnt(10)
    buffer_store_dwordx4 v[96:99], v29, s[28:31], s60 offen offset:0 sc1
    v_mfma_f32_16x16x32_bf16 v[232:235], a[148:151], v[72:75], v[232:235]
    ds_read_b64_tr_b16 a[140:141], v27 offset:46080
    v_cvt_pk_bf16_f32 v242, v244, v245
    v_cvt_pk_bf16_f32 v243, v246, v247
    v_mfma_f32_16x16x32_bf16 v[236:239], a[148:151], v[80:83], v[236:239]
    ds_read_b64_tr_b16 a[142:143], v27 offset:56320
    s_waitcnt lgkmcnt(9)
    buffer_store_dwordx4 v[100:103], v29, s[28:31], s76 offen offset:128 sc1
    ds_write_b64 v28, v[240:241] offset:256
    ds_write_b64 v28, v[242:243] offset:320
    v_add_f32 v248, v112, v123
    v_add_f32 v249, v113, v122
    v_add_f32 v250, v114, v121
    v_add_f32 v251, v115, v120
    v_sub_f32 v252, v112, v123
    v_sub_f32 v253, v113, v122
    v_sub_f32 v254, v114, v121
    v_sub_f32 v255, v115, v120
    v_cvt_pk_bf16_f32 v248, v248, v249
    v_cvt_pk_bf16_f32 v249, v250, v251
    v_cvt_pk_bf16_f32 v250, v252, v253
    v_cvt_pk_bf16_f32 v251, v254, v255
    ds_write_b64 v28, v[248:249] offset:10752
    ds_write_b64 v28, v[250:251] offset:10816
    v_mfma_f32_16x16x32_bf16 v[108:111], a[120:123], v[52:55], v[84:87]
    ds_read_b64_tr_b16 a[144:145], v27 offset:0
    v_mfma_f32_16x16x32_bf16 v[112:115], a[120:123], v[60:63], v[88:91]
    ds_read_b64_tr_b16 a[146:147], v27 offset:10240
    s_waitcnt lgkmcnt(12)
    buffer_store_dwordx4 v[104:107], v29, s[28:31], s60 offen offset:128 sc1
    v_mfma_f32_16x16x32_bf16 v[108:111], a[124:127], v[56:59], v[108:111]
    s_waitcnt lgkmcnt(2)
    s_barrier
    ds_read_b64_tr_b16 a[148:149], v27 offset:40960
    v_mfma_f32_16x16x32_bf16 v[112:115], a[124:127], v[64:67], v[112:115]
    ds_read_b64_tr_b16 a[150:151], v27 offset:51200
    ds_read_b128 v[92:95], v14 offset:256
    v_mfma_f32_16x16x32_bf16 v[108:111], a[128:131], v[68:71], v[108:111]
    v_add_f32 v240, v224, v235
    v_add_f32 v241, v225, v234
    v_add_f32 v242, v226, v233
    v_mfma_f32_16x16x32_bf16 v[112:115], a[128:131], v[76:79], v[112:115]
    ds_read_b128 v[96:99], v14 offset:5504
    v_add_f32 v243, v227, v232
    v_sub_f32 v244, v224, v235
    v_mfma_f32_16x16x32_bf16 v[108:111], a[132:135], v[72:75], v[108:111]
    v_sub_f32 v245, v225, v234
    v_sub_f32 v246, v226, v233
    v_sub_f32 v247, v227, v232
    v_mfma_f32_16x16x32_bf16 v[112:115], a[132:135], v[80:83], v[112:115]
    s_waitcnt lgkmcnt(1)
    buffer_store_dwordx4 v[92:95], v29, s[28:31], s76 offen offset:256 sc1
    v_mfma_f32_16x16x32_bf16 v[116:119], a[136:139], v[52:55], v[84:87]
    v_cvt_pk_bf16_f32 v240, v240, v241
    v_cvt_pk_bf16_f32 v241, v242, v243
    v_cvt_pk_bf16_f32 v242, v244, v245
    v_mfma_f32_16x16x32_bf16 v[120:123], a[136:139], v[60:63], v[88:91]
    s_waitcnt lgkmcnt(0)
    buffer_store_dwordx4 v[96:99], v29, s[28:31], s60 offen offset:256 sc1
    v_mfma_f32_16x16x32_bf16 v[116:119], a[140:143], v[56:59], v[116:119]
    v_cvt_pk_bf16_f32 v243, v246, v247
    ds_write_b64 v28, v[240:241] offset:384
    v_mfma_f32_16x16x32_bf16 v[120:123], a[140:143], v[64:67], v[120:123]
    ds_write_b64 v28, v[242:243] offset:448
    v_add_f32 v248, v228, v239
    v_mfma_f32_16x16x32_bf16 v[116:119], a[144:147], v[68:71], v[116:119]
    v_add_f32 v249, v229, v238
    v_add_f32 v250, v230, v237
    v_add_f32 v251, v231, v236
    v_mfma_f32_16x16x32_bf16 v[120:123], a[144:147], v[76:79], v[120:123]
    v_sub_f32 v252, v228, v239
    v_sub_f32 v253, v229, v238
    v_sub_f32 v254, v230, v237
    v_mfma_f32_16x16x32_bf16 v[116:119], a[148:151], v[72:75], v[116:119]
    v_sub_f32 v255, v231, v236
    v_cvt_pk_bf16_f32 v248, v248, v249
    v_cvt_pk_bf16_f32 v249, v250, v251
    v_mfma_f32_16x16x32_bf16 v[120:123], a[148:151], v[80:83], v[120:123]
    v_cvt_pk_bf16_f32 v250, v252, v253
    v_cvt_pk_bf16_f32 v251, v254, v255
    ds_write_b64 v28, v[248:249] offset:10880
    ds_write_b64 v28, v[250:251] offset:10944
    v_add_f32 v240, v108, v119
    v_add_f32 v241, v109, v118
    v_add_f32 v242, v110, v117
    v_add_f32 v243, v111, v116
    v_sub_f32 v244, v108, v119
    v_sub_f32 v245, v109, v118
    v_sub_f32 v246, v110, v117
    v_sub_f32 v247, v111, v116
    v_cvt_pk_bf16_f32 v240, v240, v241
    v_cvt_pk_bf16_f32 v241, v242, v243
    v_cvt_pk_bf16_f32 v242, v244, v245
    v_cvt_pk_bf16_f32 v243, v246, v247
    ds_write_b64 v28, v[240:241] offset:512
    ds_write_b64 v28, v[242:243] offset:576
    v_add_f32 v248, v112, v123
    v_add_f32 v249, v113, v122
    v_add_f32 v250, v114, v121
    v_add_f32 v251, v115, v120
    v_sub_f32 v252, v112, v123
    v_sub_f32 v253, v113, v122
    v_sub_f32 v254, v114, v121
    v_sub_f32 v255, v115, v120
    v_cvt_pk_bf16_f32 v248, v248, v249
    v_cvt_pk_bf16_f32 v249, v250, v251
    v_cvt_pk_bf16_f32 v250, v252, v253
    v_cvt_pk_bf16_f32 v251, v254, v255
    ds_write_b64 v28, v[248:249] offset:11008
    ds_write_b64 v28, v[250:251] offset:11072
    s_waitcnt lgkmcnt(0)
    s_waitcnt vmcnt(8)
    s_barrier
    ds_read_b128 v[100:103], v14 offset:384
    ds_read_b128 v[104:107], v14 offset:5632
    ds_read_b128 v[92:95], v14 offset:512
    ds_read_b128 v[96:99], v14 offset:5760
    s_waitcnt lgkmcnt(3)
    buffer_store_dwordx4 v[100:103], v29, s[28:31], s76 offen offset:384 sc1
    s_waitcnt lgkmcnt(2)
    buffer_store_dwordx4 v[104:107], v29, s[28:31], s60 offen offset:384 sc1
    s_waitcnt lgkmcnt(1)
    buffer_store_dwordx4 v[92:95], v29, s[28:31], s76 offen offset:512 sc1
    s_waitcnt lgkmcnt(0)
    buffer_store_dwordx4 v[96:99], v29, s[28:31], s60 offen offset:512 sc1
    s_barrier
    s_mul_i32 s73, s3, 24576
    s_mul_i32 s72, s3, 10240
    v_lshlrev_b32 v255, 2, v7
    v_lshlrev_b32 v122, 9, v0
    s_mul_i32 s50, s57, 12288
    s_sub_u32 s60, s73, s50
    s_add_u32 s73, s73, s50
    s_cmp_eq_u32 s57, 0
    s_cselect_b64 vcc, -1, 0
    s_mov_b64 s[50:51], s[64:65]
    s_cselect_b64 s[64:65], s[64:65], s[66:67]
    s_cselect_b64 s[66:67], s[66:67], s[50:51]
    v_cndmask_b32 v247, v16, v15, vcc
    v_cndmask_b32 v16, v15, v16, vcc
    s_add_u32 m0, s73, 40960
    s_nop 0
    buffer_load_dwordx4 v16, s[32:35], s64 offen offset:0 lds
    v_and_b32 v2, 7, v0
    v_lshlrev_b32 v2, 7, v2
    v_bfe_u32 v3, v0, 3, 1
    v_mul_u32_u24 v3, 5120, v3
    v_bfe_u32 v4, v0, 1, 3
    v_xor_b32 v4, v4, v6
    v_lshlrev_b32 v4, 4, v4
    v_add3_u32 v18, v2, v3, v4
    v_xor_b32 v19, 64, v18
    v_add_u32 v22, 40960, v8
    v_add_u32 v23, 139264, v8
    s_lshl_b32 s50, s3, 10
    s_add_u32 m0, s73, 41856
    s_nop 0
    buffer_load_dwordx4 v16, s[32:35], s64 offen offset:128 lds
    v_add_u32 v20, s50, v22
    s_lshl_b32 s50, s3, 2
    s_add_u32 s50, s50, 4096
    v_add_u32 v21, s50, v22
    v_mul_u32_u24 v2, 656, v7
    v_lshlrev_b32 v3, 3, v6
    s_lshl_b32 s50, s59, 5
    s_add_u32 s51, s50, 81920
    v_add3_u32 v24, v2, v3, s51
    s_sub_u32 s51, 82520, s50
    v_sub_u32 v2, v2, v3
    v_add_u32 v25, s51, v2
    s_add_u32 m0, s73, 42752
    s_nop 0
    buffer_load_dwordx4 v16, s[32:35], s64 offen offset:256 lds
    v_lshrrev_b32 v2, 3, v0
    v_and_b32 v4, 7, v0
    v_mul_u32_u24 v10, 81920, v2
    v_lshl_add_u32 v10, v4, 4, v10
    v_xor_b32 v4, v4, v6
    v_mul_u32_u24 v2, 640, v2
    v_lshl_add_u32 v12, v4, 4, v2
    v_xor_b32 v13, 64, v12
    s_mul_i32 s50, s3, 5248
    v_subrev_u32 v14, s50, v14
    s_mul_i32 s83, s57, 10
    s_add_u32 s83, s83, s59
    s_add_u32 m0, s73, 43648
    s_nop 0
    buffer_load_dwordx4 v16, s[32:35], s64 offen offset:384 lds
    s_mul_i32 s83, s83, 10240
    s_add_u32 s83, s83, 524288
    v_and_b32 v3, 1, v6
    v_lshlrev_b32 v3, 6, v3
    v_lshl_add_u32 v3, v6, 7, v3
    s_lshl_b32 s50, s59, 5
    s_add_u32 s50, s50, s62
    s_lshl_b32 s50, s50, 1
    s_add_u32 s51, s50, s68
    s_add_u32 s51, s51, 0
    v_lshl_add_u32 v2, v7, 2, s51
    v_lshrrev_b32 v4, 7, v2
    s_add_u32 m0, s73, 44544
    s_nop 0
    buffer_load_dwordx4 v16, s[32:35], s64 offen offset:512 lds
    v_and_b32 v2, 127, v2
    v_xor_b32 v2, v2, v3
    v_lshl_add_u32 v248, v4, 10, v2
    v_add_u32 v248, 40960, v248
    s_add_u32 s51, s50, s68
    s_add_u32 s51, s51, 64
    v_lshl_add_u32 v2, v7, 2, s51
    v_lshrrev_b32 v4, 7, v2
    v_and_b32 v2, 127, v2
    v_xor_b32 v2, v2, v3
    v_lshl_add_u32 v249, v4, 10, v2
    v_add_u32 v249, 40960, v249
    s_add_u32 m0, s73, 45440
    s_nop 0
    buffer_load_dwordx4 v16, s[32:35], s64 offen offset:640 lds
    s_add_u32 s51, s50, s68
    s_add_u32 s51, s51, 128
    v_lshl_add_u32 v2, v7, 2, s51
    v_lshrrev_b32 v4, 7, v2
    v_and_b32 v2, 127, v2
    v_xor_b32 v2, v2, v3
    v_lshl_add_u32 v250, v4, 10, v2
    v_add_u32 v250, 40960, v250
    s_add_u32 s51, s50, s69
    s_add_u32 s51, s51, 0
    v_lshl_add_u32 v2, v7, 2, s51
    v_lshrrev_b32 v4, 7, v2
    s_add_u32 m0, s73, 47104
    s_nop 0
    buffer_load_dwordx4 v15, s[32:35], s65 offen offset:0 lds
    v_and_b32 v2, 127, v2
    v_xor_b32 v2, v2, v3
    v_lshl_add_u32 v251, v4, 10, v2
    s_waitcnt vmcnt(7)
    v_mov_b32 v254, s54
    s_mov_b64 exec, 0xff
    buffer_store_dword v254, v122, s[28:31], s80 offen sc1
    s_mov_b64 exec, -1
    v_add_u32 v251, 90112, v251
    s_add_u32 s51, s50, s69
    s_add_u32 s51, s51, 64
    v_lshl_add_u32 v2, v7, 2, s51
    v_lshrrev_b32 v4, 7, v2
    v_and_b32 v2, 127, v2
    v_xor_b32 v2, v2, v3
    v_lshl_add_u32 v252, v4, 10, v2
    v_add_u32 v252, 90112, v252
    s_add_u32 m0, s73, 48000
    s_nop 0
    buffer_load_dwordx4 v15, s[32:35], s65 offen offset:128 lds
    s_add_u32 s51, s50, s69
    s_add_u32 s51, s51, 128
    v_lshl_add_u32 v2, v7, 2, s51
    v_lshrrev_b32 v4, 7, v2
    v_and_b32 v2, 127, v2
    v_xor_b32 v2, v2, v3
    v_lshl_add_u32 v253, v4, 10, v2
    v_add_u32 v253, 90112, v253
    s_sub_u32 s50, s49, 24
    s_lshl_b32 s50, s50, 2
    s_add_u32 s50, s50, s3
    s_mul_i32 s50, s50, 15360
    s_add_u32 m0, s73, 48896
    s_nop 0
    buffer_load_dwordx4 v15, s[32:35], s65 offen offset:256 lds
    s_bfe_u32 s51, s48, 0x10001
    s_xor_b32 s51, s51, 1
    s_mul_i32 s51, s51, 491520
    s_add_u32 s76, s50, s51
    v_min_u32 v122, 59, v0
    v_lshlrev_b32 v122, 7, v122
    v_mov_b64 v[128:129], 0
    v_mov_b64 v[130:131], 0
    v_mov_b64 v[132:133], 0
    v_mov_b64 v[134:135], 0
    v_mov_b64 v[136:137], 0
    v_mov_b64 v[138:139], 0
    s_add_u32 m0, s73, 49792
    s_nop 0
    buffer_load_dwordx4 v15, s[32:35], s65 offen offset:384 lds
    v_mov_b64 v[140:141], 0
    v_mov_b64 v[142:143], 0
    v_mov_b64 v[144:145], 0
    v_mov_b64 v[146:147], 0
    v_mov_b64 v[148:149], 0
    v_mov_b64 v[150:151], 0
    v_mov_b64 v[152:153], 0
    v_mov_b64 v[154:155], 0
    v_mov_b64 v[156:157], 0
    v_mov_b64 v[158:159], 0
    v_mov_b64 v[160:161], 0
    v_mov_b64 v[162:163], 0
    s_add_u32 m0, s73, 50688
    s_nop 0
    buffer_load_dwordx4 v15, s[32:35], s65 offen offset:512 lds
    v_mov_b64 v[164:165], 0
    v_mov_b64 v[166:167], 0
    v_mov_b64 v[168:169], 0
    v_mov_b64 v[170:171], 0
    v_mov_b64 v[172:173], 0
    v_mov_b64 v[174:175], 0
    v_mov_b64 v[176:177], 0
    v_mov_b64 v[178:179], 0
    v_mov_b64 v[180:181], 0
    v_mov_b64 v[182:183], 0
    v_mov_b64 v[184:185], 0
    v_mov_b64 v[186:187], 0
    s_add_u32 m0, s73, 51584
    s_nop 0
    buffer_load_dwordx4 v15, s[32:35], s65 offen offset:640 lds
    v_mov_b64 v[188:189], 0
    v_mov_b64 v[190:191], 0
    v_mov_b64 v[192:193], 0
    v_mov_b64 v[194:195], 0
    v_mov_b64 v[196:197], 0
    v_mov_b64 v[198:199], 0
    v_mov_b64 v[200:201], 0
    v_mov_b64 v[202:203], 0
    v_mov_b64 v[204:205], 0
    v_mov_b64 v[206:207], 0
    v_mov_b64 v[208:209], 0
    v_mov_b64 v[210:211], 0
    v_mov_b64 v[212:213], 0
    v_mov_b64 v[214:215], 0
    v_mov_b64 v[216:217], 0
    v_mov_b64 v[218:219], 0
    v_mov_b64 v[220:221], 0
    v_mov_b64 v[222:223], 0
    s_lshl_b32 s50, s3, 11
    s_add_u32 s50, s50, 139264
    v_add_u32 v99, s50, v8
    s_lshr_b32 s52, s3, 1
    s_and_b32 s51, s3, 1
    s_lshl_b32 s51, s51, 4
    v_add_u32 v2, s51, v7
    v_cvt_f32_u32 v5, s52
    v_mul_f32 v5, 0x3e800000, v5
    s_cmp_eq_u32 s56, 0
    s_cselect_b32 s53, 0, 0x3e800000
    v_mul_u32_u24 v3, s63, v2
    v_add_u32 v3, s56, v3
    v_cmp_eq_u32 vcc, 0, v3
    s_lshl_b32 s50, s52, 10
    v_mov_b32 v4, s50
    v_cndmask_b32 v3, v3, v4, vcc
    v_cndmask_b32 v4, v5, 0, vcc
    v_cvt_f32_u32 v3, v3
    v_mul_f32 v96, 0x3a000000, v3
    v_fma_f32 v97, v96, v9, -v4
    s_cmp_eq_u32 s56, 0
    s_cselect_b32 s50, 0, -1
    v_and_b32 v98, 1, v2
    v_add_u32 v98, -1, v98
    v_not_b32 v3, v98
    v_or_b32 v98, s50, v98
    v_fmamk_f32 v84, v96, 0x0, v97
    v_fmamk_f32 v85, v96, 0x3f800000, v97
    v_fmamk_f32 v86, v96, 0x40000000, v97
    v_fmamk_f32 v87, v96, 0x40400000, v97
    v_fmamk_f32 v88, v96, 0x41800000, v97
    v_fmamk_f32 v89, v96, 0x41880000, v97
    v_fmamk_f32 v90, v96, 0x41900000, v97
    v_fmamk_f32 v91, v96, 0x41980000, v97
    v_cos_f32 v84, v84
    v_cos_f32 v85, v85
    v_cos_f32 v86, v86
    v_cos_f32 v87, v87
    v_cos_f32 v88, v88
    v_cos_f32 v89, v89
    v_cos_f32 v90, v90
    v_cos_f32 v91, v91
    v_cvt_pk_bf16_f32 v92, v84, v85
    v_cvt_pk_bf16_f32 v93, v86, v87
    v_cvt_pk_bf16_f32 v94, v88, v89
    v_cvt_pk_bf16_f32 v95, v90, v91
    v_and_b32 v92, v98, v92
    v_and_b32 v93, v98, v93
    v_and_b32 v94, v98, v94
    v_and_b32 v95, v98, v95
    ds_write_b128 v99, v[92:95] offset:0
    v_or_b32 v98, s50, v3
    v_add_f32 v97, s53, v97
    v_fmamk_f32 v84, v96, 0x0, v97
    v_fmamk_f32 v85, v96, 0x3f800000, v97
    v_fmamk_f32 v86, v96, 0x40000000, v97
    v_fmamk_f32 v87, v96, 0x40400000, v97
    v_fmamk_f32 v88, v96, 0x41800000, v97
    v_fmamk_f32 v89, v96, 0x41880000, v97
    v_fmamk_f32 v90, v96, 0x41900000, v97
    v_fmamk_f32 v91, v96, 0x41980000, v97
    v_cos_f32 v84, v84
    v_cos_f32 v85, v85
    v_cos_f32 v86, v86
    v_cos_f32 v87, v87
    v_cos_f32 v88, v88
    v_cos_f32 v89, v89
    v_cos_f32 v90, v90
    v_cos_f32 v91, v91
    v_cvt_pk_bf16_f32 v92, v84, v85
    v_cvt_pk_bf16_f32 v93, v86, v87
    v_cvt_pk_bf16_f32 v94, v88, v89
    v_cvt_pk_bf16_f32 v95, v90, v91
    v_and_b32 v92, v98, v92
    v_and_b32 v93, v98, v93
    v_and_b32 v94, v98, v94
    v_and_b32 v95, v98, v95
    ds_write_b128 v99, v[92:95] offset:1024
    v_cvt_f32_u32 v2, v2
    v_mul_f32 v3, 0.5, v2
    v_mul_f32 v2, 0x3a000000, v2
    v_cvt_f32_u32 v96, s63
    v_mul_f32 v96, v96, v2
    v_cvt_f32_u32 v97, s56
    v_mul_f32 v97, v97, v2
    v_fmac_f32 v97, v96, v9
    v_mul_f32 v5, 4.0, v5
    v_fmac_f32 v97, s53, v5
    s_lshl_b32 s51, s52, 4
    s_lshl_b32 s84, 0xffff, s51
    s_or_b32 s84, s84, s50
    v_fmamk_f32 v84, v96, 0x0, v97
    v_fmamk_f32 v85, v96, 0x3f800000, v97
    v_fmamk_f32 v86, v96, 0x40000000, v97
    v_fmamk_f32 v87, v96, 0x40400000, v97
    v_fmamk_f32 v88, v96, 0x41800000, v97
    v_fmamk_f32 v89, v96, 0x41880000, v97
    v_fmamk_f32 v90, v96, 0x41900000, v97
    v_fmamk_f32 v91, v96, 0x41980000, v97
    v_cos_f32 v84, v84
    v_cos_f32 v85, v85
    v_cos_f32 v86, v86
    v_cos_f32 v87, v87
    v_cos_f32 v88, v88
    v_cos_f32 v89, v89
    v_cos_f32 v90, v90
    v_cos_f32 v91, v91
    v_cvt_pk_bf16_f32 v92, v84, v85
    v_cvt_pk_bf16_f32 v93, v86, v87
    v_cvt_pk_bf16_f32 v94, v88, v89
    v_cvt_pk_bf16_f32 v95, v90, v91
    v_and_b32 v92, s84, v92
    v_and_b32 v93, s84, v93
    v_and_b32 v94, s84, v94
    v_and_b32 v95, s84, v95
    ds_write_b128 v99, v[92:95] offset:8192
    buffer_load_dword v254, v255, s[28:31], s79 offen sc1
    v_add_f32 v97, 0xbe800000, v97
    v_fmamk_f32 v84, v96, 0x0, v97
    v_fmamk_f32 v85, v96, 0x3f800000, v97
    v_fmamk_f32 v86, v96, 0x40000000, v97
    v_fmamk_f32 v87, v96, 0x40400000, v97
    v_fmamk_f32 v88, v96, 0x41800000, v97
    v_fmamk_f32 v89, v96, 0x41880000, v97
    v_fmamk_f32 v90, v96, 0x41900000, v97
    v_fmamk_f32 v91, v96, 0x41980000, v97
    v_cndmask_b32 v84, v84, v3, s[74:75]
    v_cos_f32 v84, v84
    v_cos_f32 v85, v85
    v_cos_f32 v86, v86
    v_cos_f32 v87, v87
    v_cos_f32 v88, v88
    v_cos_f32 v89, v89
    v_cos_f32 v90, v90
    v_cos_f32 v91, v91
    v_cvt_pk_bf16_f32 v92, v84, v85
    v_cvt_pk_bf16_f32 v93, v86, v87
    v_cvt_pk_bf16_f32 v94, v88, v89
    v_cvt_pk_bf16_f32 v95, v90, v91
    v_and_b32 v92, s84, v92
    v_and_b32 v93, s84, v93
    v_and_b32 v94, s84, v94
    v_and_b32 v95, s84, v95
    ds_write_b128 v99, v[92:95] offset:9216
    s_mov_b64 s[70:71], vcc
    s_waitcnt vmcnt(0)
    v_cmp_ne_u32 vcc, s54, v254
    s_nop 0
    s_cbranch_vccz ok_1
    s_mov_b32 s55, 0
rt_2:
    buffer_load_dword v254, v255, s[28:31], s79 offen sc1
    s_waitcnt vmcnt(0)
    v_cmp_ne_u32 vcc, s54, v254
    s_nop 0
    s_cbranch_vccz ok_1
    s_add_u32 s55, s55, 1
    s_cmp_lt_u32 s55, 262144
    s_cbranch_scc1 rt_2
ok_1:
    s_mov_b64 vcc, s[70:71]
    s_add_u32 m0, s72, 0
    s_nop 0
    buffer_load_dwordx4 v12, s[28:31], s77 offen offset:0 sc1 lds
    s_add_u32 m0, s72, 896
    s_nop 0
    buffer_load_dwordx4 v12, s[28:31], s77 offen offset:128 sc1 lds
    s_add_u32 m0, s72, 1792
    s_nop 0
    buffer_load_dwordx4 v12, s[28:31], s77 offen offset:256 sc1 lds
    s_add_u32 m0, s72, 2688
    s_nop 0
    buffer_load_dwordx4 v12, s[28:31], s77 offen offset:384 sc1 lds
    s_add_u32 m0, s72, 3584
    s_nop 0
    buffer_load_dwordx4 v12, s[28:31], s77 offen offset:512 sc1 lds
    s_add_u32 s77, s77, 5120
    s_add_u32 m0, s72, 5120
    s_nop 0
    buffer_load_dwordx4 v13, s[28:31], s77 offen offset:0 sc1 lds
    s_add_u32 m0, s72, 6016
    s_nop 0
    buffer_load_dwordx4 v13, s[28:31], s77 offen offset:128 sc1 lds
    s_add_u32 m0, s72, 6912
    s_nop 0
    buffer_load_dwordx4 v13, s[28:31], s77 offen offset:256 sc1 lds
    s_add_u32 m0, s72, 7808
    s_nop 0
    buffer_load_dwordx4 v13, s[28:31], s77 offen offset:384 sc1 lds
    s_add_u32 m0, s72, 8704
    s_nop 0
    buffer_load_dwordx4 v13, s[28:31], s77 offen offset:512 sc1 lds
    s_add_u32 m0, s60, 53248
    s_nop 0
    buffer_load_dwordx4 v247, s[32:35], s66 offen offset:0 lds
    s_add_u32 m0, s60, 54144
    s_nop 0
    buffer_load_dwordx4 v247, s[32:35], s66 offen offset:128 lds
    s_add_u32 m0, s60, 55040
    s_nop 0
    buffer_load_dwordx4 v247, s[32:35], s66 offen offset:256 lds
    s_add_u32 m0, s60, 55936
    s_nop 0
    buffer_load_dwordx4 v247, s[32:35], s66 offen offset:384 lds
    s_add_u32 m0, s60, 56832
    s_nop 0
    buffer_load_dwordx4 v247, s[32:35], s66 offen offset:512 lds
    s_add_u32 m0, s60, 57728
    s_nop 0
    buffer_load_dwordx4 v247, s[32:35], s66 offen offset:640 lds
    s_add_u32 m0, s60, 59392
    s_nop 0
    buffer_load_dwordx4 v15, s[32:35], s67 offen offset:0 lds
    s_add_u32 m0, s60, 60288
    s_nop 0
    buffer_load_dwordx4 v15, s[32:35], s67 offen offset:128 lds
    s_add_u32 m0, s60, 61184
    s_nop 0
    buffer_load_dwordx4 v15, s[32:35], s67 offen offset:256 lds
    s_add_u32 m0, s60, 62080
    s_nop 0
    buffer_load_dwordx4 v15, s[32:35], s67 offen offset:384 lds
    s_add_u32 m0, s60, 62976
    s_nop 0
    buffer_load_dwordx4 v15, s[32:35], s67 offen offset:512 lds
    s_add_u32 m0, s60, 63872
    s_nop 0
    buffer_load_dwordx4 v15, s[32:35], s67 offen offset:640 lds
    v_mov_b32 v123, v248
    v_mov_b32 v9, v249
    v_mov_b32 v15, v250
    v_mov_b32 v16, v251
    v_mov_b32 v12, v252
    v_mov_b32 v13, v253
    s_waitcnt lgkmcnt(0)
    s_waitcnt vmcnt(12)
    s_barrier
    ds_read_b128 v[74:77], v18 offset:0
    ds_read_b128 v[78:81], v18 offset:1024
    ds_read_b128 v[82:85], v18 offset:2048
    ds_read_b128 v[86:89], v18 offset:3072
    ds_read_b128 v[90:93], v18 offset:4096
    s_waitcnt lgkmcnt(3)
    v_mfma_f32_16x16x32_bf16 v[224:227], v[74:77], a[0:3], 0
    ds_read_b128 v[94:97], v18 offset:10240
    v_mfma_f32_16x16x32_bf16 v[228:231], v[74:77], a[20:23], 0
    v_mfma_f32_16x16x32_bf16 v[232:235], v[74:77], a[40:43], 0
    v_mfma_f32_16x16x32_bf16 v[224:227], v[78:81], a[4:7], v[224:227]
    ds_read_b128 v[98:101], v18 offset:11264
    v_mfma_f32_16x16x32_bf16 v[228:231], v[78:81], a[24:27], v[228:231]
    v_mfma_f32_16x16x32_bf16 v[232:235], v[78:81], a[44:47], v[232:235]
    s_waitcnt lgkmcnt(3)
    v_mfma_f32_16x16x32_bf16 v[224:227], v[82:85], a[8:11], v[224:227]
    ds_read_b128 v[102:105], v18 offset:12288
    v_mfma_f32_16x16x32_bf16 v[228:231], v[82:85], a[28:31], v[228:231]
    v_mfma_f32_16x16x32_bf16 v[232:235], v[82:85], a[48:51], v[232:235]
    v_mfma_f32_16x16x32_bf16 v[224:227], v[86:89], a[12:15], v[224:227]
    ds_read_b128 v[74:77], v18 offset:13312
    v_mfma_f32_16x16x32_bf16 v[228:231], v[86:89], a[32:35], v[228:231]
    v_mfma_f32_16x16x32_bf16 v[232:235], v[86:89], a[52:55], v[232:235]
    s_waitcnt lgkmcnt(3)
    v_mfma_f32_16x16x32_bf16 v[224:227], v[90:93], a[16:19], v[224:227]
    ds_read_b128 v[78:81], v18 offset:14336
    v_mfma_f32_16x16x32_bf16 v[228:231], v[90:93], a[36:39], v[228:231]
    buffer_load_dwordx4 a[120:123], v8, s[28:31], s83 offen offset:0 sc1
    v_mfma_f32_16x16x32_bf16 v[232:235], v[90:93], a[56:59], v[232:235]
    v_mfma_f32_16x16x32_bf16 v[236:239], v[94:97], a[0:3], 0
    ds_read_b128 v[82:85], v18 offset:20480
    v_mfma_f32_16x16x32_bf16 v[240:243], v[94:97], a[20:23], 0
    v_mfma_f32_16x16x32_bf16 v[244:247], v[94:97], a[40:43], 0
    s_waitcnt lgkmcnt(3)
    v_mfma_f32_16x16x32_bf16 v[236:239], v[98:101], a[4:7], v[236:239]
    ds_read_b128 v[86:89], v18 offset:21504
    v_cvt_pk_bf16_f32 v26, v224, v225
    v_mfma_f32_16x16x32_bf16 v[240:243], v[98:101], a[24:27], v[240:243]
    buffer_load_dwordx4 a[124:127], v8, s[28:31], s83 offen offset:1024 sc1
    v_mfma_f32_16x16x32_bf16 v[244:247], v[98:101], a[44:47], v[244:247]
    v_cvt_pk_bf16_f32 v27, v226, v227
    v_cvt_pk_bf16_f32 v42, v228, v229
    v_mfma_f32_16x16x32_bf16 v[236:239], v[102:105], a[8:11], v[236:239]
    ds_read_b128 v[90:93], v18 offset:22528
    v_cvt_pk_bf16_f32 v43, v230, v231
    v_mfma_f32_16x16x32_bf16 v[240:243], v[102:105], a[28:31], v[240:243]
    v_cvt_pk_bf16_f32 v58, v232, v233
    v_cvt_pk_bf16_f32 v59, v234, v235
    v_mfma_f32_16x16x32_bf16 v[244:247], v[102:105], a[48:51], v[244:247]
    s_waitcnt lgkmcnt(3)
    v_mfma_f32_16x16x32_bf16 v[236:239], v[74:77], a[12:15], v[236:239]
spec_pg1:
    s_cbranch_execz spec_ret
    ds_read_b128 v[94:97], v18 offset:23552
    v_mfma_f32_16x16x32_bf16 v[240:243], v[74:77], a[32:35], v[240:243]
    buffer_load_dwordx4 a[128:131], v8, s[28:31], s83 offen offset:2048 sc1
    v_mfma_f32_16x16x32_bf16 v[244:247], v[74:77], a[52:55], v[244:247]
    v_mfma_f32_16x16x32_bf16 v[236:239], v[78:81], a[16:19], v[236:239]
    ds_read_b128 v[98:101], v18 offset:24576
    v_mfma_f32_16x16x32_bf16 v[240:243], v[78:81], a[36:39], v[240:243]
    s_waitcnt vmcnt(3)
    s_barrier
    v_mfma_f32_16x16x32_bf16 v[244:247], v[78:81], a[56:59], v[244:247]
    ds_read_u16_d16_hi v128, v123 offset:0
    s_waitcnt lgkmcnt(4)
    v_mfma_f32_16x16x32_bf16 v[224:227], v[82:85], a[0:3], 0
    ds_read_b128 v[102:105], v18 offset:30720
    buffer_load_dwordx4 a[132:135], v8, s[28:31], s83 offen offset:3072 sc1
    v_mfma_f32_16x16x32_bf16 v[228:231], v[82:85], a[20:23], 0
    ds_read_u16_d16_hi v129, v123 offset:512
    s_add_u32 s83, s83, 4096
    v_mfma_f32_16x16x32_bf16 v[232:235], v[82:85], a[40:43], 0
    ds_read_u16_d16_hi v130, v123 offset:6144
    v_mfma_f32_16x16x32_bf16 v[224:227], v[86:89], a[4:7], v[224:227]
    ds_read_b128 v[74:77], v18 offset:31744
    v_cvt_pk_bf16_f32 v28, v236, v237
    v_mfma_f32_16x16x32_bf16 v[228:231], v[86:89], a[24:27], v[228:231]
    ds_read_u16_d16_hi v131, v123 offset:6656
    v_cvt_pk_bf16_f32 v29, v238, v239
    v_mfma_f32_16x16x32_bf16 v[232:235], v[86:89], a[44:47], v[232:235]
    ds_read_u16_d16_hi v132, v123 offset:12288
    v_cvt_pk_bf16_f32 v44, v240, v241
    s_waitcnt lgkmcnt(8)
    v_mfma_f32_16x16x32_bf16 v[224:227], v[90:93], a[8:11], v[224:227]
    ds_read_b128 v[78:81], v18 offset:32768
    buffer_load_dwordx4 a[136:139], v8, s[28:31], s83 offen offset:0 sc1
    v_mfma_f32_16x16x32_bf16 v[228:231], v[90:93], a[28:31], v[228:231]
    ds_read_u16_d16_hi v133, v123 offset:12800
    v_cvt_pk_bf16_f32 v45, v242, v243
    v_mfma_f32_16x16x32_bf16 v[232:235], v[90:93], a[48:51], v[232:235]
    ds_read_u16_d16_hi v134, v123 offset:18432
    v_cvt_pk_bf16_f32 v60, v244, v245
    v_mfma_f32_16x16x32_bf16 v[224:227], v[94:97], a[12:15], v[224:227]
    ds_read_b128 v[82:85], v18 offset:33792
    v_cvt_pk_bf16_f32 v61, v246, v247
    v_mfma_f32_16x16x32_bf16 v[228:231], v[94:97], a[32:35], v[228:231]
    ds_read_u16_d16_hi v135, v123 offset:18944
    v_mfma_f32_16x16x32_bf16 v[232:235], v[94:97], a[52:55], v[232:235]
    ds_read_u16_d16_hi v136, v123 offset:24576
    s_waitcnt lgkmcnt(11)
    v_mfma_f32_16x16x32_bf16 v[224:227], v[98:101], a[16:19], v[224:227]
    ds_read_b128 v[86:89], v18 offset:34816
    buffer_load_dwordx4 a[140:143], v8, s[28:31], s83 offen offset:1024 sc1
    v_mfma_f32_16x16x32_bf16 v[228:231], v[98:101], a[36:39], v[228:231]
    ds_read_u16_d16_hi v137, v123 offset:25088
    v_mfma_f32_16x16x32_bf16 v[232:235], v[98:101], a[56:59], v[232:235]
    ds_read_u16_d16_hi v138, v123 offset:30720
    v_mfma_f32_16x16x32_bf16 v[236:239], v[102:105], a[0:3], 0
    ds_read_b128 v[90:93], v19 offset:0
    v_mfma_f32_16x16x32_bf16 v[240:243], v[102:105], a[20:23], 0
    ds_read_u16_d16_hi v139, v123 offset:31232
    v_mfma_f32_16x16x32_bf16 v[244:247], v[102:105], a[40:43], 0
    ds_read_u16_d16_hi v140, v123 offset:36864
    s_waitcnt lgkmcnt(11)
    v_mfma_f32_16x16x32_bf16 v[236:239], v[74:77], a[4:7], v[236:239]
    ds_read_b128 v[94:97], v19 offset:1024
    buffer_load_dwordx4 a[144:147], v8, s[28:31], s83 offen offset:2048 sc1
    v_mfma_f32_16x16x32_bf16 v[240:243], v[74:77], a[24:27], v[240:243]
    ds_read_u16_d16_hi v141, v123 offset:37376
    v_cvt_pk_bf16_f32 v30, v224, v225
    v_mfma_f32_16x16x32_bf16 v[244:247], v[74:77], a[44:47], v[244:247]
    ds_read_u16_d16_hi v142, v123 offset:43008
    v_cvt_pk_bf16_f32 v31, v226, v227
    v_mfma_f32_16x16x32_bf16 v[236:239], v[78:81], a[8:11], v[236:239]
    ds_read_b128 v[98:101], v19 offset:2048
    v_cvt_pk_bf16_f32 v46, v228, v229
    v_mfma_f32_16x16x32_bf16 v[240:243], v[78:81], a[28:31], v[240:243]
    ds_read_u16_d16_hi v143, v123 offset:43520
    v_cvt_pk_bf16_f32 v47, v230, v231
    v_mfma_f32_16x16x32_bf16 v[244:247], v[78:81], a[48:51], v[244:247]
    ds_read_u16_d16_hi v144, v16 offset:0
    v_cvt_pk_bf16_f32 v62, v232, v233
    s_waitcnt lgkmcnt(11)
    v_mfma_f32_16x16x32_bf16 v[236:239], v[82:85], a[12:15], v[236:239]
    ds_read_b128 v[102:105], v19 offset:3072
    buffer_load_dwordx4 a[148:151], v8, s[28:31], s83 offen offset:3072 sc1
    v_mfma_f32_16x16x32_bf16 v[240:243], v[82:85], a[32:35], v[240:243]
    ds_read_u16_d16_hi v145, v16 offset:512
    s_add_u32 s83, s83, 4096
    v_mfma_f32_16x16x32_bf16 v[244:247], v[82:85], a[52:55], v[244:247]
    ds_read_u16_d16_hi v146, v16 offset:6144
    v_cvt_pk_bf16_f32 v63, v234, v235
    v_mfma_f32_16x16x32_bf16 v[236:239], v[86:89], a[16:19], v[236:239]
    ds_read_b128 v[74:77], v19 offset:4096
    v_mfma_f32_16x16x32_bf16 v[240:243], v[86:89], a[36:39], v[240:243]
    ds_read_u16_d16_hi v147, v16 offset:6656
    v_mfma_f32_16x16x32_bf16 v[244:247], v[86:89], a[56:59], v[244:247]
    ds_read_u16_d16_hi v148, v16 offset:12288
    s_waitcnt lgkmcnt(11)
    v_mfma_f32_16x16x32_bf16 v[224:227], v[90:93], a[60:63], 0
    ds_read_b128 v[78:81], v19 offset:10240
    buffer_load_dwordx4 a[152:155], v8, s[28:31], s83 offen offset:0 sc1
    v_mfma_f32_16x16x32_bf16 v[228:231], v[90:93], a[80:83], 0
    ds_read_u16_d16_hi v149, v16 offset:12800
    v_mfma_f32_16x16x32_bf16 v[232:235], v[90:93], a[100:103], 0
    ds_read_u16_d16_hi v150, v16 offset:18432
    v_mfma_f32_16x16x32_bf16 v[224:227], v[94:97], a[64:67], v[224:227]
    ds_read_b128 v[82:85], v19 offset:11264
    v_cvt_pk_bf16_f32 v32, v236, v237
    v_mfma_f32_16x16x32_bf16 v[228:231], v[94:97], a[84:87], v[228:231]
    ds_read_u16_d16_hi v151, v16 offset:18944
    v_cvt_pk_bf16_f32 v33, v238, v239
    v_mfma_f32_16x16x32_bf16 v[232:235], v[94:97], a[104:107], v[232:235]
    ds_read_b128 a[0:3], v23 offset:0
    v_cvt_pk_bf16_f32 v48, v240, v241
    s_waitcnt lgkmcnt(11)
    v_mfma_f32_16x16x32_bf16 v[224:227], v[98:101], a[68:71], v[224:227]
    ds_read_b128 v[86:89], v19 offset:12288
    buffer_load_dwordx4 a[156:159], v8, s[28:31], s83 offen offset:1024 sc1
    v_mfma_f32_16x16x32_bf16 v[228:231], v[98:101], a[88:91], v[228:231]
    ds_read_u16_d16_hi v152, v16 offset:24576
    v_cvt_pk_bf16_f32 v49, v242, v243
    v_mfma_f32_16x16x32_bf16 v[232:235], v[98:101], a[108:111], v[232:235]
    ds_read_b128 a[4:7], v23 offset:1024
    v_cvt_pk_bf16_f32 v64, v244, v245
    v_mfma_f32_16x16x32_bf16 v[224:227], v[102:105], a[72:75], v[224:227]
    ds_read_b128 v[90:93], v19 offset:13312
    v_cvt_pk_bf16_f32 v65, v246, v247
    v_mfma_f32_16x16x32_bf16 v[228:231], v[102:105], a[92:95], v[228:231]
    ds_read_u16_d16_hi v153, v16 offset:25088
    v_mfma_f32_16x16x32_bf16 v[232:235], v[102:105], a[112:115], v[232:235]
    ds_read_b128 a[8:11], v23 offset:2048
    s_waitcnt lgkmcnt(11)
    v_mfma_f32_16x16x32_bf16 v[224:227], v[74:77], a[76:79], v[224:227]
    ds_read_b128 v[94:97], v19 offset:14336
    buffer_load_dwordx4 a[160:163], v8, s[28:31], s83 offen offset:2048 sc1
    v_mfma_f32_16x16x32_bf16 v[228:231], v[74:77], a[96:99], v[228:231]
    ds_read_u16_d16_hi v154, v16 offset:30720
    v_mfma_f32_16x16x32_bf16 v[232:235], v[74:77], a[116:119], v[232:235]
    ds_read_b128 a[12:15], v23 offset:3072
    v_mfma_f32_16x16x32_bf16 v[236:239], v[78:81], a[60:63], 0
    ds_read_b128 v[98:101], v19 offset:20480
    v_mfma_f32_16x16x32_bf16 v[240:243], v[78:81], a[80:83], 0
    ds_read_u16_d16_hi v155, v16 offset:31232
    v_mfma_f32_16x16x32_bf16 v[244:247], v[78:81], a[100:103], 0
    ds_read_b128 a[16:19], v23 offset:4096
    s_waitcnt lgkmcnt(11)
    v_mfma_f32_16x16x32_bf16 v[236:239], v[82:85], a[64:67], v[236:239]
    ds_read_b128 v[102:105], v19 offset:21504
    buffer_load_dwordx4 a[164:167], v8, s[28:31], s83 offen offset:3072 sc1
    v_mfma_f32_16x16x32_bf16 v[240:243], v[82:85], a[84:87], v[240:243]
    ds_read_u16_d16_hi v156, v16 offset:36864
    s_add_u32 s83, s83, 4096
    v_mfma_f32_16x16x32_bf16 v[244:247], v[82:85], a[104:107], v[244:247]
    ds_read_b128 a[20:23], v23 offset:5120
    v_cvt_pk_bf16_f32 v34, v224, v225
    v_mfma_f32_16x16x32_bf16 v[236:239], v[86:89], a[68:71], v[236:239]
    ds_read_b128 v[74:77], v19 offset:22528
    v_cvt_pk_bf16_f32 v35, v226, v227
    v_mfma_f32_16x16x32_bf16 v[240:243], v[86:89], a[88:91], v[240:243]
    ds_read_u16_d16_hi v157, v16 offset:37376
    v_cvt_pk_bf16_f32 v50, v228, v229
    v_mfma_f32_16x16x32_bf16 v[244:247], v[86:89], a[108:111], v[244:247]
    ds_read_b128 a[24:27], v23 offset:6144
    v_cvt_pk_bf16_f32 v51, v230, v231
    s_waitcnt lgkmcnt(11)
    v_mfma_f32_16x16x32_bf16 v[236:239], v[90:93], a[72:75], v[236:239]
    ds_read_b128 v[78:81], v19 offset:23552
    buffer_load_dwordx4 a[168:171], v8, s[28:31], s83 offen offset:0 sc1
    v_mfma_f32_16x16x32_bf16 v[240:243], v[90:93], a[92:95], v[240:243]
    ds_read_u16_d16_hi v158, v16 offset:43008
    v_cvt_pk_bf16_f32 v66, v232, v233
    v_mfma_f32_16x16x32_bf16 v[244:247], v[90:93], a[112:115], v[244:247]
    ds_read_b128 a[28:31], v23 offset:7168
    v_cvt_pk_bf16_f32 v67, v234, v235
    v_mfma_f32_16x16x32_bf16 v[236:239], v[94:97], a[76:79], v[236:239]
    ds_read_b128 v[82:85], v19 offset:24576
    v_mfma_f32_16x16x32_bf16 v[240:243], v[94:97], a[96:99], v[240:243]
    ds_read_u16_d16_hi v159, v16 offset:43520
    v_mfma_f32_16x16x32_bf16 v[244:247], v[94:97], a[116:119], v[244:247]
    ds_read_b128 a[32:35], v23 offset:8192
    s_waitcnt lgkmcnt(11)
    v_mfma_f32_16x16x32_bf16 v[224:227], v[98:101], a[60:63], 0
    ds_read_b128 v[86:89], v19 offset:30720
    buffer_load_dwordx4 a[172:175], v8, s[28:31], s83 offen offset:1024 sc1
    v_mfma_f32_16x16x32_bf16 v[228:231], v[98:101], a[80:83], 0
    ds_read_u16_d16_hi v160, v9 offset:0
    v_mfma_f32_16x16x32_bf16 v[232:235], v[98:101], a[100:103], 0
    ds_read_b128 a[36:39], v23 offset:9216
    v_mfma_f32_16x16x32_bf16 v[224:227], v[102:105], a[64:67], v[224:227]
    ds_read_b128 v[90:93], v19 offset:31744
    v_cvt_pk_bf16_f32 v36, v236, v237
    v_mfma_f32_16x16x32_bf16 v[228:231], v[102:105], a[84:87], v[228:231]
    ds_read_u16_d16_hi v161, v9 offset:512
    v_cvt_pk_bf16_f32 v37, v238, v239
    v_mfma_f32_16x16x32_bf16 v[232:235], v[102:105], a[104:107], v[232:235]
    ds_read_b128 a[40:43], v23 offset:10240
    v_cvt_pk_bf16_f32 v52, v240, v241
    s_waitcnt lgkmcnt(11)
    v_mfma_f32_16x16x32_bf16 v[224:227], v[74:77], a[68:71], v[224:227]
    ds_read_b128 v[94:97], v19 offset:32768
    buffer_load_dwordx4 a[176:179], v8, s[28:31], s83 offen offset:2048 sc1
    v_mfma_f32_16x16x32_bf16 v[228:231], v[74:77], a[88:91], v[228:231]
    ds_read_u16_d16_hi v162, v9 offset:6144
    v_cvt_pk_bf16_f32 v53, v242, v243
    v_mfma_f32_16x16x32_bf16 v[232:235], v[74:77], a[108:111], v[232:235]
    ds_read_b128 a[44:47], v23 offset:11264
    v_cvt_pk_bf16_f32 v68, v244, v245
    v_mfma_f32_16x16x32_bf16 v[224:227], v[78:81], a[72:75], v[224:227]
    ds_read_b128 v[98:101], v19 offset:33792
    v_cvt_pk_bf16_f32 v69, v246, v247
    v_mfma_f32_16x16x32_bf16 v[228:231], v[78:81], a[92:95], v[228:231]
    ds_read_u16_d16_hi v163, v9 offset:6656
    v_mfma_f32_16x16x32_bf16 v[232:235], v[78:81], a[112:115], v[232:235]
    ds_read_b128 a[48:51], v23 offset:12288
    s_waitcnt lgkmcnt(11)
    v_mfma_f32_16x16x32_bf16 v[224:227], v[82:85], a[76:79], v[224:227]
    ds_read_b128 v[102:105], v19 offset:34816
    buffer_load_dwordx4 a[180:183], v8, s[28:31], s83 offen offset:3072 sc1
    v_mfma_f32_16x16x32_bf16 v[228:231], v[82:85], a[96:99], v[228:231]
    ds_read_u16_d16_hi v164, v9 offset:12288
    s_add_u32 s83, s83, 4096
    v_mfma_f32_16x16x32_bf16 v[232:235], v[82:85], a[116:119], v[232:235]
    ds_read_b128 a[52:55], v23 offset:13312
    v_mfma_f32_16x16x32_bf16 v[236:239], v[86:89], a[60:63], 0
    v_mfma_f32_16x16x32_bf16 v[240:243], v[86:89], a[80:83], 0
    ds_read_u16_d16_hi v165, v9 offset:12800
    v_mfma_f32_16x16x32_bf16 v[244:247], v[86:89], a[100:103], 0
    ds_read_b128 a[56:59], v23 offset:14336
    s_waitcnt lgkmcnt(10)
    v_mfma_f32_16x16x32_bf16 v[236:239], v[90:93], a[64:67], v[236:239]
    buffer_load_dwordx4 a[184:187], v8, s[28:31], s83 offen offset:0 sc1
    v_mfma_f32_16x16x32_bf16 v[240:243], v[90:93], a[84:87], v[240:243]
    ds_read_u16_d16_hi v166, v9 offset:18432
    v_cvt_pk_bf16_f32 v38, v224, v225
    v_mfma_f32_16x16x32_bf16 v[244:247], v[90:93], a[104:107], v[244:247]
    ds_read_b128 a[60:63], v23 offset:15360
    v_cvt_pk_bf16_f32 v39, v226, v227
    v_mfma_f32_16x16x32_bf16 v[236:239], v[94:97], a[68:71], v[236:239]
    v_cvt_pk_bf16_f32 v54, v228, v229
    v_cvt_pk_bf16_f32 v55, v230, v231
    v_mfma_f32_16x16x32_bf16 v[240:243], v[94:97], a[88:91], v[240:243]
    ds_read_u16_d16_hi v167, v9 offset:18944
    v_cvt_pk_bf16_f32 v70, v232, v233
    v_mfma_f32_16x16x32_bf16 v[244:247], v[94:97], a[108:111], v[244:247]
    ds_read_u16_d16_hi v168, v9 offset:24576
    v_cvt_pk_bf16_f32 v71, v234, v235
    s_waitcnt lgkmcnt(8)
    v_mfma_f32_16x16x32_bf16 v[236:239], v[98:101], a[72:75], v[236:239]
    buffer_load_dwordx4 a[188:191], v8, s[28:31], s83 offen offset:1024 sc1
    v_mfma_f32_16x16x32_bf16 v[240:243], v[98:101], a[92:95], v[240:243]
    ds_read_u16_d16_hi v169, v9 offset:25088
    v_mfma_f32_16x16x32_bf16 v[244:247], v[98:101], a[112:115], v[244:247]
    ds_read_u16_d16_hi v170, v9 offset:30720
    v_mfma_f32_16x16x32_bf16 v[236:239], v[102:105], a[76:79], v[236:239]
    v_mfma_f32_16x16x32_bf16 v[240:243], v[102:105], a[96:99], v[240:243]
    ds_read_u16_d16_hi v171, v9 offset:31232
    v_mfma_f32_16x16x32_bf16 v[244:247], v[102:105], a[116:119], v[244:247]
    ds_read_u16_d16_hi v172, v9 offset:36864
    v_mfma_f32_16x16x32_bf16 v[74:77], a[0:3], v[26:29], 0
    v_mfma_f32_16x16x32_bf16 v[78:81], a[8:11], v[26:29], 0
    s_nop 1
    v_cvt_pk_bf16_f32 v40, v236, v237
    v_mfma_f32_16x16x32_bf16 v[82:85], a[16:19], v[26:29], 0
    v_cvt_pk_bf16_f32 v41, v238, v239
    v_cvt_pk_bf16_f32 v56, v240, v241
    v_mfma_f32_16x16x32_bf16 v[86:89], a[24:27], v[26:29], 0
    v_cvt_pk_bf16_f32 v57, v242, v243
    v_cvt_pk_bf16_f32 v72, v244, v245
    v_mfma_f32_16x16x32_bf16 v[74:77], a[4:7], v[30:33], v[74:77]
    ds_read_u16_d16_hi v173, v9 offset:37376
    v_cvt_pk_bf16_f32 v73, v246, v247
    v_mfma_f32_16x16x32_bf16 v[78:81], a[12:15], v[30:33], v[78:81]
    ds_read_u16_d16_hi v174, v9 offset:43008
    v_mfma_f32_16x16x32_bf16 v[82:85], a[20:23], v[30:33], v[82:85]
    ds_read_u16_d16_hi v175, v9 offset:43520
    v_mfma_f32_16x16x32_bf16 v[86:89], a[28:31], v[30:33], v[86:89]
    ds_read_u16_d16_hi v176, v12 offset:0
    v_mfma_f32_16x16x32_bf16 v[90:93], a[0:3], v[34:37], 0
    ds_read_u16_d16_hi v177, v12 offset:512
    v_mfma_f32_16x16x32_bf16 v[94:97], a[8:11], v[34:37], 0
    ds_read_u16_d16_hi v178, v12 offset:6144
    v_mfma_f32_16x16x32_bf16 v[98:101], a[16:19], v[34:37], 0
    ds_read_u16_d16_hi v179, v12 offset:6656
    v_mfma_f32_16x16x32_bf16 v[102:105], a[24:27], v[34:37], 0
    ds_read_u16_d16_hi v180, v12 offset:12288
    v_mfma_f32_16x16x32_bf16 v[90:93], a[4:7], v[38:41], v[90:93]
    ds_read_u16_d16_hi v181, v12 offset:12800
    v_mfma_f32_16x16x32_bf16 v[94:97], a[12:15], v[38:41], v[94:97]
    ds_read_u16_d16_hi v182, v12 offset:18432
    v_mfma_f32_16x16x32_bf16 v[98:101], a[20:23], v[38:41], v[98:101]
    ds_read_u16_d16_hi v183, v12 offset:18944
    v_mfma_f32_16x16x32_bf16 v[102:105], a[28:31], v[38:41], v[102:105]
    ds_read_u16_d16_hi v184, v12 offset:24576
    v_mfma_f32_16x16x32_bf16 v[224:227], a[0:3], v[42:45], 0
    ds_read_u16_d16_hi v185, v12 offset:25088
    s_and_b32 s50, s3, 1
    v_mfma_f32_16x16x32_bf16 v[228:231], a[8:11], v[42:45], 0
    ds_read_u16_d16_hi v186, v12 offset:30720
    s_mul_i32 s51, s50, 5120
    v_mfma_f32_16x16x32_bf16 v[232:235], a[16:19], v[42:45], 0
    ds_read_u16_d16_hi v187, v12 offset:31232
    s_sub_u32 s52, 5120, s51
    v_mfma_f32_16x16x32_bf16 v[236:239], a[24:27], v[42:45], 0
    ds_read_u16_d16_hi v188, v12 offset:36864
    v_add_u32 v23, s52, v22
    v_mfma_f32_16x16x32_bf16 v[224:227], a[4:7], v[46:49], v[224:227]
    ds_read_u16_d16_hi v189, v12 offset:37376
    v_add_u32 v22, s51, v22
    v_mfma_f32_16x16x32_bf16 v[228:231], a[12:15], v[46:49], v[228:231]
    ds_read_u16_d16_hi v190, v12 offset:43008
    s_mul_i32 s51, s50, 10496
    v_mfma_f32_16x16x32_bf16 v[232:235], a[20:23], v[46:49], v[232:235]
    ds_read_u16_d16_hi v191, v12 offset:43520
    s_sub_u32 s52, 10496, s51
    v_mfma_f32_16x16x32_bf16 v[236:239], a[28:31], v[46:49], v[236:239]
    ds_read_u16_d16_hi v192, v15 offset:0
    s_mul_i32 s53, s50, 96
    v_mfma_f32_16x16x32_bf16 v[240:243], a[0:3], v[50:53], 0
    ds_read_u16_d16_hi v193, v15 offset:512
    s_sub_u32 s53, 64, s53
    v_mfma_f32_16x16x32_bf16 v[244:247], a[8:11], v[50:53], 0
    ds_read_u16_d16_hi v194, v15 offset:6144
    v_add_u32 v18, s52, v24
    v_mfma_f32_16x16x32_bf16 v[248:251], a[16:19], v[50:53], 0
    ds_read_u16_d16_hi v195, v15 offset:6656
    v_add_u32 v24, s51, v24
    v_mfma_f32_16x16x32_bf16 v[252:255], a[24:27], v[50:53], 0
    ds_read_u16_d16_hi v196, v15 offset:12288
    v_add_u32 v19, s52, v25
    v_mfma_f32_16x16x32_bf16 v[240:243], a[4:7], v[54:57], v[240:243]
    ds_read_u16_d16_hi v197, v15 offset:12800
    v_add_u32 v25, s51, v25
    v_mfma_f32_16x16x32_bf16 v[244:247], a[12:15], v[54:57], v[244:247]
    ds_read_u16_d16_hi v198, v15 offset:18432
    v_add_u32 v7, s53, v24
    v_mfma_f32_16x16x32_bf16 v[248:251], a[20:23], v[54:57], v[248:251]
    ds_read_u16_d16_hi v199, v15 offset:18944
    v_subrev_u32 v6, s53, v25
    v_mfma_f32_16x16x32_bf16 v[252:255], a[28:31], v[54:57], v[252:255]
    ds_read_u16_d16_hi v200, v15 offset:24576
    v_pk_add_f32 v[106:107], v[74:75], v[98:99]
    v_pk_add_f32 v[108:109], v[90:91], v[82:83] neg_lo:[0,1] neg_hi:[0,1]
    v_pk_add_f32 v[110:111], v[74:75], v[98:99] neg_lo:[0,1] neg_hi:[0,1]
    v_pk_add_f32 v[112:113], v[90:91], v[82:83]
    v_pk_mul_f32 v[114:115], v[106:107], v[128:129]
    v_pk_mul_f32 v[116:117], v[106:107], v[136:137]
    v_pk_mul_f32 v[118:119], v[110:111], v[144:145]
    v_pk_mul_f32 v[120:121], v[110:111], v[152:153]
    v_mul_f32 v2, v74, v128
    v_mul_f32 v3, v74, v136
    v_mul_f32 v4, v82, v144
    v_mul_f32 v5, v82, v152
    v_fma_f32 v2, -v90, v136, v2
    v_fma_f32 v3, v90, v128, v3
    v_fma_f32 v4, -v98, v152, v4
    v_fma_f32 v5, v98, v144, v5
    buffer_load_dwordx4 a[192:195], v8, s[28:31], s83 offen offset:2048 sc1
    v_pk_fma_f32 v[114:115], v[108:109], v[136:137], v[114:115] neg_lo:[1,0,0] neg_hi:[1,0,0]
    v_pk_fma_f32 v[116:117], v[108:109], v[128:129], v[116:117]
    v_pk_fma_f32 v[118:119], v[112:113], v[152:153], v[118:119] neg_lo:[1,0,0] neg_hi:[1,0,0]
    v_pk_fma_f32 v[120:121], v[112:113], v[144:145], v[120:121]
    v_pk_add_f32 v[74:75], v[114:115], v[118:119]
    v_pk_add_f32 v[90:91], v[116:117], v[120:121]
    v_pk_add_f32 v[82:83], v[120:121], v[116:117] neg_lo:[0,1] neg_hi:[0,1]
    v_pk_add_f32 v[98:99], v[114:115], v[118:119] neg_lo:[0,1] neg_hi:[0,1]
    v_pk_add_f32 v[106:107], v[76:77], v[100:101]
    v_pk_add_f32 v[108:109], v[92:93], v[84:85] neg_lo:[0,1] neg_hi:[0,1]
    v_pk_add_f32 v[110:111], v[76:77], v[100:101] neg_lo:[0,1] neg_hi:[0,1]
    v_pk_add_f32 v[112:113], v[92:93], v[84:85]
    v_pk_mul_f32 v[114:115], v[106:107], v[130:131]
    v_pk_mul_f32 v[116:117], v[106:107], v[138:139]
    v_pk_mul_f32 v[118:119], v[110:111], v[146:147]
    v_pk_mul_f32 v[120:121], v[110:111], v[154:155]
    buffer_load_dwordx4 a[196:199], v8, s[28:31], s83 offen offset:3072 sc1
    v_pk_fma_f32 v[114:115], v[108:109], v[138:139], v[114:115] neg_lo:[1,0,0] neg_hi:[1,0,0]
    v_pk_fma_f32 v[116:117], v[108:109], v[130:131], v[116:117]
    v_pk_fma_f32 v[118:119], v[112:113], v[154:155], v[118:119] neg_lo:[1,0,0] neg_hi:[1,0,0]
    v_pk_fma_f32 v[120:121], v[112:113], v[146:147], v[120:121]
    v_pk_add_f32 v[76:77], v[114:115], v[118:119]
    v_pk_add_f32 v[92:93], v[116:117], v[120:121]
    v_pk_add_f32 v[84:85], v[120:121], v[116:117] neg_lo:[0,1] neg_hi:[0,1]
    v_pk_add_f32 v[100:101], v[114:115], v[118:119] neg_lo:[0,1] neg_hi:[0,1]
    v_pk_add_f32 v[106:107], v[78:79], v[102:103]
    v_pk_add_f32 v[108:109], v[94:95], v[86:87] neg_lo:[0,1] neg_hi:[0,1]
    v_pk_add_f32 v[110:111], v[78:79], v[102:103] neg_lo:[0,1] neg_hi:[0,1]
    v_pk_add_f32 v[112:113], v[94:95], v[86:87]
    v_pk_mul_f32 v[114:115], v[106:107], v[132:133]
    v_pk_mul_f32 v[116:117], v[106:107], v[140:141]
    v_pk_mul_f32 v[118:119], v[110:111], v[148:149]
    v_pk_mul_f32 v[120:121], v[110:111], v[156:157]
    s_add_u32 s83, s83, 4096
    s_and_b32 s84, s3, 1
    s_mul_i32 s84, s84, 30720
    s_sub_u32 s83, s83, s84
    buffer_load_dwordx4 a[200:203], v8, s[28:31], s83 offen offset:0 sc1
    v_pk_fma_f32 v[114:115], v[108:109], v[140:141], v[114:115] neg_lo:[1,0,0] neg_hi:[1,0,0]
    v_pk_fma_f32 v[116:117], v[108:109], v[132:133], v[116:117]
    v_pk_fma_f32 v[118:119], v[112:113], v[156:157], v[118:119] neg_lo:[1,0,0] neg_hi:[1,0,0]
    v_pk_fma_f32 v[120:121], v[112:113], v[148:149], v[120:121]
    v_pk_add_f32 v[78:79], v[114:115], v[118:119]
    v_pk_add_f32 v[94:95], v[116:117], v[120:121]
    v_pk_add_f32 v[86:87], v[120:121], v[116:117] neg_lo:[0,1] neg_hi:[0,1]
    v_pk_add_f32 v[102:103], v[114:115], v[118:119] neg_lo:[0,1] neg_hi:[0,1]
    v_pk_add_f32 v[106:107], v[80:81], v[104:105]
    v_pk_add_f32 v[108:109], v[96:97], v[88:89] neg_lo:[0,1] neg_hi:[0,1]
    v_pk_add_f32 v[110:111], v[80:81], v[104:105] neg_lo:[0,1] neg_hi:[0,1]
    v_pk_add_f32 v[112:113], v[96:97], v[88:89]
    v_pk_mul_f32 v[114:115], v[106:107], v[134:135]
    v_pk_mul_f32 v[116:117], v[106:107], v[142:143]
    v_pk_mul_f32 v[118:119], v[110:111], v[150:151]
    v_pk_mul_f32 v[120:121], v[110:111], v[158:159]
    buffer_load_dwordx4 a[204:207], v8, s[28:31], s83 offen offset:1024 sc1
    v_pk_fma_f32 v[114:115], v[108:109], v[142:143], v[114:115] neg_lo:[1,0,0] neg_hi:[1,0,0]
    v_pk_fma_f32 v[116:117], v[108:109], v[134:135], v[116:117]
    v_pk_fma_f32 v[118:119], v[112:113], v[158:159], v[118:119] neg_lo:[1,0,0] neg_hi:[1,0,0]
    v_pk_fma_f32 v[120:121], v[112:113], v[150:151], v[120:121]
    v_pk_add_f32 v[80:81], v[114:115], v[118:119]
    v_pk_add_f32 v[96:97], v[116:117], v[120:121]
    v_pk_add_f32 v[88:89], v[120:121], v[116:117] neg_lo:[0,1] neg_hi:[0,1]
    v_pk_add_f32 v[104:105], v[114:115], v[118:119] neg_lo:[0,1] neg_hi:[0,1]
    v_mfma_f32_16x16x32_bf16 v[128:131], a[0:3], v[58:61], 0
    ds_read_u16_d16_hi v201, v15 offset:25088
    v_cndmask_b32 v74, v74, v2, s[74:75]
    v_mfma_f32_16x16x32_bf16 v[132:135], a[8:11], v[58:61], 0
    ds_read_u16_d16_hi v202, v15 offset:30720
    v_cndmask_b32 v90, v90, v3, s[74:75]
    v_mfma_f32_16x16x32_bf16 v[136:139], a[16:19], v[58:61], 0
    ds_read_u16_d16_hi v203, v15 offset:31232
    v_cndmask_b32 v82, v82, v4, s[74:75]
    v_mfma_f32_16x16x32_bf16 v[140:143], a[24:27], v[58:61], 0
    ds_read_u16_d16_hi v204, v15 offset:36864
    v_cndmask_b32 v98, v98, v5, s[74:75]
    v_mfma_f32_16x16x32_bf16 v[128:131], a[4:7], v[62:65], v[128:131]
    ds_read_u16_d16_hi v205, v15 offset:37376
    v_cvt_pk_bf16_f32 v26, v74, v75
    v_mfma_f32_16x16x32_bf16 v[132:135], a[12:15], v[62:65], v[132:135]
    ds_read_u16_d16_hi v206, v15 offset:43008
    v_cvt_pk_bf16_f32 v27, v76, v77
    v_mfma_f32_16x16x32_bf16 v[136:139], a[20:23], v[62:65], v[136:139]
    ds_read_u16_d16_hi v207, v15 offset:43520
    v_cvt_pk_bf16_f32 v28, v78, v79
    v_mfma_f32_16x16x32_bf16 v[140:143], a[28:31], v[62:65], v[140:143]
    ds_read_u16_d16_hi v208, v13 offset:0
    v_cvt_pk_bf16_f32 v29, v80, v81
    v_mfma_f32_16x16x32_bf16 v[144:147], a[0:3], v[66:69], 0
    ds_read_u16_d16_hi v209, v13 offset:512
    v_cvt_pk_bf16_f32 v30, v82, v83
    v_mfma_f32_16x16x32_bf16 v[148:151], a[8:11], v[66:69], 0
    ds_read_u16_d16_hi v210, v13 offset:6144
    v_cvt_pk_bf16_f32 v31, v84, v85
    v_mfma_f32_16x16x32_bf16 v[152:155], a[16:19], v[66:69], 0
    ds_read_u16_d16_hi v211, v13 offset:6656
    v_cvt_pk_bf16_f32 v32, v86, v87
    v_mfma_f32_16x16x32_bf16 v[156:159], a[24:27], v[66:69], 0
    ds_read_u16_d16_hi v212, v13 offset:12288
    v_cvt_pk_bf16_f32 v33, v88, v89
    v_mfma_f32_16x16x32_bf16 v[144:147], a[4:7], v[70:73], v[144:147]
    ds_read_u16_d16_hi v213, v13 offset:12800
    v_cvt_pk_bf16_f32 v34, v90, v91
    v_mfma_f32_16x16x32_bf16 v[148:151], a[12:15], v[70:73], v[148:151]
    ds_read_u16_d16_hi v214, v13 offset:18432
    v_cvt_pk_bf16_f32 v35, v92, v93
    v_mfma_f32_16x16x32_bf16 v[152:155], a[20:23], v[70:73], v[152:155]
    ds_read_u16_d16_hi v215, v13 offset:18944
    v_cvt_pk_bf16_f32 v36, v94, v95
    v_mfma_f32_16x16x32_bf16 v[156:159], a[28:31], v[70:73], v[156:159]
    ds_read_u16_d16_hi v216, v13 offset:24576
    v_cvt_pk_bf16_f32 v37, v96, v97
    v_cvt_pk_bf16_f32 v38, v98, v99
    v_cvt_pk_bf16_f32 v39, v100, v101
    v_cvt_pk_bf16_f32 v40, v102, v103
    v_cvt_pk_bf16_f32 v41, v104, v105
    v_pk_add_f32 v[106:107], v[224:225], v[248:249]
    v_pk_add_f32 v[108:109], v[240:241], v[232:233] neg_lo:[0,1] neg_hi:[0,1]
    v_pk_add_f32 v[110:111], v[224:225], v[248:249] neg_lo:[0,1] neg_hi:[0,1]
    v_pk_add_f32 v[112:113], v[240:241], v[232:233]
    v_pk_mul_f32 v[114:115], v[106:107], v[160:161]
    s_waitcnt lgkmcnt(15)
    v_pk_mul_f32 v[116:117], v[106:107], v[168:169]
    v_pk_mul_f32 v[118:119], v[110:111], v[176:177]
    v_pk_mul_f32 v[120:121], v[110:111], v[184:185]
    v_mul_f32 v2, v224, v160
    v_mul_f32 v3, v224, v168
    v_mul_f32 v4, v232, v176
    v_mul_f32 v5, v232, v184
    v_fma_f32 v2, -v240, v168, v2
    v_fma_f32 v3, v240, v160, v3
    v_fma_f32 v4, -v248, v184, v4
    v_fma_f32 v5, v248, v176, v5
    buffer_load_dwordx4 a[208:211], v8, s[28:31], s83 offen offset:2048 sc1
    v_pk_fma_f32 v[114:115], v[108:109], v[168:169], v[114:115] neg_lo:[1,0,0] neg_hi:[1,0,0]
    v_pk_fma_f32 v[116:117], v[108:109], v[160:161], v[116:117]
    v_pk_fma_f32 v[118:119], v[112:113], v[184:185], v[118:119] neg_lo:[1,0,0] neg_hi:[1,0,0]
    v_pk_fma_f32 v[120:121], v[112:113], v[176:177], v[120:121]
    v_pk_add_f32 v[224:225], v[114:115], v[118:119]
    v_pk_add_f32 v[240:241], v[116:117], v[120:121]
    v_pk_add_f32 v[232:233], v[120:121], v[116:117] neg_lo:[0,1] neg_hi:[0,1]
    v_pk_add_f32 v[248:249], v[114:115], v[118:119] neg_lo:[0,1] neg_hi:[0,1]
    v_pk_add_f32 v[106:107], v[226:227], v[250:251]
    v_pk_add_f32 v[108:109], v[242:243], v[234:235] neg_lo:[0,1] neg_hi:[0,1]
    v_pk_add_f32 v[110:111], v[226:227], v[250:251] neg_lo:[0,1] neg_hi:[0,1]
    v_pk_add_f32 v[112:113], v[242:243], v[234:235]
    v_pk_mul_f32 v[114:115], v[106:107], v[162:163]
    v_pk_mul_f32 v[116:117], v[106:107], v[170:171]
    v_pk_mul_f32 v[118:119], v[110:111], v[178:179]
    v_pk_mul_f32 v[120:121], v[110:111], v[186:187]
    buffer_load_dwordx4 a[212:215], v8, s[28:31], s83 offen offset:3072 sc1
    v_pk_fma_f32 v[114:115], v[108:109], v[170:171], v[114:115] neg_lo:[1,0,0] neg_hi:[1,0,0]
    v_pk_fma_f32 v[116:117], v[108:109], v[162:163], v[116:117]
    v_pk_fma_f32 v[118:119], v[112:113], v[186:187], v[118:119] neg_lo:[1,0,0] neg_hi:[1,0,0]
    v_pk_fma_f32 v[120:121], v[112:113], v[178:179], v[120:121]
    v_pk_add_f32 v[226:227], v[114:115], v[118:119]
    v_pk_add_f32 v[242:243], v[116:117], v[120:121]
    v_pk_add_f32 v[234:235], v[120:121], v[116:117] neg_lo:[0,1] neg_hi:[0,1]
    v_pk_add_f32 v[250:251], v[114:115], v[118:119] neg_lo:[0,1] neg_hi:[0,1]
    v_pk_add_f32 v[106:107], v[228:229], v[252:253]
    v_pk_add_f32 v[108:109], v[244:245], v[236:237] neg_lo:[0,1] neg_hi:[0,1]
    v_pk_add_f32 v[110:111], v[228:229], v[252:253] neg_lo:[0,1] neg_hi:[0,1]
    v_pk_add_f32 v[112:113], v[244:245], v[236:237]
    v_pk_mul_f32 v[114:115], v[106:107], v[164:165]
    v_pk_mul_f32 v[116:117], v[106:107], v[172:173]
    v_pk_mul_f32 v[118:119], v[110:111], v[180:181]
    v_pk_mul_f32 v[120:121], v[110:111], v[188:189]
    s_add_u32 s83, s83, 4096
    buffer_load_dwordx4 a[216:219], v8, s[28:31], s83 offen offset:0 sc1
    v_pk_fma_f32 v[114:115], v[108:109], v[172:173], v[114:115] neg_lo:[1,0,0] neg_hi:[1,0,0]
    v_pk_fma_f32 v[116:117], v[108:109], v[164:165], v[116:117]
    v_pk_fma_f32 v[118:119], v[112:113], v[188:189], v[118:119] neg_lo:[1,0,0] neg_hi:[1,0,0]
    v_pk_fma_f32 v[120:121], v[112:113], v[180:181], v[120:121]
    v_pk_add_f32 v[228:229], v[114:115], v[118:119]
    v_pk_add_f32 v[244:245], v[116:117], v[120:121]
    v_pk_add_f32 v[236:237], v[120:121], v[116:117] neg_lo:[0,1] neg_hi:[0,1]
    v_pk_add_f32 v[252:253], v[114:115], v[118:119] neg_lo:[0,1] neg_hi:[0,1]
spec_pg2:
    s_cbranch_execz spec_ret
    v_pk_add_f32 v[106:107], v[230:231], v[254:255]
    v_pk_add_f32 v[108:109], v[246:247], v[238:239] neg_lo:[0,1] neg_hi:[0,1]
    v_pk_add_f32 v[110:111], v[230:231], v[254:255] neg_lo:[0,1] neg_hi:[0,1]
    v_pk_add_f32 v[112:113], v[246:247], v[238:239]
    v_pk_mul_f32 v[114:115], v[106:107], v[166:167]
    v_pk_mul_f32 v[116:117], v[106:107], v[174:175]
    v_pk_mul_f32 v[118:119], v[110:111], v[182:183]
    v_pk_mul_f32 v[120:121], v[110:111], v[190:191]
    buffer_load_dwordx4 a[220:223], v8, s[28:31], s83 offen offset:1024 sc1
    v_pk_fma_f32 v[114:115], v[108:109], v[174:175], v[114:115] neg_lo:[1,0,0] neg_hi:[1,0,0]
    v_pk_fma_f32 v[116:117], v[108:109], v[166:167], v[116:117]
    v_pk_fma_f32 v[118:119], v[112:113], v[190:191], v[118:119] neg_lo:[1,0,0] neg_hi:[1,0,0]
    v_pk_fma_f32 v[120:121], v[112:113], v[182:183], v[120:121]
    v_pk_add_f32 v[230:231], v[114:115], v[118:119]
    v_pk_add_f32 v[246:247], v[116:117], v[120:121]
    v_pk_add_f32 v[238:239], v[120:121], v[116:117] neg_lo:[0,1] neg_hi:[0,1]
    v_pk_add_f32 v[254:255], v[114:115], v[118:119] neg_lo:[0,1] neg_hi:[0,1]
    v_mfma_f32_16x16x32_bf16 v[74:77], v[26:29], a[32:35], 0
    ds_read_u16_d16_hi v217, v13 offset:25088
    v_cndmask_b32 v224, v224, v2, s[74:75]
    v_mfma_f32_16x16x32_bf16 v[78:81], v[26:29], a[40:43], 0
    ds_read_u16_d16_hi v218, v13 offset:30720
    v_cndmask_b32 v240, v240, v3, s[74:75]
    v_mfma_f32_16x16x32_bf16 v[82:85], v[26:29], a[48:51], 0
    ds_read_u16_d16_hi v219, v13 offset:31232
    v_cndmask_b32 v232, v232, v4, s[74:75]
    v_mfma_f32_16x16x32_bf16 v[86:89], v[26:29], a[56:59], 0
    ds_read_u16_d16_hi v220, v13 offset:36864
    v_cndmask_b32 v248, v248, v5, s[74:75]
    v_mfma_f32_16x16x32_bf16 v[74:77], v[30:33], a[36:39], v[74:77]
    ds_read_u16_d16_hi v221, v13 offset:37376
    v_cvt_pk_bf16_f32 v42, v224, v225
    v_mfma_f32_16x16x32_bf16 v[78:81], v[30:33], a[44:47], v[78:81]
    ds_read_u16_d16_hi v222, v13 offset:43008
    v_cvt_pk_bf16_f32 v43, v226, v227
    v_mfma_f32_16x16x32_bf16 v[82:85], v[30:33], a[52:55], v[82:85]
    ds_read_u16_d16_hi v223, v13 offset:43520
    v_cvt_pk_bf16_f32 v44, v228, v229
    v_mfma_f32_16x16x32_bf16 v[86:89], v[30:33], a[60:63], v[86:89]
    v_cvt_pk_bf16_f32 v45, v230, v231
    v_cvt_pk_bf16_f32 v46, v232, v233
    v_mfma_f32_16x16x32_bf16 v[90:93], v[34:37], a[32:35], 0
    v_cvt_pk_bf16_f32 v47, v234, v235
    v_cvt_pk_bf16_f32 v48, v236, v237
    v_mfma_f32_16x16x32_bf16 v[94:97], v[34:37], a[40:43], 0
    v_cvt_pk_bf16_f32 v49, v238, v239
    v_cvt_pk_bf16_f32 v50, v240, v241
    v_mfma_f32_16x16x32_bf16 v[98:101], v[34:37], a[48:51], 0
    v_cvt_pk_bf16_f32 v51, v242, v243
    v_cvt_pk_bf16_f32 v52, v244, v245
    v_mfma_f32_16x16x32_bf16 v[102:105], v[34:37], a[56:59], 0
    v_cvt_pk_bf16_f32 v53, v246, v247
    v_cvt_pk_bf16_f32 v54, v248, v249
    v_mfma_f32_16x16x32_bf16 v[90:93], v[38:41], a[36:39], v[90:93]
    v_cvt_pk_bf16_f32 v55, v250, v251
    v_cvt_pk_bf16_f32 v56, v252, v253
    v_mfma_f32_16x16x32_bf16 v[94:97], v[38:41], a[44:47], v[94:97]
    v_cvt_pk_bf16_f32 v57, v254, v255
    v_mfma_f32_16x16x32_bf16 v[98:101], v[38:41], a[52:55], v[98:101]
    v_mfma_f32_16x16x32_bf16 v[102:105], v[38:41], a[60:63], v[102:105]
    v_pk_add_f32 v[106:107], v[128:129], v[152:153]
    v_pk_add_f32 v[108:109], v[144:145], v[136:137] neg_lo:[0,1] neg_hi:[0,1]
    v_pk_add_f32 v[110:111], v[128:129], v[152:153] neg_lo:[0,1] neg_hi:[0,1]
    v_pk_add_f32 v[112:113], v[144:145], v[136:137]
    v_pk_mul_f32 v[114:115], v[106:107], v[192:193]
    v_pk_mul_f32 v[116:117], v[106:107], v[200:201]
    s_waitcnt lgkmcnt(14)
    v_pk_mul_f32 v[118:119], v[110:111], v[208:209]
    s_waitcnt lgkmcnt(6)
    v_pk_mul_f32 v[120:121], v[110:111], v[216:217]
    v_mul_f32 v2, v128, v192
    v_mul_f32 v3, v128, v200
    v_mul_f32 v4, v136, v208
    v_mul_f32 v5, v136, v216
    v_fma_f32 v2, -v144, v200, v2
    v_fma_f32 v3, v144, v192, v3
    v_fma_f32 v4, -v152, v216, v4
    v_fma_f32 v5, v152, v208, v5
    buffer_load_dwordx4 a[224:227], v8, s[28:31], s83 offen offset:2048 sc1
    v_pk_fma_f32 v[114:115], v[108:109], v[200:201], v[114:115] neg_lo:[1,0,0] neg_hi:[1,0,0]
    v_pk_fma_f32 v[116:117], v[108:109], v[192:193], v[116:117]
    v_pk_fma_f32 v[118:119], v[112:113], v[216:217], v[118:119] neg_lo:[1,0,0] neg_hi:[1,0,0]
    v_pk_fma_f32 v[120:121], v[112:113], v[208:209], v[120:121]
    v_pk_add_f32 v[128:129], v[114:115], v[118:119]
    v_pk_add_f32 v[144:145], v[116:117], v[120:121]
    v_pk_add_f32 v[136:137], v[120:121], v[116:117] neg_lo:[0,1] neg_hi:[0,1]
    v_pk_add_f32 v[152:153], v[114:115], v[118:119] neg_lo:[0,1] neg_hi:[0,1]
    v_pk_add_f32 v[106:107], v[130:131], v[154:155]
    v_pk_add_f32 v[108:109], v[146:147], v[138:139] neg_lo:[0,1] neg_hi:[0,1]
    v_pk_add_f32 v[110:111], v[130:131], v[154:155] neg_lo:[0,1] neg_hi:[0,1]
    v_pk_add_f32 v[112:113], v[146:147], v[138:139]
    v_pk_mul_f32 v[114:115], v[106:107], v[194:195]
    v_pk_mul_f32 v[116:117], v[106:107], v[202:203]
    v_pk_mul_f32 v[118:119], v[110:111], v[210:211]
    s_waitcnt lgkmcnt(4)
    v_pk_mul_f32 v[120:121], v[110:111], v[218:219]
    buffer_load_dwordx4 a[228:231], v8, s[28:31], s83 offen offset:3072 sc1
    v_pk_fma_f32 v[114:115], v[108:109], v[202:203], v[114:115] neg_lo:[1,0,0] neg_hi:[1,0,0]
    v_pk_fma_f32 v[116:117], v[108:109], v[194:195], v[116:117]
    v_pk_fma_f32 v[118:119], v[112:113], v[218:219], v[118:119] neg_lo:[1,0,0] neg_hi:[1,0,0]
    v_pk_fma_f32 v[120:121], v[112:113], v[210:211], v[120:121]
    v_pk_add_f32 v[130:131], v[114:115], v[118:119]
    v_pk_add_f32 v[146:147], v[116:117], v[120:121]
    v_pk_add_f32 v[138:139], v[120:121], v[116:117] neg_lo:[0,1] neg_hi:[0,1]
    v_pk_add_f32 v[154:155], v[114:115], v[118:119] neg_lo:[0,1] neg_hi:[0,1]
    v_pk_add_f32 v[106:107], v[132:133], v[156:157]
    v_pk_add_f32 v[108:109], v[148:149], v[140:141] neg_lo:[0,1] neg_hi:[0,1]
    v_pk_add_f32 v[110:111], v[132:133], v[156:157] neg_lo:[0,1] neg_hi:[0,1]
    v_pk_add_f32 v[112:113], v[148:149], v[140:141]
    v_pk_mul_f32 v[114:115], v[106:107], v[196:197]
    v_pk_mul_f32 v[116:117], v[106:107], v[204:205]
    v_pk_mul_f32 v[118:119], v[110:111], v[212:213]
    s_waitcnt lgkmcnt(2)
    v_pk_mul_f32 v[120:121], v[110:111], v[220:221]
    s_add_u32 s83, s83, 4096
    buffer_load_dwordx4 a[232:235], v8, s[28:31], s83 offen offset:0 sc1
    v_pk_fma_f32 v[114:115], v[108:109], v[204:205], v[114:115] neg_lo:[1,0,0] neg_hi:[1,0,0]
    v_pk_fma_f32 v[116:117], v[108:109], v[196:197], v[116:117]
    v_pk_fma_f32 v[118:119], v[112:113], v[220:221], v[118:119] neg_lo:[1,0,0] neg_hi:[1,0,0]
    v_pk_fma_f32 v[120:121], v[112:113], v[212:213], v[120:121]
    v_pk_add_f32 v[132:133], v[114:115], v[118:119]
    v_pk_add_f32 v[148:149], v[116:117], v[120:121]
    v_pk_add_f32 v[140:141], v[120:121], v[116:117] neg_lo:[0,1] neg_hi:[0,1]
    v_pk_add_f32 v[156:157], v[114:115], v[118:119] neg_lo:[0,1] neg_hi:[0,1]
    v_pk_add_f32 v[106:107], v[134:135], v[158:159]
    v_pk_add_f32 v[108:109], v[150:151], v[142:143] neg_lo:[0,1] neg_hi:[0,1]
    v_pk_add_f32 v[110:111], v[134:135], v[158:159] neg_lo:[0,1] neg_hi:[0,1]
    v_pk_add_f32 v[112:113], v[150:151], v[142:143]
    v_pk_mul_f32 v[114:115], v[106:107], v[198:199]
    v_pk_mul_f32 v[116:117], v[106:107], v[206:207]
    v_pk_mul_f32 v[118:119], v[110:111], v[214:215]
    s_waitcnt lgkmcnt(0)
    v_pk_mul_f32 v[120:121], v[110:111], v[222:223]
    buffer_load_dwordx4 a[236:239], v8, s[28:31], s83 offen offset:1024 sc1
    v_pk_fma_f32 v[114:115], v[108:109], v[206:207], v[114:115] neg_lo:[1,0,0] neg_hi:[1,0,0]
    v_pk_fma_f32 v[116:117], v[108:109], v[198:199], v[116:117]
    v_pk_fma_f32 v[118:119], v[112:113], v[222:223], v[118:119] neg_lo:[1,0,0] neg_hi:[1,0,0]
    v_pk_fma_f32 v[120:121], v[112:113], v[214:215], v[120:121]
    v_pk_add_f32 v[134:135], v[114:115], v[118:119]
    v_pk_add_f32 v[150:151], v[116:117], v[120:121]
    v_pk_add_f32 v[142:143], v[120:121], v[116:117] neg_lo:[0,1] neg_hi:[0,1]
    v_pk_add_f32 v[158:159], v[114:115], v[118:119] neg_lo:[0,1] neg_hi:[0,1]
    s_barrier
    buffer_load_dword v124, v122, s[40:43], s76 offen
    s_add_u32 s76, s76, 7680
    v_mfma_f32_16x16x32_bf16 v[224:227], v[42:45], a[32:35], 0
    v_cndmask_b32 v128, v128, v2, s[74:75]
    v_cndmask_b32 v144, v144, v3, s[74:75]
    v_mfma_f32_16x16x32_bf16 v[228:231], v[42:45], a[40:43], 0
    v_cndmask_b32 v136, v136, v4, s[74:75]
    v_cndmask_b32 v152, v152, v5, s[74:75]
    v_mfma_f32_16x16x32_bf16 v[232:235], v[42:45], a[48:51], 0
    v_cvt_pk_bf16_f32 v58, v128, v129
    v_cvt_pk_bf16_f32 v59, v130, v131
    v_mfma_f32_16x16x32_bf16 v[236:239], v[42:45], a[56:59], 0
    v_cvt_pk_bf16_f32 v60, v132, v133
    v_cvt_pk_bf16_f32 v61, v134, v135
    v_mfma_f32_16x16x32_bf16 v[224:227], v[46:49], a[36:39], v[224:227]
    v_cvt_pk_bf16_f32 v62, v136, v137
    v_cvt_pk_bf16_f32 v63, v138, v139
    v_mfma_f32_16x16x32_bf16 v[228:231], v[46:49], a[44:47], v[228:231]
    v_cvt_pk_bf16_f32 v64, v140, v141
    v_cvt_pk_bf16_f32 v65, v142, v143
    v_mfma_f32_16x16x32_bf16 v[232:235], v[46:49], a[52:55], v[232:235]
    v_cvt_pk_bf16_f32 v66, v144, v145
    v_cvt_pk_bf16_f32 v67, v146, v147
    v_mfma_f32_16x16x32_bf16 v[236:239], v[46:49], a[60:63], v[236:239]
    v_cvt_pk_bf16_f32 v68, v148, v149
    v_cvt_pk_bf16_f32 v69, v150, v151
    v_mfma_f32_16x16x32_bf16 v[240:243], v[50:53], a[32:35], 0
    v_cvt_pk_bf16_f32 v70, v152, v153
    v_cvt_pk_bf16_f32 v71, v154, v155
    v_mfma_f32_16x16x32_bf16 v[244:247], v[50:53], a[40:43], 0
    v_cvt_pk_bf16_f32 v72, v156, v157
    v_cvt_pk_bf16_f32 v73, v158, v159
    v_mfma_f32_16x16x32_bf16 v[248:251], v[50:53], a[48:51], 0
    v_cvt_pk_bf16_f32 v74, v74, v75
    v_cvt_pk_bf16_f32 v75, v76, v77
    v_mfma_f32_16x16x32_bf16 v[252:255], v[50:53], a[56:59], 0
    v_cvt_pk_bf16_f32 v78, v78, v79
    v_cvt_pk_bf16_f32 v79, v80, v81
    v_mfma_f32_16x16x32_bf16 v[240:243], v[54:57], a[36:39], v[240:243]
    v_cvt_pk_bf16_f32 v82, v82, v83
    v_cvt_pk_bf16_f32 v83, v84, v85
    v_mfma_f32_16x16x32_bf16 v[244:247], v[54:57], a[44:47], v[244:247]
    v_cvt_pk_bf16_f32 v86, v86, v87
    v_cvt_pk_bf16_f32 v87, v88, v89
    v_mfma_f32_16x16x32_bf16 v[248:251], v[54:57], a[52:55], v[248:251]
    v_cvt_pk_bf16_f32 v90, v90, v91
    v_cvt_pk_bf16_f32 v91, v92, v93
    v_mfma_f32_16x16x32_bf16 v[252:255], v[54:57], a[60:63], v[252:255]
    v_cvt_pk_bf16_f32 v94, v94, v95
    v_cvt_pk_bf16_f32 v95, v96, v97
    v_mfma_f32_16x16x32_bf16 v[160:163], v[58:61], a[32:35], 0
    v_cvt_pk_bf16_f32 v98, v98, v99
    v_cvt_pk_bf16_f32 v99, v100, v101
    v_mfma_f32_16x16x32_bf16 v[164:167], v[58:61], a[40:43], 0
    v_cvt_pk_bf16_f32 v102, v102, v103
    v_cvt_pk_bf16_f32 v103, v104, v105
    v_mfma_f32_16x16x32_bf16 v[168:171], v[58:61], a[48:51], 0
    v_cvt_pk_bf16_f32 v76, v224, v225
    v_cvt_pk_bf16_f32 v77, v226, v227
    v_mfma_f32_16x16x32_bf16 v[172:175], v[58:61], a[56:59], 0
    ds_write_b128 v20, v[74:77] offset:0
    v_mfma_f32_16x16x32_bf16 v[160:163], v[62:65], a[36:39], v[160:163]
    v_cvt_pk_bf16_f32 v80, v228, v229
    v_cvt_pk_bf16_f32 v81, v230, v231
    v_mfma_f32_16x16x32_bf16 v[164:167], v[62:65], a[44:47], v[164:167]
    ds_write_b128 v20, v[78:81] offset:5120
    v_mfma_f32_16x16x32_bf16 v[168:171], v[62:65], a[52:55], v[168:171]
    v_cvt_pk_bf16_f32 v84, v232, v233
    v_cvt_pk_bf16_f32 v85, v234, v235
    v_mfma_f32_16x16x32_bf16 v[172:175], v[62:65], a[60:63], v[172:175]
    ds_write_b128 v20, v[82:85] offset:10240
    v_mfma_f32_16x16x32_bf16 v[176:179], v[66:69], a[32:35], 0
    v_cvt_pk_bf16_f32 v88, v236, v237
    v_cvt_pk_bf16_f32 v89, v238, v239
    v_mfma_f32_16x16x32_bf16 v[180:183], v[66:69], a[40:43], 0
    ds_write_b128 v20, v[86:89] offset:15360
    v_mfma_f32_16x16x32_bf16 v[184:187], v[66:69], a[48:51], 0
    v_cvt_pk_bf16_f32 v92, v240, v241
    v_cvt_pk_bf16_f32 v93, v242, v243
    v_mfma_f32_16x16x32_bf16 v[188:191], v[66:69], a[56:59], 0
    ds_write_b128 v20, v[90:93] offset:20480
    v_mfma_f32_16x16x32_bf16 v[176:179], v[70:73], a[36:39], v[176:179]
    v_cvt_pk_bf16_f32 v96, v244, v245
    v_cvt_pk_bf16_f32 v97, v246, v247
    v_mfma_f32_16x16x32_bf16 v[180:183], v[70:73], a[44:47], v[180:183]
    ds_write_b128 v20, v[94:97] offset:25600
    v_mfma_f32_16x16x32_bf16 v[184:187], v[70:73], a[52:55], v[184:187]
    v_cvt_pk_bf16_f32 v100, v248, v249
    v_cvt_pk_bf16_f32 v101, v250, v251
    v_mfma_f32_16x16x32_bf16 v[188:191], v[70:73], a[60:63], v[188:191]
    ds_write_b128 v20, v[98:101] offset:30720
    v_cvt_pk_bf16_f32 v104, v252, v253
    v_cvt_pk_bf16_f32 v105, v254, v255
    ds_write_b128 v20, v[102:105] offset:35840
    buffer_load_dword v124, v122, s[40:43], s76 offen
    s_add_u32 s76, s76, 975360
    s_bitcmp1_b32 s3, 0
    s_cbranch_scc1 spec_noz
    v_cvt_pk_bf16_f32 v160, v160, v161
    v_cvt_pk_bf16_f32 v161, v162, v163
    ds_write_b64 v21, v[160:161] offset:0
    v_cvt_pk_bf16_f32 v164, v164, v165
    v_cvt_pk_bf16_f32 v165, v166, v167
    ds_write_b64 v21, v[164:165] offset:5120
    v_cvt_pk_bf16_f32 v168, v168, v169
    v_cvt_pk_bf16_f32 v169, v170, v171
    ds_write_b64 v21, v[168:169] offset:10240
    v_cvt_pk_bf16_f32 v172, v172, v173
    v_cvt_pk_bf16_f32 v173, v174, v175
    ds_write_b64 v21, v[172:173] offset:15360
    v_cvt_pk_bf16_f32 v176, v176, v177
    v_cvt_pk_bf16_f32 v177, v178, v179
    ds_write_b64 v21, v[176:177] offset:20480
    v_cvt_pk_bf16_f32 v180, v180, v181
    v_cvt_pk_bf16_f32 v181, v182, v183
    ds_write_b64 v21, v[180:181] offset:25600
    v_cvt_pk_bf16_f32 v184, v184, v185
    v_cvt_pk_bf16_f32 v185, v186, v187
    ds_write_b64 v21, v[184:185] offset:30720
    v_cvt_pk_bf16_f32 v188, v188, v189
    v_cvt_pk_bf16_f32 v189, v190, v191
    ds_write_b64 v21, v[188:189] offset:35840
spec_noz:
    s_waitcnt lgkmcnt(0)
    s_barrier
    ds_read_b128 v[74:77], v22 offset:0
    ds_read_b128 v[78:81], v22 offset:1024
    ds_read_b128 v[82:85], v22 offset:2048
    ds_read_b128 v[86:89], v22 offset:3072
    ds_read_b128 v[90:93], v22 offset:4096
    s_waitcnt lgkmcnt(3)
    s_waitcnt vmcnt(31)
    v_mfma_f32_16x16x32_bf16 v[128:131], a[120:123], v[74:77], 0
    ds_read_b128 v[94:97], v22 offset:20480
    s_waitcnt vmcnt(21)
    v_mfma_f32_16x16x32_bf16 v[132:135], a[160:163], v[74:77], 0
    s_waitcnt vmcnt(11)
    v_mfma_f32_16x16x32_bf16 v[136:139], a[200:203], v[74:77], 0
    v_mfma_f32_16x16x32_bf16 v[128:131], a[124:127], v[78:81], v[128:131]
    ds_read_b128 v[98:101], v22 offset:21504
    v_mfma_f32_16x16x32_bf16 v[132:135], a[164:167], v[78:81], v[132:135]
    s_waitcnt vmcnt(10)
    v_mfma_f32_16x16x32_bf16 v[136:139], a[204:207], v[78:81], v[136:139]
    s_waitcnt lgkmcnt(3)
    v_mfma_f32_16x16x32_bf16 v[128:131], a[128:131], v[82:85], v[128:131]
    ds_read_b128 v[102:105], v22 offset:22528
    v_mfma_f32_16x16x32_bf16 v[132:135], a[168:171], v[82:85], v[132:135]
    s_waitcnt vmcnt(9)
    v_mfma_f32_16x16x32_bf16 v[136:139], a[208:211], v[82:85], v[136:139]
    v_mfma_f32_16x16x32_bf16 v[128:131], a[132:135], v[86:89], v[128:131]
    ds_read_b128 v[74:77], v22 offset:23552
    v_mfma_f32_16x16x32_bf16 v[132:135], a[172:175], v[86:89], v[132:135]
    s_waitcnt vmcnt(8)
    v_mfma_f32_16x16x32_bf16 v[136:139], a[212:215], v[86:89], v[136:139]
    s_waitcnt lgkmcnt(3)
    v_mfma_f32_16x16x32_bf16 v[128:131], a[136:139], v[90:93], v[128:131]
    ds_read_b128 v[78:81], v22 offset:24576
    v_mfma_f32_16x16x32_bf16 v[132:135], a[176:179], v[90:93], v[132:135]
    s_waitcnt vmcnt(7)
    v_mfma_f32_16x16x32_bf16 v[136:139], a[216:219], v[90:93], v[136:139]
    v_mfma_f32_16x16x32_bf16 v[140:143], a[140:143], v[94:97], v[128:131]
    ds_read_b128 v[82:85], v23 offset:0
    v_mfma_f32_16x16x32_bf16 v[144:147], a[180:183], v[94:97], v[132:135]
    s_waitcnt vmcnt(6)
    v_mfma_f32_16x16x32_bf16 v[148:151], a[220:223], v[94:97], v[136:139]
    s_waitcnt lgkmcnt(3)
    buffer_load_dword v124, v122, s[40:43], s76 offen
    s_add_u32 s76, s76, 7680
    v_mfma_f32_16x16x32_bf16 v[140:143], a[144:147], v[98:101], v[140:143]
    ds_read_b128 v[86:89], v23 offset:1024
    v_mfma_f32_16x16x32_bf16 v[144:147], a[184:187], v[98:101], v[144:147]
    s_waitcnt vmcnt(6)
    v_mfma_f32_16x16x32_bf16 v[148:151], a[224:227], v[98:101], v[148:151]
    v_mfma_f32_16x16x32_bf16 v[140:143], a[148:151], v[102:105], v[140:143]
    ds_read_b128 v[90:93], v23 offset:2048
    v_mfma_f32_16x16x32_bf16 v[144:147], a[188:191], v[102:105], v[144:147]
    s_waitcnt vmcnt(5)
    v_mfma_f32_16x16x32_bf16 v[148:151], a[228:231], v[102:105], v[148:151]
    s_waitcnt lgkmcnt(3)
    v_mfma_f32_16x16x32_bf16 v[140:143], a[152:155], v[74:77], v[140:143]
    ds_read_b128 v[94:97], v23 offset:3072
    v_mfma_f32_16x16x32_bf16 v[144:147], a[192:195], v[74:77], v[144:147]
    s_waitcnt vmcnt(4)
    v_mfma_f32_16x16x32_bf16 v[148:151], a[232:235], v[74:77], v[148:151]
    v_mfma_f32_16x16x32_bf16 v[140:143], a[156:159], v[78:81], v[140:143]
    ds_read_b128 v[98:101], v23 offset:4096
    v_mfma_f32_16x16x32_bf16 v[144:147], a[196:199], v[78:81], v[144:147]
    s_waitcnt vmcnt(3)
    v_mfma_f32_16x16x32_bf16 v[148:151], a[236:239], v[78:81], v[148:151]
    s_waitcnt lgkmcnt(3)
    v_mfma_f32_16x16x32_bf16 v[152:155], a[120:123], v[82:85], 0
    ds_read_b128 v[102:105], v23 offset:20480
    v_mfma_f32_16x16x32_bf16 v[156:159], a[160:163], v[82:85], 0
    v_mfma_f32_16x16x32_bf16 v[152:155], a[124:127], v[86:89], v[152:155]
    ds_read_b128 v[74:77], v23 offset:21504
    v_cvt_pk_bf16_f32 v106, v140, v141
    v_cvt_pk_bf16_f32 v107, v142, v143
    v_mfma_f32_16x16x32_bf16 v[156:159], a[164:167], v[86:89], v[156:159]
    ds_write_b64 v24, v[106:107] offset:0
    v_fma_f32 v128, v128, 2.0, -v140
    s_waitcnt lgkmcnt(4)
    v_mfma_f32_16x16x32_bf16 v[152:155], a[128:131], v[90:93], v[152:155]
    ds_read_b128 v[78:81], v23 offset:22528
    v_fma_f32 v129, v129, 2.0, -v141
    v_fma_f32 v130, v130, 2.0, -v142
    v_mfma_f32_16x16x32_bf16 v[156:159], a[168:171], v[90:93], v[156:159]
    v_fma_f32 v131, v131, 2.0, -v143
    v_cvt_pk_bf16_f32 v108, v131, v130
    v_cvt_pk_bf16_f32 v109, v129, v128
    v_mfma_f32_16x16x32_bf16 v[152:155], a[132:135], v[94:97], v[152:155]
    ds_read_b128 v[82:85], v23 offset:23552
    ds_write_b64 v25, v[108:109] offset:32
    v_mfma_f32_16x16x32_bf16 v[156:159], a[172:175], v[94:97], v[156:159]
    v_cvt_pk_bf16_f32 v110, v144, v145
    v_cvt_pk_bf16_f32 v111, v146, v147
    s_waitcnt lgkmcnt(5)
    v_mfma_f32_16x16x32_bf16 v[152:155], a[136:139], v[98:101], v[152:155]
    ds_read_b128 v[86:89], v23 offset:24576
    ds_write_b64 v24, v[110:111] offset:32
    v_mfma_f32_16x16x32_bf16 v[156:159], a[176:179], v[98:101], v[156:159]
    v_fma_f32 v132, v132, 2.0, -v144
    v_fma_f32 v133, v133, 2.0, -v145
    v_fma_f32 v134, v134, 2.0, -v146
    v_mfma_f32_16x16x32_bf16 v[164:167], a[140:143], v[102:105], v[152:155]
    ds_read_b128 v[90:93], v22 offset:10240
    v_fma_f32 v135, v135, 2.0, -v147
    v_cvt_pk_bf16_f32 v112, v135, v134
    v_mfma_f32_16x16x32_bf16 v[168:171], a[180:183], v[102:105], v[156:159]
    v_cvt_pk_bf16_f32 v113, v133, v132
    ds_write_b64 v25, v[112:113] offset:0
    s_waitcnt lgkmcnt(6)
    buffer_load_dword v124, v122, s[40:43], s76 offen
    s_add_u32 s76, s76, 7680
    v_mfma_f32_16x16x32_bf16 v[164:167], a[144:147], v[74:77], v[164:167]
    ds_read_b128 v[94:97], v22 offset:11264
    v_cvt_pk_bf16_f32 v114, v148, v149
    v_cvt_pk_bf16_f32 v115, v150, v151
    v_mfma_f32_16x16x32_bf16 v[168:171], a[184:187], v[74:77], v[168:171]
    ds_write_b64 v7, v[114:115] offset:0
    v_fma_f32 v136, v136, 2.0, -v148
    v_mfma_f32_16x16x32_bf16 v[164:167], a[148:151], v[78:81], v[164:167]
    ds_read_b128 v[98:101], v22 offset:12288
    v_fma_f32 v137, v137, 2.0, -v149
    v_fma_f32 v138, v138, 2.0, -v150
    v_mfma_f32_16x16x32_bf16 v[168:171], a[188:191], v[78:81], v[168:171]
    v_fma_f32 v139, v139, 2.0, -v151
    v_cvt_pk_bf16_f32 v116, v139, v138
    v_cvt_pk_bf16_f32 v117, v137, v136
    s_waitcnt lgkmcnt(6)
    v_mfma_f32_16x16x32_bf16 v[164:167], a[152:155], v[82:85], v[164:167]
    ds_read_b128 v[102:105], v22 offset:13312
    ds_write_b64 v6, v[116:117] offset:32
    v_mfma_f32_16x16x32_bf16 v[168:171], a[192:195], v[82:85], v[168:171]
    v_mfma_f32_16x16x32_bf16 v[164:167], a[156:159], v[86:89], v[164:167]
    ds_read_b128 v[74:77], v22 offset:14336
    v_mfma_f32_16x16x32_bf16 v[168:171], a[196:199], v[86:89], v[168:171]
    s_waitcnt lgkmcnt(5)
    v_mfma_f32_16x16x32_bf16 v[128:131], a[120:123], v[90:93], 0
    ds_read_b128 v[78:81], v22 offset:30720
    v_mfma_f32_16x16x32_bf16 v[132:135], a[160:163], v[90:93], 0
    v_mfma_f32_16x16x32_bf16 v[136:139], a[200:203], v[90:93], 0
    v_mfma_f32_16x16x32_bf16 v[128:131], a[124:127], v[94:97], v[128:131]
    ds_read_b128 v[82:85], v22 offset:31744
    v_cvt_pk_bf16_f32 v106, v164, v165
    v_mfma_f32_16x16x32_bf16 v[132:135], a[164:167], v[94:97], v[132:135]
    v_cvt_pk_bf16_f32 v107, v166, v167
    v_mfma_f32_16x16x32_bf16 v[136:139], a[204:207], v[94:97], v[136:139]
    ds_write_b64 v18, v[106:107] offset:0
    s_waitcnt lgkmcnt(5)
    v_mfma_f32_16x16x32_bf16 v[128:131], a[128:131], v[98:101], v[128:131]
    ds_read_b128 v[86:89], v22 offset:32768
    v_fma_f32 v152, v152, 2.0, -v164
    v_mfma_f32_16x16x32_bf16 v[132:135], a[168:171], v[98:101], v[132:135]
    v_fma_f32 v153, v153, 2.0, -v165
    v_fma_f32 v154, v154, 2.0, -v166
    v_mfma_f32_16x16x32_bf16 v[136:139], a[208:211], v[98:101], v[136:139]
    v_fma_f32 v155, v155, 2.0, -v167
    v_cvt_pk_bf16_f32 v108, v155, v154
    v_mfma_f32_16x16x32_bf16 v[128:131], a[132:135], v[102:105], v[128:131]
    ds_read_b128 v[90:93], v22 offset:33792
    v_cvt_pk_bf16_f32 v109, v153, v152
    v_mfma_f32_16x16x32_bf16 v[132:135], a[172:175], v[102:105], v[132:135]
    ds_write_b64 v19, v[108:109] offset:32
    v_mfma_f32_16x16x32_bf16 v[136:139], a[212:215], v[102:105], v[136:139]
    v_cvt_pk_bf16_f32 v110, v168, v169
    v_cvt_pk_bf16_f32 v111, v170, v171
    s_waitcnt lgkmcnt(5)
    v_mfma_f32_16x16x32_bf16 v[128:131], a[136:139], v[74:77], v[128:131]
    ds_read_b128 v[94:97], v22 offset:34816
    v_mfma_f32_16x16x32_bf16 v[132:135], a[176:179], v[74:77], v[132:135]
    ds_write_b64 v18, v[110:111] offset:32
    v_mfma_f32_16x16x32_bf16 v[136:139], a[216:219], v[74:77], v[136:139]
    v_fma_f32 v156, v156, 2.0, -v168
    v_fma_f32 v157, v157, 2.0, -v169
    v_mfma_f32_16x16x32_bf16 v[140:143], a[140:143], v[78:81], v[128:131]
    ds_read_b128 v[98:101], v23 offset:10240
    v_fma_f32 v158, v158, 2.0, -v170
    v_mfma_f32_16x16x32_bf16 v[144:147], a[180:183], v[78:81], v[132:135]
    v_fma_f32 v159, v159, 2.0, -v171
    v_cvt_pk_bf16_f32 v112, v159, v158
    v_mfma_f32_16x16x32_bf16 v[148:151], a[220:223], v[78:81], v[136:139]
    v_cvt_pk_bf16_f32 v113, v157, v156
    s_waitcnt lgkmcnt(5)
    v_mfma_f32_16x16x32_bf16 v[140:143], a[144:147], v[82:85], v[140:143]
    ds_read_b128 v[102:105], v23 offset:11264
    v_mfma_f32_16x16x32_bf16 v[144:147], a[184:187], v[82:85], v[144:147]
    ds_write_b64 v19, v[112:113] offset:0
    v_mfma_f32_16x16x32_bf16 v[148:151], a[224:227], v[82:85], v[148:151]
    v_mfma_f32_16x16x32_bf16 v[140:143], a[148:151], v[86:89], v[140:143]
    ds_read_b128 v[74:77], v23 offset:12288
    v_mfma_f32_16x16x32_bf16 v[144:147], a[188:191], v[86:89], v[144:147]
    v_mfma_f32_16x16x32_bf16 v[148:151], a[228:231], v[86:89], v[148:151]
    s_waitcnt lgkmcnt(5)
    v_mfma_f32_16x16x32_bf16 v[140:143], a[152:155], v[90:93], v[140:143]
    ds_read_b128 v[78:81], v23 offset:13312
    v_mfma_f32_16x16x32_bf16 v[144:147], a[192:195], v[90:93], v[144:147]
    v_mfma_f32_16x16x32_bf16 v[148:151], a[232:235], v[90:93], v[148:151]
    v_mfma_f32_16x16x32_bf16 v[140:143], a[156:159], v[94:97], v[140:143]
    ds_read_b128 v[82:85], v23 offset:14336
    v_mfma_f32_16x16x32_bf16 v[144:147], a[196:199], v[94:97], v[144:147]
    v_mfma_f32_16x16x32_bf16 v[148:151], a[236:239], v[94:97], v[148:151]
    s_waitcnt lgkmcnt(4)
    v_mfma_f32_16x16x32_bf16 v[152:155], a[120:123], v[98:101], 0
    ds_read_b128 v[86:89], v23 offset:30720
    v_mfma_f32_16x16x32_bf16 v[156:159], a[160:163], v[98:101], 0
    v_mfma_f32_16x16x32_bf16 v[152:155], a[124:127], v[102:105], v[152:155]
    s_waitcnt lgkmcnt(4)
    s_barrier
    ds_read_b128 v[90:93], v23 offset:31744
    v_mfma_f32_16x16x32_bf16 v[156:159], a[164:167], v[102:105], v[156:159]
    ds_read_b128 v[26:29], v14 offset:0
    v_cvt_pk_bf16_f32 v106, v140, v141
    v_cvt_pk_bf16_f32 v107, v142, v143
    s_waitcnt lgkmcnt(4)
    v_mfma_f32_16x16x32_bf16 v[152:155], a[128:131], v[74:77], v[152:155]
    ds_read_b128 v[94:97], v23 offset:32768
    ds_write_b64 v24, v[106:107] offset:20992
    v_mfma_f32_16x16x32_bf16 v[156:159], a[168:171], v[74:77], v[156:159]
    ds_read_b128 v[30:33], v14 offset:128
    v_fma_f32 v128, v128, 2.0, -v140
    v_fma_f32 v129, v129, 2.0, -v141
    v_mfma_f32_16x16x32_bf16 v[152:155], a[132:135], v[78:81], v[152:155]
    ds_read_b128 v[98:101], v23 offset:33792
    v_fma_f32 v130, v130, 2.0, -v142
    v_fma_f32 v131, v131, 2.0, -v143
    v_mfma_f32_16x16x32_bf16 v[156:159], a[172:175], v[78:81], v[156:159]
    ds_read_b128 v[34:37], v14 offset:256
    v_cvt_pk_bf16_f32 v108, v131, v130
    v_cvt_pk_bf16_f32 v109, v129, v128
    s_waitcnt lgkmcnt(7)
    v_mfma_f32_16x16x32_bf16 v[152:155], a[136:139], v[82:85], v[152:155]
    ds_read_b128 v[102:105], v23 offset:34816
    ds_write_b64 v25, v[108:109] offset:21024
    v_mfma_f32_16x16x32_bf16 v[156:159], a[176:179], v[82:85], v[156:159]
    ds_read_b128 v[38:41], v14 offset:384
    v_cvt_pk_bf16_f32 v110, v144, v145
    v_cvt_pk_bf16_f32 v111, v146, v147
    v_mfma_f32_16x16x32_bf16 v[164:167], a[140:143], v[86:89], v[152:155]
    ds_read_b128 v[42:45], v14 offset:512
    ds_write_b64 v24, v[110:111] offset:21024
    v_mfma_f32_16x16x32_bf16 v[168:171], a[180:183], v[86:89], v[156:159]
    s_waitcnt lgkmcnt(10)
    buffer_store_dwordx4 v[26:29], v10, s[28:31], s78 offen offset:0 sc1
    s_waitcnt lgkmcnt(9)
    v_mfma_f32_16x16x32_bf16 v[164:167], a[144:147], v[90:93], v[164:167]
    s_waitcnt lgkmcnt(7)
    buffer_store_dwordx4 v[30:33], v10, s[28:31], s78 offen offset:128 sc1
    v_mfma_f32_16x16x32_bf16 v[168:171], a[184:187], v[90:93], v[168:171]
    s_waitcnt lgkmcnt(5)
    buffer_store_dwordx4 v[34:37], v10, s[28:31], s78 offen offset:256 sc1
    v_mfma_f32_16x16x32_bf16 v[164:167], a[148:151], v[94:97], v[164:167]
    s_waitcnt lgkmcnt(2)
    buffer_store_dwordx4 v[38:41], v10, s[28:31], s78 offen offset:384 sc1
    v_mfma_f32_16x16x32_bf16 v[168:171], a[188:191], v[94:97], v[168:171]
    s_waitcnt lgkmcnt(1)
    buffer_store_dwordx4 v[42:45], v10, s[28:31], s78 offen offset:512 sc1
    v_mfma_f32_16x16x32_bf16 v[164:167], a[152:155], v[98:101], v[164:167]
    v_fma_f32 v132, v132, 2.0, -v144
    v_fma_f32 v133, v133, 2.0, -v145
    v_fma_f32 v134, v134, 2.0, -v146
    v_mfma_f32_16x16x32_bf16 v[168:171], a[192:195], v[98:101], v[168:171]
    v_fma_f32 v135, v135, 2.0, -v147
    v_cvt_pk_bf16_f32 v112, v135, v134
    v_cvt_pk_bf16_f32 v113, v133, v132
    v_mfma_f32_16x16x32_bf16 v[164:167], a[156:159], v[102:105], v[164:167]
    ds_write_b64 v25, v[112:113] offset:20992
    v_cvt_pk_bf16_f32 v114, v148, v149
    v_mfma_f32_16x16x32_bf16 v[168:171], a[196:199], v[102:105], v[168:171]
    v_cvt_pk_bf16_f32 v115, v150, v151
    ds_write_b64 v7, v[114:115] offset:20992
    v_fma_f32 v136, v136, 2.0, -v148
    v_fma_f32 v137, v137, 2.0, -v149
    v_fma_f32 v138, v138, 2.0, -v150
    v_fma_f32 v139, v139, 2.0, -v151
    v_cvt_pk_bf16_f32 v116, v139, v138
    v_cvt_pk_bf16_f32 v117, v137, v136
spec_pg3:
    s_cbranch_execz spec_ret
    ds_write_b64 v6, v[116:117] offset:21024
    v_cvt_pk_bf16_f32 v106, v164, v165
    v_cvt_pk_bf16_f32 v107, v166, v167
    ds_write_b64 v18, v[106:107] offset:20992
    v_fma_f32 v152, v152, 2.0, -v164
    v_fma_f32 v153, v153, 2.0, -v165
    v_fma_f32 v154, v154, 2.0, -v166
    v_fma_f32 v155, v155, 2.0, -v167
    v_cvt_pk_bf16_f32 v108, v155, v154
    v_cvt_pk_bf16_f32 v109, v153, v152
    ds_write_b64 v19, v[108:109] offset:21024
    v_cvt_pk_bf16_f32 v110, v168, v169
    v_cvt_pk_bf16_f32 v111, v170, v171
    ds_write_b64 v18, v[110:111] offset:21024
    v_fma_f32 v156, v156, 2.0, -v168
    v_fma_f32 v157, v157, 2.0, -v169
    v_fma_f32 v158, v158, 2.0, -v170
    v_fma_f32 v159, v159, 2.0, -v171
    v_cvt_pk_bf16_f32 v112, v159, v158
    v_cvt_pk_bf16_f32 v113, v157, v156
    ds_write_b64 v19, v[112:113] offset:20992
    s_waitcnt lgkmcnt(0)
    s_barrier
    ds_read_b128 v[46:49], v14 offset:20992
    ds_read_b128 v[50:53], v14 offset:21120
    ds_read_b128 v[54:57], v14 offset:21248
    ds_read_b128 v[58:61], v14 offset:21376
    ds_read_b128 v[62:65], v14 offset:21504
    s_waitcnt lgkmcnt(4)
    buffer_store_dwordx4 v[46:49], v10, s[28:31], s78 offen offset:640 sc1
    s_waitcnt lgkmcnt(3)
    buffer_store_dwordx4 v[50:53], v10, s[28:31], s78 offen offset:768 sc1
    s_waitcnt lgkmcnt(2)
    buffer_store_dwordx4 v[54:57], v10, s[28:31], s78 offen offset:896 sc1
    s_waitcnt lgkmcnt(1)
    buffer_store_dwordx4 v[58:61], v10, s[28:31], s78 offen offset:1024 sc1
    s_waitcnt lgkmcnt(0)
    buffer_store_dwordx4 v[62:65], v10, s[28:31], s78 offen offset:1152 sc1
    s_waitcnt vmcnt(0)
    v_mov_b32 v2, s54
    s_mov_b32 exec_hi, 0
    buffer_store_dword v2, v17, s[28:31], s81 offen sc1
    s_mov_b32 exec_hi, -1
    s_endpgm
k_end:
.section .rodata,"a"
.p2align 6
.amdhsa_kernel recurrent_scan__spectral_gfnet__swiglu_ffn__prompt_kernel
  .amdhsa_next_free_vgpr 512
  .amdhsa_next_free_sgpr 102
  .amdhsa_accum_offset 256
  .amdhsa_group_segment_fixed_size 0
  .amdhsa_kernarg_size 80
  .amdhsa_user_sgpr_count 2
  .amdhsa_user_sgpr_kernarg_segment_ptr 1
  .amdhsa_system_sgpr_workgroup_id_x 1
  .amdhsa_float_denorm_mode_32 3
.end_amdhsa_kernel
```
